```python
import torch

def _softmax(x, axis=-1):
    return torch.softmax(x, dim=axis)
def _gelu(x):
    return torch.nn.functional.gelu(x, approximate="tanh")
def _silu(x):
    return torch.nn.functional.silu(x)
def _sigmoid(x):
    return torch.sigmoid(x)
def _layernorm(x, axis=-1, eps=1e-5):
    m = x.mean(dim=axis, keepdim=True)
    v = x.var(dim=axis, keepdim=True, unbiased=False)
    return (x - m) / torch.sqrt(v + eps)
def _scatter_add(tgt, idx, src, axis=0):
    return tgt.clone().index_add_(axis, idx, src)
def _segment_sum(src, seg, n):
    out = torch.zeros((n,) + src.shape[1:], dtype=src.dtype)
    return out.index_add_(0, seg, src)
def _pad(x, pw):
    flat = tuple(v for pair in reversed(pw) for v in pair)
    return torch.nn.functional.pad(x, flat)

kernel_name = 'interleave_layers__mha_block_cached__glu_gated_geglu__decode'

def setup_inputs():

    _w = (lambda a: (lambda t: t.to(torch.bfloat16) if t.is_floating_point() else t)(torch.as_tensor(a)))
    def _A_setup():
        B, Sq, D = 2, 1, 512
        H, Sk, Dh = 32, 8192, 128
        return {
            "x": _w((lambda *s: torch.randn(*s, dtype=torch.bfloat16) * 0.05)(B, Sq, D)),
            "k_cache": _w((lambda *s: torch.randn(*s, dtype=torch.bfloat16) * 0.8)(B, H, Sk, Dh)),
            "v_cache": _w((lambda *s: torch.randn(*s, dtype=torch.bfloat16) * 1.6)(B, H, Sk, Dh)),
            "wq": _w((lambda *s: torch.randn(*s, dtype=torch.bfloat16) * 0.8)(D, H * Dh) * (D ** -0.5)),
            "wo": _w((lambda *s: torch.randn(*s, dtype=torch.bfloat16) * 1.6)(H * Dh, D) * ((H * Dh) ** -0.5)),
        }
    _A_in = _A_setup()

    def _B_setup():
        B, S, Dm, Df = 2, 1, 512, 1792
        return {
            "x": _w((lambda *s: torch.randn(*s, dtype=torch.bfloat16) * 0.05)(B, S, Dm)),
            "w_gate": _w((lambda *s: torch.randn(*s, dtype=torch.bfloat16) * 0.4)(Dm, Df) * (Dm ** -0.5)),
            "w_up": _w((lambda *s: torch.randn(*s, dtype=torch.bfloat16) * 0.4)(Dm, Df) * (Dm ** -0.5)),
            "w_down": _w((lambda *s: torch.randn(*s, dtype=torch.bfloat16) * 0.4)(Df, Dm) * (Df ** -0.5)),
        }
    _B_in = _B_setup()

    return {
        "A_x": _A_in["x"],
        "A_k_cache": _A_in["k_cache"],
        "A_v_cache": _A_in["v_cache"],
        "A_wq": _A_in["wq"],
        "A_wo": _A_in["wo"],
        "B_x": _B_in["x"],
        "B_w_gate": _B_in["w_gate"],
        "B_w_up": _B_in["w_up"],
        "B_w_down": _B_in["w_down"],
    }

def reference(A_x, A_k_cache, A_v_cache, A_wq, A_wo, B_x, B_w_gate, B_w_up, B_w_down):
    def _A_ref(x, k_cache, v_cache, wq, wo):
        B, Sq, D = x.shape
        H, Dh = 32, 128
        q = (lambda x, *d: x.permute(*d))((x @ wq).reshape(B, Sq, H, Dh), 0, 2, 1, 3)
        scores = torch.einsum("bhqd,bhkd->bhqk", q, k_cache) * (Dh ** -0.5)
        p = _softmax(scores, axis=-1)
        o = torch.einsum("bhqk,bhkd->bhqd", p, v_cache)
        return (lambda x, *d: x.permute(*d))(o, 0, 2, 1, 3).reshape(B, Sq, H * Dh) @ wo

    def _B_ref(x, w_gate, w_up, w_down):
        g = torch.einsum("bsd,df->bsf", x, w_gate)
        u = torch.einsum("bsd,df->bsf", x, w_up)
        h = _gelu(g) * u
        return torch.einsum("bsf,fd->bsd", h, w_down)

    x = A_x
    x = x + _A_ref(_layernorm(x, axis=-1), A_k_cache, A_v_cache, A_wq, A_wo)
    x = x + _B_ref(_layernorm(x, axis=-1), B_w_gate, B_w_up, B_w_down)
    x = x + _A_ref(_layernorm(x, axis=-1), A_k_cache, A_v_cache, A_wq, A_wo)
    x = x + _B_ref(_layernorm(x, axis=-1), B_w_gate, B_w_up, B_w_down)
    return x
```

```asm
; @launch grid=(256,1,1) block=(256,1,1) lds=163840
.amdgcn_target "amdgcn-amd-amdhsa--gfx950"
.text
.globl interleave_layers__mha_block_cached__glu_gated_geglu__decode_kernel
.p2align 12
.p2align 8
.type interleave_layers__mha_block_cached__glu_gated_geglu__decode_kernel,@function
interleave_layers__mha_block_cached__glu_gated_geglu__decode_kernel:
    s_cmp_ge_u32 s2, 256
    s_cbranch_scc0 L_go
    s_endpgm
L_go:
    s_load_dwordx16 s[4:19], s[0:1], 0
    s_load_dwordx8 s[20:27], s[0:1], 64
    v_lshrrev_b32 v1, 6, v0
    v_and_b32 v0, 63, v0
    v_readfirstlane_b32 s3, v1
    s_mov_b32 s72, 400000
    s_lshr_b32 s73, s2, 5
    s_and_b32 s2, s2, 31
    s_sub_u32 s73, s73, 1
    s_nop 0
    s_cbranch_scc1 L_service
    s_mov_b32 s94, s2
    s_lshl_b32 s88, s94, 21
    s_mul_i32 s74, s73, 299008
    s_add_u32 s88, s88, s74
    s_lshl_b32 s74, s3, 12
    s_add_u32 s86, s88, s74
    s_xor_b32 s74, s74, 0x2000
    s_add_u32 s44, s88, s74
    v_lshlrev_b32 v1, 4, v0
    v_and_b32 v4, 3, v0
    v_lshlrev_b32 v4, 4, v4
    v_bfe_u32 v28, v0, 2, 2
    v_lshl_or_b32 v4, v28, 9, v4
    v_lshrrev_b32 v28, 4, v0
    v_lshl_or_b32 v4, v28, 6, v4
    s_waitcnt lgkmcnt(0)
    s_mov_b32 s28, s6
    s_mov_b32 s29, s7
    s_mov_b32 s30, 0x8000000
    s_mov_b32 s31, 0x00020000
    s_add_u32 s87, s86, 0x0
    buffer_load_dwordx4 a[0:3], v4, s[28:31], s87 offen offset:0 nt
    buffer_load_dwordx4 a[4:7], v4, s[28:31], s87 offen offset:256 nt
    buffer_load_dwordx4 a[8:11], v4, s[28:31], s87 offen offset:2048 nt
    buffer_load_dwordx4 a[12:15], v4, s[28:31], s87 offen offset:2304 nt
    s_add_u32 s87, s44, 0x4000
    buffer_load_dwordx4 a[16:19], v4, s[28:31], s87 offen offset:0 nt
    buffer_load_dwordx4 a[20:23], v4, s[28:31], s87 offen offset:256 nt
    s_mov_b64 exec, 0
    s_cmp_eq_u32 s3, 1
    s_cbranch_scc1 L_wa1
    s_cmp_eq_u32 s3, 2
    s_cbranch_scc1 L_wa2
    s_cmp_eq_u32 s3, 3
    s_cbranch_scc1 L_wa3
    s_branch L_wa0
L_wr0:
    s_mov_b64 exec, -1
    s_mov_b32 s32, s8
    s_mov_b32 s33, s9
    s_mov_b32 s34, 0x8000000
    s_mov_b32 s35, 0x00020000
    s_mov_b32 s36, s26
    s_mov_b32 s37, s27
    s_mov_b32 s38, 0x108800
    s_mov_b32 s39, 0x00020000
    s_mov_b32 s40, s24
    s_mov_b32 s41, s25
    s_mov_b32 s42, 0x100
    s_mov_b32 s43, 0x00020000
    s_mov_b32 s78, 0x33373337
    s_mov_b32 s79, 0x33373337
    s_lshr_b32 s95, s3, 1
    s_lshl_b32 s95, s95, 11
    s_and_b32 s74, s3, 1
    s_lshl_b32 s74, s74, 8
    s_add_u32 s95, s95, s74
    s_add_u32 s95, s95, s88
    s_add_u32 s95, s95, 294912
    s_mul_i32 s88, s3, 39936
    s_add_u32 s88, s88, 4096
    s_lshl_b32 s99, s3, 4
    v_add_u32 v11, s88, v1
    s_mul_i32 s89, s94, 11264
    s_and_b32 s96, s94, 7
    s_lshl_b32 s96, s96, 8
    s_add_u32 s96, s96, 0x108000
    s_lshr_b32 s101, s94, 3
    s_lshl2_add_u32 s101, s73, s101
    s_lshl3_add_u32 s101, s101, s96
    v_mov_b32 v28, 0
    v_mov_b32 v29, 0
    s_cmp_eq_u32 s3, 1
    s_nop 0
    s_cbranch_scc0 L_nz
    s_mov_b64 exec, 1
    buffer_store_dwordx2 v[28:29], off, s[36:39], s101
    s_mov_b64 exec, -1
    s_nop 1
L_nz:
    v_and_b32 v6, 3, v0
    v_lshlrev_b32 v6, 4, v6
    v_lshrrev_b32 v28, 4, v0
    v_lshl_or_b32 v6, v28, 6, v6
    s_lshl_b32 s92, s73, 9
    s_add_u32 s92, s92, s89
    s_add_u32 s92, s92, 3072
    s_lshl_b32 s93, s73, 7
    s_lshl3_add_u32 s93, s3, s93
    s_add_u32 s93, s93, s89
    s_and_b32 s94, s94, 7
    s_lshl_b32 s94, s94, 4
    s_getreg_b32 s98, hwreg(HW_REG_XCC_ID, 0, 4)
    s_or_b32 s98, s98, 0x80000000
    v_mov_b32 v28, 0xffff
    v_mov_b32 v29, 0xffff0000
    s_mov_b32 s80, 0x00010001
    s_mov_b32 s81, 0x00010001
    v_cndmask_b32 v44, 0, v28, s[80:81]
    s_mov_b32 s80, 0x00020002
    s_mov_b32 s81, 0x00020002
    v_cndmask_b32 v44, v44, v29, s[80:81]
    s_mov_b32 s80, 0x00040004
    s_mov_b32 s81, 0x00040004
    v_cndmask_b32 v45, 0, v28, s[80:81]
    s_mov_b32 s80, 0x00080008
    s_mov_b32 s81, 0x00080008
    v_cndmask_b32 v45, v45, v29, s[80:81]
    s_mov_b32 s80, 0x00100010
    s_mov_b32 s81, 0x00100010
    v_cndmask_b32 v46, 0, v28, s[80:81]
    s_mov_b32 s80, 0x00200020
    s_mov_b32 s81, 0x00200020
    v_cndmask_b32 v46, v46, v29, s[80:81]
    s_mov_b32 s80, 0x00400040
    s_mov_b32 s81, 0x00400040
    v_cndmask_b32 v47, 0, v28, s[80:81]
    s_mov_b32 s80, 0x00800080
    s_mov_b32 s81, 0x00800080
    v_cndmask_b32 v47, v47, v29, s[80:81]
    v_mov_b32 v28, 0x3e0293ee
    s_mov_b32 s80, 0x11111111
    s_mov_b32 s81, 0x11111111
    v_cndmask_b32 v7, 0, v28, s[80:81]
    s_mov_b32 s80, 0x22222222
    s_mov_b32 s81, 0x22222222
    v_cndmask_b32 v8, 0, v28, s[80:81]
    s_mov_b32 s80, 0x44444444
    s_mov_b32 s81, 0x44444444
    v_cndmask_b32 v9, 0, v28, s[80:81]
    s_mov_b32 s80, 0x88888888
    s_mov_b32 s81, 0x88888888
    v_cndmask_b32 v10, 0, v28, s[80:81]
    v_lshlrev_b32 v5, 3, v0
    s_waitcnt vmcnt(5)
    buffer_load_dwordx4 a[24:27], v4, s[28:31], s87 offen offset:2048 nt
    s_waitcnt vmcnt(5)
    buffer_load_dwordx4 a[28:31], v4, s[28:31], s87 offen offset:2304 nt
    s_waitcnt vmcnt(5)
    s_add_u32 s87, s86, 0x8000
    buffer_load_dwordx4 a[32:35], v4, s[28:31], s87 offen offset:0 nt
    s_waitcnt vmcnt(5)
    buffer_load_dwordx4 a[36:39], v4, s[28:31], s87 offen offset:256 nt
    s_waitcnt vmcnt(5)
    buffer_load_dwordx4 a[40:43], v4, s[28:31], s87 offen offset:2048 nt
    s_waitcnt vmcnt(5)
    buffer_load_dwordx4 a[44:47], v4, s[28:31], s87 offen offset:2304 nt
    s_waitcnt vmcnt(5)
    s_add_u32 s87, s44, 0xc000
    buffer_load_dwordx4 a[48:51], v4, s[28:31], s87 offen offset:0 nt
    s_waitcnt vmcnt(5)
    buffer_load_dwordx4 a[52:55], v4, s[28:31], s87 offen offset:256 nt
    s_waitcnt vmcnt(5)
    buffer_load_dwordx4 a[56:59], v4, s[28:31], s87 offen offset:2048 nt
    s_waitcnt vmcnt(5)
    buffer_load_dwordx4 a[60:63], v4, s[28:31], s87 offen offset:2304 nt
    s_waitcnt vmcnt(5)
    s_add_u32 s87, s86, 0x10000
    buffer_load_dwordx4 a[64:67], v4, s[28:31], s87 offen offset:0 nt
    s_waitcnt vmcnt(5)
    buffer_load_dwordx4 a[68:71], v4, s[28:31], s87 offen offset:256 nt
    s_waitcnt vmcnt(5)
    buffer_load_dwordx4 a[72:75], v4, s[28:31], s87 offen offset:2048 nt
    s_waitcnt vmcnt(5)
    buffer_load_dwordx4 a[76:79], v4, s[28:31], s87 offen offset:2304 nt
    s_waitcnt vmcnt(5)
    s_add_u32 s87, s44, 0x14000
    buffer_load_dwordx4 a[80:83], v4, s[28:31], s87 offen offset:0 nt
    s_waitcnt vmcnt(5)
    buffer_load_dwordx4 a[84:87], v4, s[28:31], s87 offen offset:256 nt
    s_mov_b64 exec, 0
    s_cmp_eq_u32 s3, 1
    s_cbranch_scc1 L_wa5
    s_cmp_eq_u32 s3, 2
    s_cbranch_scc1 L_wa6
    s_cmp_eq_u32 s3, 3
    s_cbranch_scc1 L_wa7
    s_branch L_wa4
L_wr1:
    s_mov_b64 exec, -1
    s_waitcnt vmcnt(5)
    buffer_load_dwordx4 a[88:91], v4, s[28:31], s87 offen offset:2048 nt
    s_waitcnt vmcnt(5)
    buffer_load_dwordx4 a[92:95], v4, s[28:31], s87 offen offset:2304 nt
    s_waitcnt vmcnt(5)
    s_add_u32 s87, s86, 0x18000
    buffer_load_dwordx4 a[96:99], v4, s[28:31], s87 offen offset:0 nt
    s_waitcnt vmcnt(5)
    buffer_load_dwordx4 a[100:103], v4, s[28:31], s87 offen offset:256 nt
    s_waitcnt vmcnt(5)
    buffer_load_dwordx4 a[104:107], v4, s[28:31], s87 offen offset:2048 nt
    s_waitcnt vmcnt(5)
    buffer_load_dwordx4 a[108:111], v4, s[28:31], s87 offen offset:2304 nt
    s_waitcnt vmcnt(5)
    s_add_u32 s87, s44, 0x1c000
    buffer_load_dwordx4 a[112:115], v4, s[28:31], s87 offen offset:0 nt
    s_waitcnt vmcnt(5)
    buffer_load_dwordx4 a[116:119], v4, s[28:31], s87 offen offset:256 nt
    s_waitcnt vmcnt(5)
    buffer_load_dwordx4 a[120:123], v4, s[28:31], s87 offen offset:2048 nt
    s_waitcnt vmcnt(5)
    buffer_load_dwordx4 a[124:127], v4, s[28:31], s87 offen offset:2304 nt
    s_waitcnt vmcnt(5)
    s_add_u32 s87, s86, 0x20000
    buffer_load_dwordx4 a[128:131], v4, s[28:31], s87 offen offset:0 nt
    s_waitcnt vmcnt(5)
    buffer_load_dwordx4 a[132:135], v4, s[28:31], s87 offen offset:256 nt
    s_mov_b64 exec, 0
    s_cmp_eq_u32 s3, 1
    s_cbranch_scc1 L_wa9
    s_cmp_eq_u32 s3, 2
    s_cbranch_scc1 L_wa10
    s_cmp_eq_u32 s3, 3
    s_cbranch_scc1 L_wa11
    s_branch L_wa8
L_wr2:
    s_mov_b64 exec, -1
    s_waitcnt vmcnt(5)
    buffer_load_dwordx4 a[136:139], v4, s[28:31], s87 offen offset:2048 nt
    s_waitcnt vmcnt(5)
    buffer_load_dwordx4 a[140:143], v4, s[28:31], s87 offen offset:2304 nt
    s_waitcnt vmcnt(5)
    s_add_u32 s87, s44, 0x24000
    buffer_load_dwordx4 a[144:147], v4, s[28:31], s87 offen offset:0 nt
    s_waitcnt vmcnt(5)
    buffer_load_dwordx4 a[148:151], v4, s[28:31], s87 offen offset:256 nt
    s_waitcnt vmcnt(5)
    buffer_load_dwordx4 a[152:155], v4, s[28:31], s87 offen offset:2048 nt
    s_waitcnt vmcnt(5)
    buffer_load_dwordx4 a[156:159], v4, s[28:31], s87 offen offset:2304 nt
    s_cmp_eq_u32 s3, 1
    s_cbranch_scc0 L_nv_1
    s_mov_b64 exec, 2
    buffer_store_byte v5, off, s[36:39], s101 offset:0
    s_mov_b32 exec_lo, -1
L_nv_1:
    s_mov_b32 exec_hi, 0
    buffer_load_ubyte v51, v5, s[36:39], s96 offen offset:0 sc1
    s_mov_b32 exec_hi, -1
    s_waitcnt vmcnt(6)
    s_add_u32 s87, s86, 0x28000
    buffer_load_dwordx4 a[160:163], v4, s[28:31], s87 offen offset:0 nt
    s_waitcnt vmcnt(6)
    buffer_load_dwordx4 a[164:167], v4, s[28:31], s87 offen offset:256 nt
    s_waitcnt vmcnt(6)
    buffer_load_dwordx4 a[168:171], v4, s[28:31], s87 offen offset:2048 nt
    s_waitcnt vmcnt(6)
    buffer_load_dwordx4 a[172:175], v4, s[28:31], s87 offen offset:2304 nt
    s_waitcnt vmcnt(6)
    s_add_u32 s87, s44, 0x2c000
    buffer_load_dwordx4 a[176:179], v4, s[28:31], s87 offen offset:0 nt
    s_waitcnt vmcnt(6)
    buffer_load_dwordx4 a[180:183], v4, s[28:31], s87 offen offset:256 nt
    s_mov_b64 exec, 0
    s_cmp_eq_u32 s3, 1
    s_cbranch_scc1 L_wa13
    s_cmp_eq_u32 s3, 2
    s_cbranch_scc1 L_wa14
    s_cmp_eq_u32 s3, 3
    s_cbranch_scc1 L_wa15
    s_branch L_wa12
L_wr3:
    s_mov_b64 exec, -1
    s_waitcnt vmcnt(6)
    v_cmp_ne_u32 vcc, 0, v51
    s_nop 0
    s_and_b32 vcc_lo, vcc_lo, 0x0fffffff
    s_bcnt1_i32_b32 s100, vcc_lo
    s_cmp_lt_u32 s100, 18
    s_cselect_b32 s100, -1, 0
    s_mov_b32 vcc_lo, s100
    s_mov_b32 vcc_hi, 0
    s_cbranch_vccz L_pc_2
    s_waitcnt vmcnt(5)
L_pc_2:
    buffer_load_dwordx4 a[184:187], v4, s[28:31], s87 offen offset:2048 nt
    s_cbranch_vccz L_pc_3
    s_waitcnt vmcnt(5)
L_pc_3:
    buffer_load_dwordx4 a[188:191], v4, s[28:31], s87 offen offset:2304 nt
    s_waitcnt vmcnt(7)
    s_cbranch_vccz L_pc_4
    s_waitcnt vmcnt(5)
L_pc_4:
    s_add_u32 s87, s86, 0x30000
    buffer_load_dwordx4 v[84:87], v4, s[28:31], s87 offen offset:0 nt
    s_waitcnt vmcnt(7)
    s_cbranch_vccz L_pc_5
    s_waitcnt vmcnt(5)
L_pc_5:
    buffer_load_dwordx4 v[88:91], v4, s[28:31], s87 offen offset:256 nt
    s_waitcnt vmcnt(7)
    s_cbranch_vccz L_pc_6
    s_waitcnt vmcnt(5)
L_pc_6:
    buffer_load_dwordx4 v[92:95], v4, s[28:31], s87 offen offset:2048 nt
    s_waitcnt vmcnt(7)
    s_cbranch_vccz L_pc_7
    s_waitcnt vmcnt(5)
L_pc_7:
    buffer_load_dwordx4 v[96:99], v4, s[28:31], s87 offen offset:2304 nt
    s_waitcnt vmcnt(7)
    s_cbranch_vccz L_pc_8
    s_waitcnt vmcnt(5)
L_pc_8:
    s_add_u32 s87, s44, 0x34000
    buffer_load_dwordx4 v[100:103], v4, s[28:31], s87 offen offset:0 nt
    s_waitcnt vmcnt(7)
    s_cbranch_vccz L_pc_9
    s_waitcnt vmcnt(5)
L_pc_9:
    buffer_load_dwordx4 v[104:107], v4, s[28:31], s87 offen offset:256 nt
    s_waitcnt vmcnt(7)
    s_cbranch_vccz L_pc_10
    s_waitcnt vmcnt(5)
L_pc_10:
    buffer_load_dwordx4 v[108:111], v4, s[28:31], s87 offen offset:2048 nt
    s_waitcnt vmcnt(7)
    s_cbranch_vccz L_pc_11
    s_waitcnt vmcnt(5)
L_pc_11:
    buffer_load_dwordx4 v[112:115], v4, s[28:31], s87 offen offset:2304 nt
    s_waitcnt vmcnt(7)
    s_cbranch_vccz L_pc_12
    s_waitcnt vmcnt(5)
L_pc_12:
    s_add_u32 s87, s86, 0x38000
    buffer_load_dwordx4 a[192:195], v4, s[28:31], s87 offen offset:0 nt
    s_waitcnt vmcnt(7)
    s_cbranch_vccz L_pc_13
    s_waitcnt vmcnt(5)
L_pc_13:
    buffer_load_dwordx4 a[196:199], v4, s[28:31], s87 offen offset:256 nt
    s_mov_b64 exec, 0
    s_cmp_eq_u32 s3, 1
    s_cbranch_scc1 L_wa17
    s_cmp_eq_u32 s3, 2
    s_cbranch_scc1 L_wa18
    s_cmp_eq_u32 s3, 3
    s_cbranch_scc1 L_wa19
    s_branch L_wa16
L_wr4:
    s_mov_b64 exec, -1
    s_waitcnt vmcnt(7)
    s_cbranch_vccz L_pc_14
    s_waitcnt vmcnt(5)
L_pc_14:
    buffer_load_dwordx4 a[200:203], v4, s[28:31], s87 offen offset:2048 nt
    s_waitcnt vmcnt(7)
    s_cbranch_vccz L_pc_15
    s_waitcnt vmcnt(5)
L_pc_15:
    buffer_load_dwordx4 a[204:207], v4, s[28:31], s87 offen offset:2304 nt
    s_waitcnt vmcnt(7)
    s_cbranch_vccz L_pc_16
    s_waitcnt vmcnt(5)
L_pc_16:
    s_add_u32 s87, s44, 0x3c000
    buffer_load_dwordx4 a[208:211], v4, s[28:31], s87 offen offset:0 nt
    s_waitcnt vmcnt(7)
    s_cbranch_vccz L_pc_17
    s_waitcnt vmcnt(5)
L_pc_17:
    buffer_load_dwordx4 a[212:215], v4, s[28:31], s87 offen offset:256 nt
    s_waitcnt vmcnt(7)
    s_cbranch_vccz L_pc_18
    s_waitcnt vmcnt(5)
L_pc_18:
    buffer_load_dwordx4 a[216:219], v4, s[28:31], s87 offen offset:2048 nt
    s_waitcnt vmcnt(7)
    s_cbranch_vccz L_pc_19
    s_waitcnt vmcnt(5)
L_pc_19:
    buffer_load_dwordx4 a[220:223], v4, s[28:31], s87 offen offset:2304 nt
    s_waitcnt vmcnt(7)
    s_cbranch_vccz L_pc_20
    s_waitcnt vmcnt(5)
L_pc_20:
    s_add_u32 s87, s86, 0x40000
    buffer_load_dwordx4 a[224:227], v4, s[28:31], s87 offen offset:0 nt
    s_waitcnt vmcnt(7)
    s_cbranch_vccz L_pc_21
    s_waitcnt vmcnt(5)
L_pc_21:
    buffer_load_dwordx4 a[228:231], v4, s[28:31], s87 offen offset:256 nt
    s_waitcnt vmcnt(7)
    s_cbranch_vccz L_pc_22
    s_waitcnt vmcnt(5)
L_pc_22:
    buffer_load_dwordx4 a[232:235], v4, s[28:31], s87 offen offset:2048 nt
    s_waitcnt vmcnt(7)
    s_cbranch_vccz L_pc_23
    s_waitcnt vmcnt(5)
L_pc_23:
    buffer_load_dwordx4 a[236:239], v4, s[28:31], s87 offen offset:2304 nt
    s_waitcnt vmcnt(7)
    s_cbranch_vccz L_pc_24
    s_waitcnt vmcnt(5)
L_pc_24:
    s_add_u32 s87, s44, 0x44000
    buffer_load_dwordx4 a[240:243], v4, s[28:31], s87 offen offset:0 nt
    s_waitcnt vmcnt(7)
    s_cbranch_vccz L_pc_25
    s_waitcnt vmcnt(5)
L_pc_25:
    buffer_load_dwordx4 a[244:247], v4, s[28:31], s87 offen offset:256 nt
L_wa0:
    s_cbranch_execz L_wr0
    s_waitcnt vmcnt(7)
    s_cbranch_vccz L_pc_26
    s_waitcnt vmcnt(5)
L_pc_26:
    buffer_load_dwordx4 a[248:251], v4, s[28:31], s87 offen offset:2048 nt
    s_waitcnt vmcnt(7)
    s_cbranch_vccz L_pc_27
    s_waitcnt vmcnt(5)
L_pc_27:
    buffer_load_dwordx4 a[252:255], v4, s[28:31], s87 offen offset:2304 nt
    s_waitcnt vmcnt(7)
    s_cbranch_vccz L_pc_28
    s_waitcnt vmcnt(5)
L_pc_28:
    s_add_u32 s87, s95, 0x0
    buffer_load_dwordx4 v[116:119], v4, s[28:31], s87 offen offset:0 nt
    s_waitcnt vmcnt(7)
    s_cbranch_vccz L_pc_29
    s_waitcnt vmcnt(5)
L_pc_29:
    s_add_u32 s87, s86, 0x0
    s_add_u32 m0, s88, 0x0
    s_nop 0
    buffer_load_dwordx4 v1, s[32:35], s87 offen offset:0 nt lds
    s_waitcnt vmcnt(7)
    s_cbranch_vccz L_pc_30
    s_waitcnt vmcnt(5)
L_pc_30:
    buffer_load_dwordx4 v1, s[32:35], s87 offen offset:1024 nt lds
    s_cmp_eq_u32 s3, 1
    s_cbranch_scc0 L_nv_31
    s_mov_b64 exec, 2
    buffer_store_byte v5, off, s[36:39], s101 offset:1
    s_mov_b32 exec_lo, -1
L_nv_31:
    s_mov_b32 exec_hi, 0
    buffer_load_ubyte v51, v5, s[36:39], s96 offen offset:1 sc1
    s_mov_b32 exec_hi, -1
    s_waitcnt vmcnt(8)
    s_cbranch_vccz L_pc_32
    s_waitcnt vmcnt(6)
L_pc_32:
    buffer_load_dwordx4 v1, s[32:35], s87 offen offset:2048 nt lds
    s_waitcnt vmcnt(8)
    s_cbranch_vccz L_pc_33
    s_waitcnt vmcnt(6)
L_pc_33:
    buffer_load_dwordx4 v1, s[32:35], s87 offen offset:3072 nt lds
    s_waitcnt vmcnt(8)
    s_cbranch_vccz L_pc_34
    s_waitcnt vmcnt(6)
L_pc_34:
    s_add_u32 s87, s44, 0x4000
    s_add_u32 m0, s88, 0x1000
    s_nop 0
    buffer_load_dwordx4 v1, s[32:35], s87 offen offset:0 nt lds
    s_waitcnt vmcnt(8)
    s_cbranch_vccz L_pc_35
    s_waitcnt vmcnt(6)
L_pc_35:
    buffer_load_dwordx4 v1, s[32:35], s87 offen offset:1024 nt lds
    buffer_load_dwordx4 v[28:31], off, s[40:43], s94 sc1
    s_waitcnt vmcnt(9)
    s_cbranch_vccz L_pc_36
    s_waitcnt vmcnt(7)
L_pc_36:
    buffer_load_dwordx4 v1, s[32:35], s87 offen offset:2048 nt lds
    s_waitcnt vmcnt(9)
    s_cbranch_vccz L_pc_37
    s_waitcnt vmcnt(7)
L_pc_37:
    buffer_load_dwordx4 v1, s[32:35], s87 offen offset:3072 nt lds
    s_waitcnt vmcnt(7)
    v_cmp_ne_u32 vcc, 0, v51
    s_nop 0
    s_and_b32 vcc_lo, vcc_lo, 0x0fffffff
    s_bcnt1_i32_b32 s100, vcc_lo
    s_cmp_lt_u32 s100, 18
    s_cselect_b32 s100, -1, 0
    s_mov_b32 vcc_lo, s100
    s_mov_b32 vcc_hi, 0
    s_cbranch_vccz L_pc_38
    s_waitcnt vmcnt(6)
L_pc_38:
    s_add_u32 s87, s86, 0x8000
    s_add_u32 m0, s88, 0x2000
    s_nop 0
    buffer_load_dwordx4 v1, s[32:35], s87 offen offset:0 nt lds
    s_cbranch_vccz L_pc_39
    s_waitcnt vmcnt(6)
L_pc_39:
    buffer_load_dwordx4 v1, s[32:35], s87 offen offset:1024 nt lds
    s_waitcnt vmcnt(8)
    s_cbranch_vccz L_pc_40
    s_waitcnt vmcnt(6)
L_pc_40:
    buffer_load_dwordx4 v1, s[32:35], s87 offen offset:2048 nt lds
    s_waitcnt vmcnt(8)
    s_cbranch_vccz L_pc_41
    s_waitcnt vmcnt(6)
L_pc_41:
    buffer_load_dwordx4 v1, s[32:35], s87 offen offset:3072 nt lds
    s_waitcnt vmcnt(8)
    s_cbranch_vccz L_pc_42
    s_waitcnt vmcnt(5)
L_pc_42:
    s_add_u32 s87, s44, 0xc000
    s_add_u32 m0, s88, 0x3000
    s_nop 0
    buffer_load_dwordx4 v1, s[32:35], s87 offen offset:0 nt lds
    s_waitcnt vmcnt(8)
    s_cbranch_vccz L_pc_43
    s_waitcnt vmcnt(5)
L_pc_43:
    buffer_load_dwordx4 v1, s[32:35], s87 offen offset:1024 nt lds
    s_waitcnt vmcnt(7)
    s_cbranch_vccz L_pc_44
    s_waitcnt vmcnt(5)
L_pc_44:
    buffer_load_dwordx4 v1, s[32:35], s87 offen offset:2048 nt lds
    s_waitcnt vmcnt(7)
    s_cbranch_vccz L_pc_45
    s_waitcnt vmcnt(5)
L_pc_45:
    buffer_load_dwordx4 v1, s[32:35], s87 offen offset:3072 nt lds
    s_waitcnt vmcnt(7)
    s_cbranch_vccz L_pc_46
    s_waitcnt vmcnt(5)
L_pc_46:
    s_add_u32 s87, s86, 0x10000
    s_add_u32 m0, s88, 0x4000
    s_nop 0
    buffer_load_dwordx4 v1, s[32:35], s87 offen offset:0 nt lds
    s_waitcnt vmcnt(7)
    s_cbranch_vccz L_pc_47
    s_waitcnt vmcnt(5)
L_pc_47:
    buffer_load_dwordx4 v1, s[32:35], s87 offen offset:1024 nt lds
L_fc:
    v_min3_u32 v32, v28, v29, v30
    v_min_u32 v32, v32, v31
    v_cmp_eq_u32 vcc, 0, v32
    s_nop 4
    s_cbranch_vccz L_fok
    buffer_load_dwordx4 v[28:31], off, s[40:43], s94 sc1
    s_waitcnt vmcnt(0)
    s_sub_u32 s72, s72, 1
    s_cbranch_scc0 L_fc
    s_endpgm
L_fok:
    v_max3_u32 v33, v28, v29, v30
    v_max_u32 v33, v33, v31
    v_xor_b32 v32, s98, v32
    v_xor_b32 v33, s98, v33
    v_or_b32 v32, v32, v33
    s_nop 0
    v_readfirstlane_b32 s98, v32
    s_cmp_eq_u32 s98, 0
    s_cselect_b32 s73, 0, 1024
    v_add_u32 v6, s73, v6
    s_add_u32 s73, s89, 0x400
    buffer_load_dwordx4 v[40:43], v6, s[36:39], s73 offen sc1
    v_mov_b32 v34, -1
    v_mov_b32 v35, -1
    s_lshl3_add_u32 s73, s99, s92
    s_mov_b64 exec, 0xffff
    s_cmp_eq_u32 s98, 0
    s_cbranch_scc0 L_st_fill0
    buffer_store_dwordx2 v[34:35], v5, s[36:39], s73 offen
L_str_fill0:
    s_mov_b64 exec, -1
    s_mov_b32 vcc_lo, s100
    s_mov_b32 vcc_hi, 0
    s_waitcnt vmcnt(9)
    s_cbranch_vccz L_pc_48
    s_waitcnt vmcnt(7)
L_pc_48:
    buffer_load_dwordx4 v1, s[32:35], s87 offen offset:2048 nt lds
    s_waitcnt vmcnt(9)
    s_cbranch_vccz L_pc_49
    s_waitcnt vmcnt(7)
L_pc_49:
    buffer_load_dwordx4 v1, s[32:35], s87 offen offset:3072 nt lds
    s_waitcnt vmcnt(9)
    s_cbranch_vccz L_pc_50
    s_waitcnt vmcnt(7)
L_pc_50:
    s_add_u32 s87, s44, 0x14000
    s_add_u32 m0, s88, 0x5000
    s_nop 0
    buffer_load_dwordx4 v1, s[32:35], s87 offen offset:0 nt lds
    s_waitcnt vmcnt(9)
    s_cbranch_vccz L_pc_51
    s_waitcnt vmcnt(7)
L_pc_51:
    buffer_load_dwordx4 v1, s[32:35], s87 offen offset:1024 nt lds
    s_waitcnt vmcnt(9)
    s_cbranch_vccz L_pc_52
    s_waitcnt vmcnt(7)
L_pc_52:
    buffer_load_dwordx4 v1, s[32:35], s87 offen offset:2048 nt lds
    s_waitcnt vmcnt(9)
    s_cbranch_vccz L_pc_53
    s_waitcnt vmcnt(7)
L_pc_53:
    buffer_load_dwordx4 v1, s[32:35], s87 offen offset:3072 nt lds
    s_waitcnt vmcnt(7)
L_qc_54:
    v_max3_u32 v28, v40, v41, v42
    v_max_u32 v28, v28, v43
    v_cmp_eq_u32 vcc, -1, v28
    s_nop 4
    s_cbranch_vccz L_qok_55
    s_add_u32 s73, s89, 0x400
    buffer_load_dwordx4 v[40:43], v6, s[36:39], s73 offen sc1
    s_waitcnt vmcnt(0)
    s_sub_u32 s72, s72, 1
    s_cbranch_scc0 L_qc_54
    s_endpgm
L_qok_55:
    s_mov_b32 vcc_lo, s100
    s_mov_b32 vcc_hi, 0
    s_mov_b32 s80, 0x000f000f
    s_mov_b32 s81, 0x000f000f
    v_cndmask_b32 v12, 0, v40, s[80:81]
    v_cndmask_b32 v13, 0, v41, s[80:81]
    v_cndmask_b32 v14, 0, v42, s[80:81]
    v_cndmask_b32 v15, 0, v43, s[80:81]
    s_mov_b32 s80, 0x00f000f0
    s_mov_b32 s81, 0x00f000f0
    v_cndmask_b32 v16, 0, v40, s[80:81]
    v_cndmask_b32 v17, 0, v41, s[80:81]
    v_cndmask_b32 v18, 0, v42, s[80:81]
    v_cndmask_b32 v19, 0, v43, s[80:81]
    s_mov_b32 s80, 0x0f000f00
    s_mov_b32 s81, 0x0f000f00
L_wa1:
    s_cbranch_execz L_wr0
    v_cndmask_b32 v20, 0, v40, s[80:81]
    v_cndmask_b32 v21, 0, v41, s[80:81]
    v_cndmask_b32 v22, 0, v42, s[80:81]
    v_cndmask_b32 v23, 0, v43, s[80:81]
    s_mov_b32 s80, 0xf000f000
    s_mov_b32 s81, 0xf000f000
    v_cndmask_b32 v24, 0, v40, s[80:81]
    v_cndmask_b32 v25, 0, v41, s[80:81]
    v_cndmask_b32 v26, 0, v42, s[80:81]
    v_cndmask_b32 v27, 0, v43, s[80:81]
    v_mfma_f32_16x16x32_bf16 v[28:31], a[0:3], v[12:15], 0
    v_mfma_f32_16x16x32_bf16 v[28:31], a[4:7], v[16:19], v[28:31]
    v_mfma_f32_16x16x32_bf16 v[28:31], a[8:11], v[20:23], v[28:31]
    v_mfma_f32_16x16x32_bf16 v[28:31], a[12:15], v[24:27], v[28:31]
    s_nop 7
    v_mul_f32_dpp v40, v28, v7 quad_perm:[0,0,0,0] row_mask:0xf bank_mask:0xf
    s_nop 1
    v_fmac_f32_dpp v40, v29, v7 quad_perm:[1,1,1,1] row_mask:0xf bank_mask:0xf
    s_nop 1
    v_fmac_f32_dpp v40, v30, v7 quad_perm:[2,2,2,2] row_mask:0xf bank_mask:0xf
    s_nop 1
    v_fmac_f32_dpp v40, v31, v7 quad_perm:[3,3,3,3] row_mask:0xf bank_mask:0xf
    s_cbranch_vccz L_pc_56
    s_waitcnt vmcnt(5)
L_pc_56:
    s_add_u32 s87, s86, 0x18000
    s_add_u32 m0, s88, 0x6000
    s_nop 0
    buffer_load_dwordx4 v1, s[32:35], s87 offen offset:0 nt lds
    v_mfma_f32_16x16x32_bf16 v[32:35], a[16:19], v[12:15], 0
    v_mfma_f32_16x16x32_bf16 v[32:35], a[20:23], v[16:19], v[32:35]
    v_mfma_f32_16x16x32_bf16 v[32:35], a[24:27], v[20:23], v[32:35]
    v_mfma_f32_16x16x32_bf16 v[32:35], a[28:31], v[24:27], v[32:35]
    s_nop 7
    v_fmac_f32_dpp v40, v32, v8 quad_perm:[0,0,0,0] row_mask:0xf bank_mask:0xf
    s_nop 1
    v_fmac_f32_dpp v40, v33, v8 quad_perm:[1,1,1,1] row_mask:0xf bank_mask:0xf
    s_nop 1
    v_fmac_f32_dpp v40, v34, v8 quad_perm:[2,2,2,2] row_mask:0xf bank_mask:0xf
    s_nop 1
    v_fmac_f32_dpp v40, v35, v8 quad_perm:[3,3,3,3] row_mask:0xf bank_mask:0xf
    v_mfma_f32_16x16x32_bf16 v[36:39], a[32:35], v[12:15], 0
    v_mfma_f32_16x16x32_bf16 v[36:39], a[36:39], v[16:19], v[36:39]
    v_mfma_f32_16x16x32_bf16 v[36:39], a[40:43], v[20:23], v[36:39]
    v_mfma_f32_16x16x32_bf16 v[36:39], a[44:47], v[24:27], v[36:39]
    s_nop 7
    v_fmac_f32_dpp v40, v36, v9 quad_perm:[0,0,0,0] row_mask:0xf bank_mask:0xf
    s_nop 1
    v_fmac_f32_dpp v40, v37, v9 quad_perm:[1,1,1,1] row_mask:0xf bank_mask:0xf
    s_nop 1
    v_fmac_f32_dpp v40, v38, v9 quad_perm:[2,2,2,2] row_mask:0xf bank_mask:0xf
    s_nop 1
    v_fmac_f32_dpp v40, v39, v9 quad_perm:[3,3,3,3] row_mask:0xf bank_mask:0xf
    s_cbranch_vccz L_pc_57
    s_waitcnt vmcnt(5)
L_pc_57:
    buffer_load_dwordx4 v1, s[32:35], s87 offen offset:1024 nt lds
    v_mfma_f32_16x16x32_bf16 v[28:31], a[48:51], v[12:15], 0
    v_mfma_f32_16x16x32_bf16 v[28:31], a[52:55], v[16:19], v[28:31]
    v_mfma_f32_16x16x32_bf16 v[28:31], a[56:59], v[20:23], v[28:31]
    v_mfma_f32_16x16x32_bf16 v[28:31], a[60:63], v[24:27], v[28:31]
    s_nop 7
    v_fmac_f32_dpp v40, v28, v10 quad_perm:[0,0,0,0] row_mask:0xf bank_mask:0xf
    s_nop 1
    v_fmac_f32_dpp v40, v29, v10 quad_perm:[1,1,1,1] row_mask:0xf bank_mask:0xf
    s_nop 1
    v_fmac_f32_dpp v40, v30, v10 quad_perm:[2,2,2,2] row_mask:0xf bank_mask:0xf
    s_nop 1
    v_fmac_f32_dpp v40, v31, v10 quad_perm:[3,3,3,3] row_mask:0xf bank_mask:0xf
    v_mfma_f32_16x16x32_bf16 v[32:35], a[64:67], v[12:15], 0
    v_mfma_f32_16x16x32_bf16 v[32:35], a[68:71], v[16:19], v[32:35]
    v_mfma_f32_16x16x32_bf16 v[32:35], a[72:75], v[20:23], v[32:35]
    v_mfma_f32_16x16x32_bf16 v[32:35], a[76:79], v[24:27], v[32:35]
    s_nop 7
    v_mul_f32_dpp v41, v32, v7 quad_perm:[0,0,0,0] row_mask:0xf bank_mask:0xf
    s_nop 1
    v_fmac_f32_dpp v41, v33, v7 quad_perm:[1,1,1,1] row_mask:0xf bank_mask:0xf
    s_nop 1
    v_fmac_f32_dpp v41, v34, v7 quad_perm:[2,2,2,2] row_mask:0xf bank_mask:0xf
    s_nop 1
    v_fmac_f32_dpp v41, v35, v7 quad_perm:[3,3,3,3] row_mask:0xf bank_mask:0xf
    s_waitcnt vmcnt(7)
    s_cbranch_vccz L_pc_58
    s_waitcnt vmcnt(5)
L_pc_58:
    buffer_load_dwordx4 v1, s[32:35], s87 offen offset:2048 nt lds
    v_mfma_f32_16x16x32_bf16 v[36:39], a[80:83], v[12:15], 0
    v_mfma_f32_16x16x32_bf16 v[36:39], a[84:87], v[16:19], v[36:39]
    v_mfma_f32_16x16x32_bf16 v[36:39], a[88:91], v[20:23], v[36:39]
    v_mfma_f32_16x16x32_bf16 v[36:39], a[92:95], v[24:27], v[36:39]
    s_nop 7
    v_fmac_f32_dpp v41, v36, v8 quad_perm:[0,0,0,0] row_mask:0xf bank_mask:0xf
    s_nop 1
    v_fmac_f32_dpp v41, v37, v8 quad_perm:[1,1,1,1] row_mask:0xf bank_mask:0xf
    s_nop 1
    v_fmac_f32_dpp v41, v38, v8 quad_perm:[2,2,2,2] row_mask:0xf bank_mask:0xf
    s_nop 1
    v_fmac_f32_dpp v41, v39, v8 quad_perm:[3,3,3,3] row_mask:0xf bank_mask:0xf
    v_mfma_f32_16x16x32_bf16 v[28:31], a[96:99], v[12:15], 0
    v_mfma_f32_16x16x32_bf16 v[28:31], a[100:103], v[16:19], v[28:31]
    v_mfma_f32_16x16x32_bf16 v[28:31], a[104:107], v[20:23], v[28:31]
    v_mfma_f32_16x16x32_bf16 v[28:31], a[108:111], v[24:27], v[28:31]
    s_nop 7
    v_fmac_f32_dpp v41, v28, v9 quad_perm:[0,0,0,0] row_mask:0xf bank_mask:0xf
    s_nop 1
    v_fmac_f32_dpp v41, v29, v9 quad_perm:[1,1,1,1] row_mask:0xf bank_mask:0xf
    s_nop 1
    v_fmac_f32_dpp v41, v30, v9 quad_perm:[2,2,2,2] row_mask:0xf bank_mask:0xf
    s_nop 1
    v_fmac_f32_dpp v41, v31, v9 quad_perm:[3,3,3,3] row_mask:0xf bank_mask:0xf
    s_waitcnt vmcnt(7)
    s_cbranch_vccz L_pc_59
    s_waitcnt vmcnt(5)
L_pc_59:
    buffer_load_dwordx4 v1, s[32:35], s87 offen offset:3072 nt lds
    v_mfma_f32_16x16x32_bf16 v[32:35], a[112:115], v[12:15], 0
    v_mfma_f32_16x16x32_bf16 v[32:35], a[116:119], v[16:19], v[32:35]
    v_mfma_f32_16x16x32_bf16 v[32:35], a[120:123], v[20:23], v[32:35]
    v_mfma_f32_16x16x32_bf16 v[32:35], a[124:127], v[24:27], v[32:35]
    s_nop 7
    v_fmac_f32_dpp v41, v32, v10 quad_perm:[0,0,0,0] row_mask:0xf bank_mask:0xf
    s_nop 1
    v_fmac_f32_dpp v41, v33, v10 quad_perm:[1,1,1,1] row_mask:0xf bank_mask:0xf
    s_nop 1
    v_fmac_f32_dpp v41, v34, v10 quad_perm:[2,2,2,2] row_mask:0xf bank_mask:0xf
    s_nop 1
    v_fmac_f32_dpp v41, v35, v10 quad_perm:[3,3,3,3] row_mask:0xf bank_mask:0xf
    v_mfma_f32_16x16x32_bf16 v[36:39], a[128:131], v[12:15], 0
    v_mfma_f32_16x16x32_bf16 v[36:39], a[132:135], v[16:19], v[36:39]
    v_mfma_f32_16x16x32_bf16 v[36:39], a[136:139], v[20:23], v[36:39]
    v_mfma_f32_16x16x32_bf16 v[36:39], a[140:143], v[24:27], v[36:39]
L_wa2:
    s_cbranch_execz L_wr0
    s_nop 6
    v_mul_f32_dpp v42, v36, v7 quad_perm:[0,0,0,0] row_mask:0xf bank_mask:0xf
    s_nop 1
    v_fmac_f32_dpp v42, v37, v7 quad_perm:[1,1,1,1] row_mask:0xf bank_mask:0xf
    s_nop 1
    v_fmac_f32_dpp v42, v38, v7 quad_perm:[2,2,2,2] row_mask:0xf bank_mask:0xf
    s_nop 1
    v_fmac_f32_dpp v42, v39, v7 quad_perm:[3,3,3,3] row_mask:0xf bank_mask:0xf
    s_waitcnt vmcnt(7)
    s_cbranch_vccz L_pc_60
    s_waitcnt vmcnt(5)
L_pc_60:
    s_add_u32 s87, s44, 0x1c000
    s_add_u32 m0, s88, 0x7000
    s_nop 0
    buffer_load_dwordx4 v1, s[32:35], s87 offen offset:0 nt lds
    v_mfma_f32_16x16x32_bf16 v[28:31], a[144:147], v[12:15], 0
    v_mfma_f32_16x16x32_bf16 v[28:31], a[148:151], v[16:19], v[28:31]
    v_mfma_f32_16x16x32_bf16 v[28:31], a[152:155], v[20:23], v[28:31]
    v_mfma_f32_16x16x32_bf16 v[28:31], a[156:159], v[24:27], v[28:31]
    s_nop 7
    v_fmac_f32_dpp v42, v28, v8 quad_perm:[0,0,0,0] row_mask:0xf bank_mask:0xf
    s_nop 1
    v_fmac_f32_dpp v42, v29, v8 quad_perm:[1,1,1,1] row_mask:0xf bank_mask:0xf
    s_nop 1
    v_fmac_f32_dpp v42, v30, v8 quad_perm:[2,2,2,2] row_mask:0xf bank_mask:0xf
    s_nop 1
    v_fmac_f32_dpp v42, v31, v8 quad_perm:[3,3,3,3] row_mask:0xf bank_mask:0xf
    v_mfma_f32_16x16x32_bf16 v[32:35], a[160:163], v[12:15], 0
    v_mfma_f32_16x16x32_bf16 v[32:35], a[164:167], v[16:19], v[32:35]
    v_mfma_f32_16x16x32_bf16 v[32:35], a[168:171], v[20:23], v[32:35]
    v_mfma_f32_16x16x32_bf16 v[32:35], a[172:175], v[24:27], v[32:35]
    s_nop 7
    v_fmac_f32_dpp v42, v32, v9 quad_perm:[0,0,0,0] row_mask:0xf bank_mask:0xf
    s_nop 1
    v_fmac_f32_dpp v42, v33, v9 quad_perm:[1,1,1,1] row_mask:0xf bank_mask:0xf
    s_nop 1
    v_fmac_f32_dpp v42, v34, v9 quad_perm:[2,2,2,2] row_mask:0xf bank_mask:0xf
    s_nop 1
    v_fmac_f32_dpp v42, v35, v9 quad_perm:[3,3,3,3] row_mask:0xf bank_mask:0xf
    s_waitcnt vmcnt(7)
    s_cbranch_vccz L_pc_61
    s_waitcnt vmcnt(5)
L_pc_61:
    buffer_load_dwordx4 v1, s[32:35], s87 offen offset:1024 nt lds
    v_mfma_f32_16x16x32_bf16 v[36:39], a[176:179], v[12:15], 0
    v_mfma_f32_16x16x32_bf16 v[36:39], a[180:183], v[16:19], v[36:39]
    v_mfma_f32_16x16x32_bf16 v[36:39], a[184:187], v[20:23], v[36:39]
    v_mfma_f32_16x16x32_bf16 v[36:39], a[188:191], v[24:27], v[36:39]
    s_nop 7
    v_fmac_f32_dpp v42, v36, v10 quad_perm:[0,0,0,0] row_mask:0xf bank_mask:0xf
    s_nop 1
    v_fmac_f32_dpp v42, v37, v10 quad_perm:[1,1,1,1] row_mask:0xf bank_mask:0xf
    s_nop 1
    v_fmac_f32_dpp v42, v38, v10 quad_perm:[2,2,2,2] row_mask:0xf bank_mask:0xf
    s_nop 1
    v_fmac_f32_dpp v42, v39, v10 quad_perm:[3,3,3,3] row_mask:0xf bank_mask:0xf
    v_mfma_f32_16x16x32_bf16 v[28:31], v[84:87], v[12:15], 0
    v_mfma_f32_16x16x32_bf16 v[28:31], v[88:91], v[16:19], v[28:31]
    v_mfma_f32_16x16x32_bf16 v[28:31], v[92:95], v[20:23], v[28:31]
    v_mfma_f32_16x16x32_bf16 v[28:31], v[96:99], v[24:27], v[28:31]
    s_nop 7
    v_mul_f32_dpp v43, v28, v7 quad_perm:[0,0,0,0] row_mask:0xf bank_mask:0xf
    s_nop 1
    v_fmac_f32_dpp v43, v29, v7 quad_perm:[1,1,1,1] row_mask:0xf bank_mask:0xf
    s_nop 1
    v_fmac_f32_dpp v43, v30, v7 quad_perm:[2,2,2,2] row_mask:0xf bank_mask:0xf
    s_nop 1
    v_fmac_f32_dpp v43, v31, v7 quad_perm:[3,3,3,3] row_mask:0xf bank_mask:0xf
    s_waitcnt vmcnt(7)
    s_cbranch_vccz L_pc_62
    s_waitcnt vmcnt(5)
L_pc_62:
    buffer_load_dwordx4 v1, s[32:35], s87 offen offset:2048 nt lds
    v_mfma_f32_16x16x32_bf16 v[32:35], v[100:103], v[12:15], 0
    v_mfma_f32_16x16x32_bf16 v[32:35], v[104:107], v[16:19], v[32:35]
    v_mfma_f32_16x16x32_bf16 v[32:35], v[108:111], v[20:23], v[32:35]
    v_mfma_f32_16x16x32_bf16 v[32:35], v[112:115], v[24:27], v[32:35]
    s_nop 7
    v_fmac_f32_dpp v43, v32, v8 quad_perm:[0,0,0,0] row_mask:0xf bank_mask:0xf
    s_nop 1
    v_fmac_f32_dpp v43, v33, v8 quad_perm:[1,1,1,1] row_mask:0xf bank_mask:0xf
    s_nop 1
    v_fmac_f32_dpp v43, v34, v8 quad_perm:[2,2,2,2] row_mask:0xf bank_mask:0xf
    s_nop 1
    v_fmac_f32_dpp v43, v35, v8 quad_perm:[3,3,3,3] row_mask:0xf bank_mask:0xf
    v_mfma_f32_16x16x32_bf16 v[36:39], a[192:195], v[12:15], 0
    v_mfma_f32_16x16x32_bf16 v[36:39], a[196:199], v[16:19], v[36:39]
    v_mfma_f32_16x16x32_bf16 v[36:39], a[200:203], v[20:23], v[36:39]
    v_mfma_f32_16x16x32_bf16 v[36:39], a[204:207], v[24:27], v[36:39]
    s_nop 7
    v_fmac_f32_dpp v43, v36, v9 quad_perm:[0,0,0,0] row_mask:0xf bank_mask:0xf
    s_nop 1
    v_fmac_f32_dpp v43, v37, v9 quad_perm:[1,1,1,1] row_mask:0xf bank_mask:0xf
    s_nop 1
    v_fmac_f32_dpp v43, v38, v9 quad_perm:[2,2,2,2] row_mask:0xf bank_mask:0xf
    s_nop 1
    v_fmac_f32_dpp v43, v39, v9 quad_perm:[3,3,3,3] row_mask:0xf bank_mask:0xf
    s_waitcnt vmcnt(7)
    s_cbranch_vccz L_pc_63
    s_waitcnt vmcnt(5)
L_pc_63:
    buffer_load_dwordx4 v1, s[32:35], s87 offen offset:3072 nt lds
    v_mfma_f32_16x16x32_bf16 v[28:31], a[208:211], v[12:15], 0
    v_mfma_f32_16x16x32_bf16 v[28:31], a[212:215], v[16:19], v[28:31]
    v_mfma_f32_16x16x32_bf16 v[28:31], a[216:219], v[20:23], v[28:31]
    v_mfma_f32_16x16x32_bf16 v[28:31], a[220:223], v[24:27], v[28:31]
    s_nop 7
    v_fmac_f32_dpp v43, v28, v10 quad_perm:[0,0,0,0] row_mask:0xf bank_mask:0xf
    s_nop 1
    v_fmac_f32_dpp v43, v29, v10 quad_perm:[1,1,1,1] row_mask:0xf bank_mask:0xf
    s_nop 1
    v_fmac_f32_dpp v43, v30, v10 quad_perm:[2,2,2,2] row_mask:0xf bank_mask:0xf
    s_nop 1
    v_fmac_f32_dpp v43, v31, v10 quad_perm:[3,3,3,3] row_mask:0xf bank_mask:0xf
    v_mfma_f32_16x16x32_bf16 v[32:35], a[224:227], v[12:15], 0
    v_mfma_f32_16x16x32_bf16 v[32:35], a[228:231], v[16:19], v[32:35]
    v_mfma_f32_16x16x32_bf16 v[32:35], a[232:235], v[20:23], v[32:35]
    v_mfma_f32_16x16x32_bf16 v[32:35], a[236:239], v[24:27], v[32:35]
    s_nop 7
    v_mul_f32_dpp v2, v32, v7 quad_perm:[0,0,0,0] row_mask:0xf bank_mask:0xf
    s_nop 1
    v_fmac_f32_dpp v2, v33, v7 quad_perm:[1,1,1,1] row_mask:0xf bank_mask:0xf
    s_nop 1
    v_fmac_f32_dpp v2, v34, v7 quad_perm:[2,2,2,2] row_mask:0xf bank_mask:0xf
    s_nop 1
    v_fmac_f32_dpp v2, v35, v7 quad_perm:[3,3,3,3] row_mask:0xf bank_mask:0xf
    s_cmp_eq_u32 s3, 1
    s_cbranch_scc0 L_nv_64
    s_mov_b64 exec, 2
    buffer_store_byte v5, off, s[36:39], s101 offset:2
    s_mov_b32 exec_lo, -1
L_nv_64:
    s_mov_b32 exec_hi, 0
    buffer_load_ubyte v51, v5, s[36:39], s96 offen offset:2 sc1
    s_mov_b32 exec_hi, -1
    s_waitcnt vmcnt(8)
    s_cbranch_vccz L_pc_65
    s_waitcnt vmcnt(6)
L_pc_65:
    s_add_u32 s87, s86, 0x20000
    s_add_u32 m0, s88, 0x8000
    s_nop 0
    buffer_load_dwordx4 v1, s[32:35], s87 offen offset:0 nt lds
    v_mfma_f32_16x16x32_bf16 v[36:39], a[240:243], v[12:15], 0
    v_mfma_f32_16x16x32_bf16 v[36:39], a[244:247], v[16:19], v[36:39]
    v_mfma_f32_16x16x32_bf16 v[36:39], a[248:251], v[20:23], v[36:39]
    v_mfma_f32_16x16x32_bf16 v[36:39], a[252:255], v[24:27], v[36:39]
    s_nop 7
    v_fmac_f32_dpp v2, v36, v8 quad_perm:[0,0,0,0] row_mask:0xf bank_mask:0xf
    s_nop 1
    v_fmac_f32_dpp v2, v37, v8 quad_perm:[1,1,1,1] row_mask:0xf bank_mask:0xf
    s_nop 1
    v_fmac_f32_dpp v2, v38, v8 quad_perm:[2,2,2,2] row_mask:0xf bank_mask:0xf
    s_nop 1
    v_fmac_f32_dpp v2, v39, v8 quad_perm:[3,3,3,3] row_mask:0xf bank_mask:0xf
    v_mfma_f32_16x16x32_bf16 v[28:31], v[116:119], v[12:15], 0
    s_nop 7
    v_fmac_f32_dpp v2, v28, v9 quad_perm:[0,0,0,0] row_mask:0xf bank_mask:0xf
    s_nop 1
    v_fmac_f32_dpp v2, v29, v9 quad_perm:[1,1,1,1] row_mask:0xf bank_mask:0xf
    s_nop 1
    v_fmac_f32_dpp v2, v30, v9 quad_perm:[2,2,2,2] row_mask:0xf bank_mask:0xf
    s_nop 1
    v_fmac_f32_dpp v2, v31, v9 quad_perm:[3,3,3,3] row_mask:0xf bank_mask:0xf
    s_waitcnt vmcnt(8)
    s_cbranch_vccz L_pc_66
    s_waitcnt vmcnt(6)
L_pc_66:
    buffer_load_dwordx4 v1, s[32:35], s87 offen offset:1024 nt lds
    s_add_u32 s90, s92, 0x0
    s_add_u32 s91, s93, 0x0
    v_mov_b32 v0, 0xff800000
    v_cndmask_b32 v2, v0, v2, s[78:79]
    v_max3_f32 v26, v40, v41, v42
    v_max3_f32 v26, v26, v43, v2
    v_mov_b32 v28, 0
L_wa3:
    s_cbranch_execz L_wr0
    v_mov_b32 v29, 0
    v_max_f32_dpp v26, v26, v26 quad_perm:[1,0,3,2] row_mask:0xf bank_mask:0xf
    v_mov_b32 v30, 0
    v_mov_b32 v31, 0
    v_max_f32_dpp v26, v26, v26 quad_perm:[2,3,0,1] row_mask:0xf bank_mask:0xf
    v_mov_b32 v32, 0
    v_mov_b32 v33, 0
    v_max_f32_dpp v26, v26, v26 row_ror:4 row_mask:0xf bank_mask:0xf
    v_mov_b32 v34, 0
    v_mov_b32 v35, 0
    v_max_f32_dpp v26, v26, v26 row_ror:8 row_mask:0xf bank_mask:0xf
    v_mov_b32 v0, v26
    v_mov_b32 v36, 0
    v_mov_b32 v37, 0
    v_permlane16_swap_b32 v26, v0
    v_max_f32 v26, v26, v0
    v_mov_b32 v0, v26
    v_mov_b32 v38, 0
    v_mov_b32 v39, 0
    v_permlane32_swap_b32 v26, v0
    v_max_f32 v26, v26, v0
    v_sub_f32 v40, v40, v26
    v_sub_f32 v41, v41, v26
    v_sub_f32 v42, v42, v26
    v_sub_f32 v43, v43, v26
    v_sub_f32 v2, v2, v26
    v_exp_f32 v40, v40
    v_exp_f32 v41, v41
    v_exp_f32 v42, v42
    v_exp_f32 v43, v43
    v_exp_f32 v2, v2
    v_cvt_pk_bf16_f32 v40, 0, v40
    v_cvt_pk_bf16_f32 v41, 0, v41
    v_cvt_pk_bf16_f32 v42, 0, v42
    v_cvt_pk_bf16_f32 v43, 0, v43
    v_cvt_pk_bf16_f32 v2, 0, v2
    v_add_f32 v27, v40, v41
    v_add_f32 v0, v42, v43
    v_add_f32 v27, v27, v2
    v_add_f32 v27, v27, v0
    v_mov_b32 v12, 0
    v_mov_b32 v13, 0
    v_add_f32_dpp v27, v27, v27 quad_perm:[1,0,3,2] row_mask:0xf bank_mask:0xf
    v_mov_b32 v14, 0
    v_mov_b32 v15, 0
    v_add_f32_dpp v27, v27, v27 quad_perm:[2,3,0,1] row_mask:0xf bank_mask:0xf
    v_mov_b32 v16, 0
    v_mov_b32 v17, 0
    v_add_f32_dpp v27, v27, v27 row_ror:4 row_mask:0xf bank_mask:0xf
    v_mov_b32 v18, 0
    v_mov_b32 v19, 0
    v_add_f32_dpp v27, v27, v27 row_ror:8 row_mask:0xf bank_mask:0xf
    v_mov_b32 v0, v27
    v_bfe_u32 v25, v1, 4, 2
    v_mul_u32_u24 v25, 0x4444, v25
    v_permlane16_swap_b32 v27, v0
    v_add_f32 v27, v27, v0
    v_mov_b32 v0, v27
    v_mov_b32_dpp v20, v40 row_half_mirror row_mask:0xf bank_mask:0xf
    v_mov_b32_dpp v21, v41 row_half_mirror row_mask:0xf bank_mask:0xf
    v_permlane32_swap_b32 v27, v0
    v_add_f32 v27, v27, v0
    v_min_u32 v26, -2, v26
    v_min_u32 v27, -2, v27
    v_mov_b32 v0, s99
    s_mov_b64 exec, 1
    s_cmp_eq_u32 s98, 0
    s_cbranch_scc0 L_st_s0
    buffer_store_dwordx2 v[26:27], off, s[36:39], s91
L_str_s0:
    ds_write_b32 v0, v26 offset:2048
    s_mov_b64 exec, -1
    v_mov_b32_dpp v22, v42 row_half_mirror row_mask:0xf bank_mask:0xf
    v_mov_b32_dpp v23, v43 row_half_mirror row_mask:0xf bank_mask:0xf
    v_mov_b32_dpp v24, v2 row_half_mirror row_mask:0xf bank_mask:0xf
    v_mov_b32_dpp v28, v40 quad_perm:[0,0,0,0] row_mask:0xf bank_mask:0x5
    v_mov_b32_dpp v29, v20 quad_perm:[3,3,3,3] row_mask:0xf bank_mask:0xa
    v_mov_b32_dpp v30, v20 quad_perm:[3,3,3,3] row_mask:0xf bank_mask:0x5
    v_mov_b32_dpp v31, v40 quad_perm:[0,0,0,0] row_mask:0xf bank_mask:0xa
    v_mov_b32_dpp v32, v40 quad_perm:[1,1,1,1] row_mask:0xf bank_mask:0x5
    v_mov_b32_dpp v33, v20 quad_perm:[2,2,2,2] row_mask:0xf bank_mask:0xa
    v_mov_b32_dpp v34, v20 quad_perm:[2,2,2,2] row_mask:0xf bank_mask:0x5
    v_mov_b32_dpp v35, v40 quad_perm:[1,1,1,1] row_mask:0xf bank_mask:0xa
    s_waitcnt vmcnt(9)
    s_cbranch_vccz L_pc_67
    s_waitcnt vmcnt(7)
L_pc_67:
    buffer_load_dwordx4 v1, s[32:35], s87 offen offset:2048 nt lds
    ds_read_b128 v[52:55], v11 offset:0
    ds_read_b128 v[56:59], v11 offset:1024
    v_mov_b32_dpp v36, v40 quad_perm:[2,2,2,2] row_mask:0xf bank_mask:0x5
    v_mov_b32_dpp v37, v20 quad_perm:[1,1,1,1] row_mask:0xf bank_mask:0xa
    s_waitcnt lgkmcnt(0)
    v_smfmac_f32_16x16x64_bf16 v[12:15], v[28:31], v[52:59], v25
    ds_read_b128 v[60:63], v11 offset:2048
    ds_read_b128 v[64:67], v11 offset:3072
    v_mov_b32_dpp v38, v20 quad_perm:[1,1,1,1] row_mask:0xf bank_mask:0x5
    v_mov_b32_dpp v39, v40 quad_perm:[2,2,2,2] row_mask:0xf bank_mask:0xa
    s_waitcnt lgkmcnt(0)
    v_smfmac_f32_16x16x64_bf16 v[16:19], v[28:31], v[60:67], v25
    s_waitcnt vmcnt(9)
    s_cbranch_vccz L_pc_68
    s_waitcnt vmcnt(7)
L_pc_68:
    buffer_load_dwordx4 v1, s[32:35], s87 offen offset:3072 nt lds
    ds_read_b128 v[52:55], v11 offset:4096
    ds_read_b128 v[56:59], v11 offset:5120
    v_mov_b32_dpp v28, v40 quad_perm:[3,3,3,3] row_mask:0xf bank_mask:0x5
    v_mov_b32_dpp v29, v20 quad_perm:[0,0,0,0] row_mask:0xf bank_mask:0xa
    s_waitcnt lgkmcnt(0)
    v_smfmac_f32_16x16x64_bf16 v[12:15], v[32:35], v[52:59], v25
    ds_read_b128 v[60:63], v11 offset:6144
    ds_read_b128 v[64:67], v11 offset:7168
    v_mov_b32_dpp v30, v20 quad_perm:[0,0,0,0] row_mask:0xf bank_mask:0x5
    v_mov_b32_dpp v31, v40 quad_perm:[3,3,3,3] row_mask:0xf bank_mask:0xa
    s_waitcnt lgkmcnt(0)
    v_smfmac_f32_16x16x64_bf16 v[16:19], v[32:35], v[60:67], v25
    s_waitcnt vmcnt(9)
    s_cbranch_vccz L_pc_69
    s_waitcnt vmcnt(7)
L_pc_69:
    s_add_u32 s87, s44, 0x24000
    s_add_u32 m0, s88, 0x9000
    s_nop 0
    buffer_load_dwordx4 v1, s[32:35], s87 offen offset:0 nt lds
    v_and_b32 v27, 0x30, v1
    s_barrier
    ds_read_b32 v27, v27 offset:2048
    ds_read_b128 v[52:55], v11 offset:8192
    ds_read_b128 v[56:59], v11 offset:9216
    v_mov_b32_dpp v32, v41 quad_perm:[0,0,0,0] row_mask:0xf bank_mask:0x5
    v_mov_b32_dpp v33, v21 quad_perm:[3,3,3,3] row_mask:0xf bank_mask:0xa
    s_waitcnt lgkmcnt(0)
    v_smfmac_f32_16x16x64_bf16 v[12:15], v[36:39], v[52:59], v25
    ds_read_b128 v[60:63], v11 offset:10240
    ds_read_b128 v[64:67], v11 offset:11264
    v_mov_b32_dpp v34, v21 quad_perm:[3,3,3,3] row_mask:0xf bank_mask:0x5
    v_mov_b32_dpp v35, v41 quad_perm:[0,0,0,0] row_mask:0xf bank_mask:0xa
    s_waitcnt lgkmcnt(0)
    v_smfmac_f32_16x16x64_bf16 v[16:19], v[36:39], v[60:67], v25
    s_waitcnt vmcnt(9)
    s_cbranch_vccz L_pc_70
    s_waitcnt vmcnt(7)
L_pc_70:
    buffer_load_dwordx4 v1, s[32:35], s87 offen offset:1024 nt lds
    v_max_f32_dpp v27, v27, v27 quad_perm:[1,0,3,2] row_mask:0xf bank_mask:0xf
    s_nop 1
    v_max_f32_dpp v27, v27, v27 quad_perm:[2,3,0,1] row_mask:0xf bank_mask:0xf
    v_sub_f32 v27, v26, v27
    v_exp_f32 v27, v27
    ds_read_b128 v[52:55], v11 offset:12288
    ds_read_b128 v[56:59], v11 offset:13312
    v_mov_b32_dpp v36, v41 quad_perm:[1,1,1,1] row_mask:0xf bank_mask:0x5
    v_mov_b32_dpp v37, v21 quad_perm:[2,2,2,2] row_mask:0xf bank_mask:0xa
    s_waitcnt lgkmcnt(0)
    v_smfmac_f32_16x16x64_bf16 v[12:15], v[28:31], v[52:59], v25
    ds_read_b128 v[60:63], v11 offset:14336
    ds_read_b128 v[64:67], v11 offset:15360
    v_mov_b32_dpp v38, v21 quad_perm:[2,2,2,2] row_mask:0xf bank_mask:0x5
    v_mov_b32_dpp v39, v41 quad_perm:[1,1,1,1] row_mask:0xf bank_mask:0xa
    s_waitcnt lgkmcnt(0)
    v_smfmac_f32_16x16x64_bf16 v[16:19], v[28:31], v[60:67], v25
    s_waitcnt vmcnt(7)
    v_cmp_ne_u32 vcc, 0, v51
    s_nop 0
    s_and_b32 vcc_lo, vcc_lo, 0x0fffffff
    s_bcnt1_i32_b32 s100, vcc_lo
    s_cmp_lt_u32 s100, 18
    s_cselect_b32 s100, -1, 0
    s_mov_b32 vcc_lo, s100
    s_mov_b32 vcc_hi, 0
    s_cbranch_vccz L_pc_71
    s_waitcnt vmcnt(6)
L_pc_71:
    s_add_u32 s87, s95, 0x0
    s_add_u32 m0, s88, 0x9800
    v_and_b32 v0, 0x300, v1
    v_add_u32 v0, v0, v1
    buffer_load_dwordx4 v0, s[32:35], s87 offen offset:0 nt lds
    ds_read_b128 v[52:55], v11 offset:16384
    ds_read_b128 v[56:59], v11 offset:17408
    v_mov_b32_dpp v28, v41 quad_perm:[2,2,2,2] row_mask:0xf bank_mask:0x5
    v_mov_b32_dpp v29, v21 quad_perm:[1,1,1,1] row_mask:0xf bank_mask:0xa
    s_waitcnt lgkmcnt(0)
    v_smfmac_f32_16x16x64_bf16 v[12:15], v[32:35], v[52:59], v25
    ds_read_b128 v[60:63], v11 offset:18432
    ds_read_b128 v[64:67], v11 offset:19456
    v_mov_b32_dpp v30, v21 quad_perm:[1,1,1,1] row_mask:0xf bank_mask:0x5
    v_mov_b32_dpp v31, v41 quad_perm:[2,2,2,2] row_mask:0xf bank_mask:0xa
L_wa4:
    s_cbranch_execz L_wr1
    s_waitcnt lgkmcnt(0)
    v_smfmac_f32_16x16x64_bf16 v[16:19], v[32:35], v[60:67], v25
    s_cbranch_vccz L_pc_72
    s_waitcnt vmcnt(6)
L_pc_72:
    s_add_u32 s87, s44, 0x24000
    buffer_load_dwordx4 v[120:123], v1, s[32:35], s87 offen offset:2048 nt
    ds_read_b128 v[52:55], v11 offset:20480
    ds_read_b128 v[56:59], v11 offset:21504
    v_mov_b32_dpp v32, v41 quad_perm:[3,3,3,3] row_mask:0xf bank_mask:0x5
    v_mov_b32_dpp v33, v21 quad_perm:[0,0,0,0] row_mask:0xf bank_mask:0xa
    s_waitcnt lgkmcnt(0)
    v_smfmac_f32_16x16x64_bf16 v[12:15], v[36:39], v[52:59], v25
    ds_read_b128 v[60:63], v11 offset:22528
    ds_read_b128 v[64:67], v11 offset:23552
    v_mov_b32_dpp v34, v21 quad_perm:[0,0,0,0] row_mask:0xf bank_mask:0x5
    v_mov_b32_dpp v35, v41 quad_perm:[3,3,3,3] row_mask:0xf bank_mask:0xa
    s_waitcnt lgkmcnt(0)
    v_smfmac_f32_16x16x64_bf16 v[16:19], v[36:39], v[60:67], v25
    s_waitcnt vmcnt(8)
    s_cbranch_vccz L_pc_73
    s_waitcnt vmcnt(5)
L_pc_73:
    buffer_load_dwordx4 v[124:127], v1, s[32:35], s87 offen offset:3072 nt
    ds_read_b128 v[52:55], v11 offset:24576
    ds_read_b128 v[56:59], v11 offset:25600
    v_mov_b32_dpp v36, v42 quad_perm:[0,0,0,0] row_mask:0xf bank_mask:0x5
    v_mov_b32_dpp v37, v22 quad_perm:[3,3,3,3] row_mask:0xf bank_mask:0xa
    s_waitcnt lgkmcnt(0)
    v_smfmac_f32_16x16x64_bf16 v[12:15], v[28:31], v[52:59], v25
    ds_read_b128 v[60:63], v11 offset:26624
    ds_read_b128 v[64:67], v11 offset:27648
    v_mov_b32_dpp v38, v22 quad_perm:[3,3,3,3] row_mask:0xf bank_mask:0x5
    v_mov_b32_dpp v39, v42 quad_perm:[0,0,0,0] row_mask:0xf bank_mask:0xa
    s_waitcnt lgkmcnt(0)
    v_smfmac_f32_16x16x64_bf16 v[16:19], v[28:31], v[60:67], v25
    s_waitcnt vmcnt(8)
    s_cbranch_vccz L_pc_74
    s_waitcnt vmcnt(5)
L_pc_74:
    s_add_u32 s87, s86, 0x28000
    buffer_load_dwordx4 v[128:131], v1, s[32:35], s87 offen offset:0 nt
    ds_read_b128 v[52:55], v11 offset:28672
    ds_read_b128 v[56:59], v11 offset:29696
    v_mov_b32_dpp v28, v42 quad_perm:[1,1,1,1] row_mask:0xf bank_mask:0x5
    v_mov_b32_dpp v29, v22 quad_perm:[2,2,2,2] row_mask:0xf bank_mask:0xa
    s_waitcnt lgkmcnt(0)
    v_smfmac_f32_16x16x64_bf16 v[12:15], v[32:35], v[52:59], v25
    ds_read_b128 v[60:63], v11 offset:30720
    ds_read_b128 v[64:67], v11 offset:31744
    v_mov_b32_dpp v30, v22 quad_perm:[2,2,2,2] row_mask:0xf bank_mask:0x5
    v_mov_b32_dpp v31, v42 quad_perm:[1,1,1,1] row_mask:0xf bank_mask:0xa
    s_waitcnt lgkmcnt(0)
    v_smfmac_f32_16x16x64_bf16 v[16:19], v[32:35], v[60:67], v25
    s_waitcnt vmcnt(7)
    s_cbranch_vccz L_pc_75
    s_waitcnt vmcnt(5)
L_pc_75:
    buffer_load_dwordx4 v[132:135], v1, s[32:35], s87 offen offset:1024 nt
    ds_read_b128 v[52:55], v11 offset:32768
    ds_read_b128 v[56:59], v11 offset:33792
    v_mov_b32_dpp v32, v42 quad_perm:[2,2,2,2] row_mask:0xf bank_mask:0x5
    v_mov_b32_dpp v33, v22 quad_perm:[1,1,1,1] row_mask:0xf bank_mask:0xa
    s_waitcnt lgkmcnt(0)
    v_smfmac_f32_16x16x64_bf16 v[12:15], v[36:39], v[52:59], v25
    s_waitcnt vmcnt(7)
    s_cbranch_vccz L_pc_76
    s_waitcnt vmcnt(5)
L_pc_76:
    buffer_load_dwordx4 v[136:139], v1, s[32:35], s87 offen offset:2048 nt
    ds_read_b128 v[60:63], v11 offset:34816
    ds_read_b128 v[64:67], v11 offset:35840
    v_mov_b32_dpp v34, v22 quad_perm:[1,1,1,1] row_mask:0xf bank_mask:0x5
    v_mov_b32_dpp v35, v42 quad_perm:[2,2,2,2] row_mask:0xf bank_mask:0xa
    s_waitcnt lgkmcnt(0)
    v_smfmac_f32_16x16x64_bf16 v[16:19], v[36:39], v[60:67], v25
    s_waitcnt vmcnt(7)
    s_cbranch_vccz L_pc_77
    s_waitcnt vmcnt(5)
L_pc_77:
    buffer_load_dwordx4 v[140:143], v1, s[32:35], s87 offen offset:3072 nt
    s_waitcnt vmcnt(7)
    s_cbranch_vccz L_pc_78
    s_waitcnt vmcnt(5)
L_pc_78:
    s_add_u32 s87, s44, 0x2c000
    buffer_load_dwordx4 v[144:147], v1, s[32:35], s87 offen offset:0 nt
    ds_read_b128 v[52:55], v11 offset:36864
    ds_read_b128 v[56:59], v11 offset:37888
    v_mov_b32_dpp v36, v42 quad_perm:[3,3,3,3] row_mask:0xf bank_mask:0x5
    v_mov_b32_dpp v37, v22 quad_perm:[0,0,0,0] row_mask:0xf bank_mask:0xa
    s_waitcnt lgkmcnt(0)
    v_smfmac_f32_16x16x64_bf16 v[12:15], v[28:31], v[52:59], v25
    s_waitcnt vmcnt(7)
    s_cbranch_vccz L_pc_79
    s_waitcnt vmcnt(5)
L_pc_79:
    buffer_load_dwordx4 v[148:151], v1, s[32:35], s87 offen offset:1024 nt
    ds_read_b128 v[60:63], v11 offset:38912
    v_lshrrev_b32 v0, 16, v2
    v_or_b32 v0, v0, v2
    s_nop 1
    v_and_b32_dpp v64, v0, v44 row_newbcast:2 row_mask:0xf bank_mask:0xf
    v_and_b32_dpp v65, v0, v45 row_newbcast:2 row_mask:0xf bank_mask:0xf
    v_and_b32_dpp v66, v0, v46 row_newbcast:2 row_mask:0xf bank_mask:0xf
    v_and_b32_dpp v67, v0, v47 row_newbcast:2 row_mask:0xf bank_mask:0xf
    s_waitcnt lgkmcnt(0)
    s_nop 0
    v_mfma_f32_16x16x32_bf16 v[12:15], v[64:67], v[60:63], v[12:15]
    s_waitcnt vmcnt(7)
    s_cbranch_vccz L_pc_80
    s_waitcnt vmcnt(5)
L_pc_80:
    buffer_load_dwordx4 v[152:155], v1, s[32:35], s87 offen offset:2048 nt
    s_waitcnt vmcnt(7)
    s_cbranch_vccz L_pc_81
    s_waitcnt vmcnt(5)
L_pc_81:
    buffer_load_dwordx4 v[156:159], v1, s[32:35], s87 offen offset:3072 nt
    v_smfmac_f32_16x16x64_bf16 v[16:19], v[28:31], v[120:127], v25
    v_mov_b32_dpp v38, v22 quad_perm:[0,0,0,0] row_mask:0xf bank_mask:0x5
    v_mov_b32_dpp v39, v42 quad_perm:[3,3,3,3] row_mask:0xf bank_mask:0xa
    s_waitcnt vmcnt(7)
    s_cbranch_vccz L_pc_82
    s_waitcnt vmcnt(5)
L_pc_82:
    s_add_u32 s87, s86, 0x30000
    buffer_load_dwordx4 v[160:163], v1, s[32:35], s87 offen offset:0 nt
    s_waitcnt vmcnt(7)
    s_cbranch_vccz L_pc_83
    s_waitcnt vmcnt(5)
L_pc_83:
    buffer_load_dwordx4 v[164:167], v1, s[32:35], s87 offen offset:1024 nt
    v_smfmac_f32_16x16x64_bf16 v[12:15], v[32:35], v[128:135], v25
    v_mov_b32_dpp v28, v43 quad_perm:[0,0,0,0] row_mask:0xf bank_mask:0x5
    v_mov_b32_dpp v29, v23 quad_perm:[3,3,3,3] row_mask:0xf bank_mask:0xa
    s_waitcnt vmcnt(7)
    s_cbranch_vccz L_pc_84
    s_waitcnt vmcnt(5)
L_pc_84:
    buffer_load_dwordx4 v[168:171], v1, s[32:35], s87 offen offset:2048 nt
    s_cmp_eq_u32 s3, 1
    s_cbranch_scc0 L_nv_85
    s_mov_b64 exec, 2
    buffer_store_byte v5, off, s[36:39], s101 offset:3
    s_mov_b32 exec_lo, -1
L_nv_85:
    s_mov_b32 exec_hi, 0
    buffer_load_ubyte v51, v5, s[36:39], s96 offen offset:3 sc1
    s_mov_b32 exec_hi, -1
    s_waitcnt vmcnt(8)
    s_cbranch_vccz L_pc_86
    s_waitcnt vmcnt(6)
L_pc_86:
    buffer_load_dwordx4 v[172:175], v1, s[32:35], s87 offen offset:3072 nt
    v_smfmac_f32_16x16x64_bf16 v[16:19], v[32:35], v[136:143], v25
    v_mov_b32_dpp v30, v23 quad_perm:[3,3,3,3] row_mask:0xf bank_mask:0x5
    v_mov_b32_dpp v31, v43 quad_perm:[0,0,0,0] row_mask:0xf bank_mask:0xa
    s_waitcnt vmcnt(8)
    s_cbranch_vccz L_pc_87
    s_waitcnt vmcnt(6)
L_pc_87:
    s_add_u32 s87, s44, 0x34000
    buffer_load_dwordx4 v[176:179], v1, s[32:35], s87 offen offset:0 nt
    s_waitcnt vmcnt(8)
    s_cbranch_vccz L_pc_88
    s_waitcnt vmcnt(6)
L_pc_88:
    buffer_load_dwordx4 v[180:183], v1, s[32:35], s87 offen offset:1024 nt
    v_smfmac_f32_16x16x64_bf16 v[12:15], v[36:39], v[144:151], v25
    v_mov_b32_dpp v32, v43 quad_perm:[1,1,1,1] row_mask:0xf bank_mask:0x5
    v_mov_b32_dpp v33, v23 quad_perm:[2,2,2,2] row_mask:0xf bank_mask:0xa
    s_waitcnt vmcnt(8)
    s_cbranch_vccz L_pc_89
    s_waitcnt vmcnt(6)
L_pc_89:
    buffer_load_dwordx4 v[184:187], v1, s[32:35], s87 offen offset:2048 nt
    s_waitcnt vmcnt(8)
    s_cbranch_vccz L_pc_90
    s_waitcnt vmcnt(6)
L_pc_90:
    buffer_load_dwordx4 v[188:191], v1, s[32:35], s87 offen offset:3072 nt
    v_smfmac_f32_16x16x64_bf16 v[16:19], v[36:39], v[152:159], v25
    v_mov_b32_dpp v34, v23 quad_perm:[2,2,2,2] row_mask:0xf bank_mask:0x5
    v_mov_b32_dpp v35, v43 quad_perm:[1,1,1,1] row_mask:0xf bank_mask:0xa
    s_waitcnt vmcnt(8)
    s_cbranch_vccz L_pc_91
    s_waitcnt vmcnt(6)
L_pc_91:
    s_add_u32 s87, s86, 0x38000
    buffer_load_dwordx4 v[192:195], v1, s[32:35], s87 offen offset:0 nt
    s_waitcnt vmcnt(6)
    v_cmp_ne_u32 vcc, 0, v51
L_wa5:
    s_cbranch_execz L_wr1
    s_and_b32 vcc_lo, vcc_lo, 0x0fffffff
    s_bcnt1_i32_b32 s100, vcc_lo
    s_cmp_lt_u32 s100, 18
    s_cselect_b32 s100, -1, 0
    s_mov_b32 vcc_lo, s100
    s_mov_b32 vcc_hi, 0
    s_cbranch_vccz L_pc_92
    s_waitcnt vmcnt(5)
L_pc_92:
    buffer_load_dwordx4 v[196:199], v1, s[32:35], s87 offen offset:1024 nt
    v_smfmac_f32_16x16x64_bf16 v[12:15], v[28:31], v[160:167], v25
    v_mov_b32_dpp v36, v43 quad_perm:[2,2,2,2] row_mask:0xf bank_mask:0x5
    v_mov_b32_dpp v37, v23 quad_perm:[1,1,1,1] row_mask:0xf bank_mask:0xa
    s_cbranch_vccz L_pc_93
    s_waitcnt vmcnt(5)
L_pc_93:
    buffer_load_dwordx4 v[200:203], v1, s[32:35], s87 offen offset:2048 nt
    s_waitcnt vmcnt(7)
    s_cbranch_vccz L_pc_94
    s_waitcnt vmcnt(5)
L_pc_94:
    buffer_load_dwordx4 v[204:207], v1, s[32:35], s87 offen offset:3072 nt
    v_smfmac_f32_16x16x64_bf16 v[16:19], v[28:31], v[168:175], v25
    v_mov_b32_dpp v38, v23 quad_perm:[1,1,1,1] row_mask:0xf bank_mask:0x5
    v_mov_b32_dpp v39, v43 quad_perm:[2,2,2,2] row_mask:0xf bank_mask:0xa
    s_waitcnt vmcnt(7)
    s_cbranch_vccz L_pc_95
    s_waitcnt vmcnt(5)
L_pc_95:
    s_add_u32 s87, s44, 0x3c000
    buffer_load_dwordx4 v[208:211], v1, s[32:35], s87 offen offset:0 nt
    s_waitcnt vmcnt(7)
    s_cbranch_vccz L_pc_96
    s_waitcnt vmcnt(5)
L_pc_96:
    buffer_load_dwordx4 v[212:215], v1, s[32:35], s87 offen offset:1024 nt
    v_smfmac_f32_16x16x64_bf16 v[12:15], v[32:35], v[176:183], v25
    v_mov_b32_dpp v28, v43 quad_perm:[3,3,3,3] row_mask:0xf bank_mask:0x5
    v_mov_b32_dpp v29, v23 quad_perm:[0,0,0,0] row_mask:0xf bank_mask:0xa
    s_waitcnt vmcnt(7)
    s_cbranch_vccz L_pc_97
    s_waitcnt vmcnt(5)
L_pc_97:
    buffer_load_dwordx4 v[216:219], v1, s[32:35], s87 offen offset:2048 nt
    s_waitcnt vmcnt(7)
    s_cbranch_vccz L_pc_98
    s_waitcnt vmcnt(5)
L_pc_98:
    buffer_load_dwordx4 v[220:223], v1, s[32:35], s87 offen offset:3072 nt
    v_smfmac_f32_16x16x64_bf16 v[16:19], v[32:35], v[184:191], v25
    v_mov_b32_dpp v30, v23 quad_perm:[0,0,0,0] row_mask:0xf bank_mask:0x5
    v_mov_b32_dpp v31, v43 quad_perm:[3,3,3,3] row_mask:0xf bank_mask:0xa
    s_waitcnt vmcnt(7)
    s_cbranch_vccz L_pc_99
    s_waitcnt vmcnt(5)
L_pc_99:
    s_add_u32 s87, s86, 0x40000
    buffer_load_dwordx4 v[224:227], v1, s[32:35], s87 offen offset:0 nt
    s_waitcnt vmcnt(7)
    s_cbranch_vccz L_pc_100
    s_waitcnt vmcnt(5)
L_pc_100:
    buffer_load_dwordx4 v[228:231], v1, s[32:35], s87 offen offset:1024 nt
    s_add_u32 s73, s89, 0x500
    buffer_load_dwordx4 v[48:51], v6, s[36:39], s73 offen sc1
    v_smfmac_f32_16x16x64_bf16 v[12:15], v[36:39], v[192:199], v25
    v_mov_b32_dpp v32, v2 quad_perm:[0,0,0,0] row_mask:0xf bank_mask:0x5
    v_mov_b32_dpp v33, v24 quad_perm:[3,3,3,3] row_mask:0xf bank_mask:0xa
    s_waitcnt vmcnt(8)
    s_cbranch_vccz L_pc_101
    s_waitcnt vmcnt(6)
L_pc_101:
    buffer_load_dwordx4 v[232:235], v1, s[32:35], s87 offen offset:2048 nt
    s_waitcnt vmcnt(8)
    s_cbranch_vccz L_pc_102
    s_waitcnt vmcnt(6)
L_pc_102:
    buffer_load_dwordx4 v[236:239], v1, s[32:35], s87 offen offset:3072 nt
    v_smfmac_f32_16x16x64_bf16 v[16:19], v[36:39], v[200:207], v25
    v_mov_b32_dpp v34, v24 quad_perm:[3,3,3,3] row_mask:0xf bank_mask:0x5
    v_mov_b32_dpp v35, v2 quad_perm:[0,0,0,0] row_mask:0xf bank_mask:0xa
    s_waitcnt vmcnt(8)
    s_cbranch_vccz L_pc_103
    s_waitcnt vmcnt(6)
L_pc_103:
    s_add_u32 s87, s44, 0x44000
    buffer_load_dwordx4 v[240:243], v1, s[32:35], s87 offen offset:0 nt
    s_waitcnt vmcnt(8)
    s_cbranch_vccz L_pc_104
    s_waitcnt vmcnt(6)
L_pc_104:
    buffer_load_dwordx4 v[244:247], v1, s[32:35], s87 offen offset:1024 nt
    v_smfmac_f32_16x16x64_bf16 v[12:15], v[28:31], v[208:215], v25
    v_mov_b32_dpp v36, v2 quad_perm:[1,1,1,1] row_mask:0xf bank_mask:0x5
    v_mov_b32_dpp v37, v24 quad_perm:[2,2,2,2] row_mask:0xf bank_mask:0xa
    s_waitcnt vmcnt(8)
    s_cbranch_vccz L_pc_105
    s_waitcnt vmcnt(6)
L_pc_105:
    buffer_load_dwordx4 v[248:251], v1, s[32:35], s87 offen offset:2048 nt
    s_waitcnt vmcnt(8)
    s_cbranch_vccz L_pc_106
    s_waitcnt vmcnt(6)
L_pc_106:
    buffer_load_dwordx4 v[252:255], v1, s[32:35], s87 offen offset:3072 nt
    v_smfmac_f32_16x16x64_bf16 v[16:19], v[28:31], v[216:223], v25
    v_mov_b32_dpp v38, v24 quad_perm:[2,2,2,2] row_mask:0xf bank_mask:0x5
    v_mov_b32_dpp v39, v2 quad_perm:[1,1,1,1] row_mask:0xf bank_mask:0xa
    s_waitcnt vmcnt(4)
    v_smfmac_f32_16x16x64_bf16 v[12:15], v[32:35], v[224:231], v25
    v_smfmac_f32_16x16x64_bf16 v[16:19], v[32:35], v[232:239], v25
    s_add_u32 s87, s86, 0x4008000
    buffer_load_dwordx4 v[68:71], v4, s[28:31], s87 offen offset:0
    s_waitcnt vmcnt(4)
    buffer_load_dwordx4 v[72:75], v4, s[28:31], s87 offen offset:256
    s_waitcnt vmcnt(4)
    v_smfmac_f32_16x16x64_bf16 v[12:15], v[36:39], v[240:247], v25
    buffer_load_dwordx4 v[76:79], v4, s[28:31], s87 offen offset:2048
    s_waitcnt vmcnt(4)
    buffer_load_dwordx4 v[80:83], v4, s[28:31], s87 offen offset:2304
    s_waitcnt vmcnt(4)
    v_smfmac_f32_16x16x64_bf16 v[16:19], v[36:39], v[248:255], v25
M_pub0:
    s_lshl_b32 s73, s99, 5
    v_add_u32 v0, s73, v5
    s_nop 0
    v_permlane32_swap_b32 v12, v14
    v_permlane32_swap_b32 v13, v15
    s_nop 2
    v_permlane32_swap_b32 v16, v18
    v_permlane32_swap_b32 v17, v19
    v_add_f32 v12, v12, v18
    v_add_f32 v13, v13, v19
    v_mul_f32 v12, v12, v27
    v_mul_f32 v13, v13, v27
    s_cmp_lg_u32 s3, 0
    ds_write_b64 v0, v[12:13] offset:0
    v_lshrrev_b32 v28, 8, v5
    v_and_b32 v29, 0xf8, v5
    v_lshl_or_b32 v34, v28, 2, v29
    s_waitcnt lgkmcnt(0)
    s_barrier
    s_cbranch_scc1 L_np0
    ds_read_b64 v[28:29], v5 offset:512
    ds_read_b64 v[30:31], v5 offset:1024
    ds_read_b64 v[32:33], v5 offset:1536
    s_waitcnt lgkmcnt(2)
    v_pk_add_f32 v[12:13], v[12:13], v[28:29]
    s_waitcnt lgkmcnt(0)
    v_pk_add_f32 v[30:31], v[30:31], v[32:33]
    v_pk_add_f32 v[12:13], v[12:13], v[30:31]
    v_cvt_pk_bf16_f32 v12, v12, v13
    v_min_u32 v12, -2, v12
    s_cmp_eq_u32 s98, 0
    s_cbranch_scc0 L_st_o0
    buffer_store_dword v12, v34, s[36:39], s90 offen
L_str_o0:
L_np0:
L_qc_107:
    v_max3_u32 v28, v48, v49, v50
    v_max_u32 v28, v28, v51
    v_cmp_eq_u32 vcc, -1, v28
    s_nop 4
    s_cbranch_vccz L_qok_108
    s_add_u32 s73, s89, 0x500
    buffer_load_dwordx4 v[48:51], v6, s[36:39], s73 offen sc1
    s_waitcnt vmcnt(0)
    s_sub_u32 s72, s72, 1
    s_cbranch_scc0 L_qc_107
    s_endpgm
L_wa6:
    s_branch L_wr1
L_qok_108:
    s_mov_b32 vcc_lo, s100
    s_mov_b32 vcc_hi, 0
    v_mov_b64 v[12:13], v[48:49]
    v_mov_b64 v[14:15], v[50:51]
    s_add_u32 s87, s44, 0x400c000
    buffer_load_dwordx4 v[52:55], v4, s[28:31], s87 offen offset:0
    s_waitcnt vmcnt(4)
    v_mfma_f32_16x16x32_bf16 v[28:31], v[68:71], v[12:15], 0
    buffer_load_dwordx4 v[56:59], v4, s[28:31], s87 offen offset:256
    v_mov_b32_dpp v7, v7 quad_perm:[1,1,0,1] row_mask:0xf bank_mask:0xf
    s_nop 5
    v_mul_f32_dpp v48, v28, v7 quad_perm:[0,0,0,0] row_mask:0xf bank_mask:0x1
    s_nop 1
    v_fmac_f32_dpp v48, v29, v7 quad_perm:[1,1,1,1] row_mask:0xf bank_mask:0x1
    s_nop 1
    v_fmac_f32_dpp v48, v30, v7 quad_perm:[2,2,2,2] row_mask:0xf bank_mask:0x1
    s_nop 1
    v_fmac_f32_dpp v48, v31, v7 quad_perm:[3,3,3,3] row_mask:0xf bank_mask:0x1
    s_waitcnt vmcnt(4)
    v_mfma_f32_16x16x32_bf16 v[28:31], v[72:75], v[12:15], 0
    buffer_load_dwordx4 v[60:63], v4, s[28:31], s87 offen offset:2048
    s_nop 6
    v_mul_f32_dpp v48, v28, v7 quad_perm:[0,0,0,0] row_mask:0xf bank_mask:0x2
    s_nop 1
    v_fmac_f32_dpp v48, v29, v7 quad_perm:[1,1,1,1] row_mask:0xf bank_mask:0x2
    s_nop 1
    v_fmac_f32_dpp v48, v30, v7 quad_perm:[2,2,2,2] row_mask:0xf bank_mask:0x2
    s_nop 1
    v_fmac_f32_dpp v48, v31, v7 quad_perm:[3,3,3,3] row_mask:0xf bank_mask:0x2
    s_waitcnt vmcnt(4)
    v_mfma_f32_16x16x32_bf16 v[28:31], v[76:79], v[12:15], 0
    buffer_load_dwordx4 v[64:67], v4, s[28:31], s87 offen offset:2304
    s_nop 6
    v_mul_f32_dpp v48, v28, v7 quad_perm:[0,0,0,0] row_mask:0xf bank_mask:0x4
    s_nop 1
    v_fmac_f32_dpp v48, v29, v7 quad_perm:[1,1,1,1] row_mask:0xf bank_mask:0x4
    s_nop 1
    v_fmac_f32_dpp v48, v30, v7 quad_perm:[2,2,2,2] row_mask:0xf bank_mask:0x4
    s_nop 1
    v_fmac_f32_dpp v48, v31, v7 quad_perm:[3,3,3,3] row_mask:0xf bank_mask:0x4
    s_add_u32 s87, s86, 0x4010000
    buffer_load_dwordx4 v[68:71], v4, s[28:31], s87 offen offset:0
    s_cbranch_vccz L_pc_109
    s_waitcnt vmcnt(5)
L_pc_109:
    buffer_load_dwordx4 v[72:75], v4, s[28:31], s87 offen offset:256
    s_cbranch_vccz L_pc_110
    s_waitcnt vmcnt(5)
L_pc_110:
    buffer_load_dwordx4 v[76:79], v4, s[28:31], s87 offen offset:2048
    s_waitcnt vmcnt(7)
    s_cbranch_vccz L_pc_111
    s_waitcnt vmcnt(5)
L_pc_111:
    v_mfma_f32_16x16x32_bf16 v[28:31], v[80:83], v[12:15], 0
    buffer_load_dwordx4 v[80:83], v4, s[28:31], s87 offen offset:2304
    s_nop 6
    v_mul_f32_dpp v48, v28, v7 quad_perm:[0,0,0,0] row_mask:0xf bank_mask:0x8
    s_nop 1
    v_fmac_f32_dpp v48, v29, v7 quad_perm:[1,1,1,1] row_mask:0xf bank_mask:0x8
    s_nop 1
    v_fmac_f32_dpp v48, v30, v7 quad_perm:[2,2,2,2] row_mask:0xf bank_mask:0x8
    s_nop 1
    v_fmac_f32_dpp v48, v31, v7 quad_perm:[3,3,3,3] row_mask:0xf bank_mask:0x8
    s_waitcnt vmcnt(7)
    s_cbranch_vccz L_pc_112
    s_waitcnt vmcnt(5)
L_pc_112:
    v_mfma_f32_16x16x32_bf16 v[28:31], v[52:55], v[12:15], 0
    s_add_u32 s87, s86, 0x4000000
    buffer_load_dwordx4 v[32:35], v4, s[28:31], s87 offen offset:0 nt
    v_mov_b32_dpp v7, v7 quad_perm:[3,3,3,2] row_mask:0xf bank_mask:0xf
    s_nop 4
    v_fmac_f32_dpp v48, v28, v7 quad_perm:[0,0,0,0] row_mask:0xf bank_mask:0x1
    s_nop 1
    v_fmac_f32_dpp v48, v29, v7 quad_perm:[1,1,1,1] row_mask:0xf bank_mask:0x1
    s_nop 1
    v_fmac_f32_dpp v48, v30, v7 quad_perm:[2,2,2,2] row_mask:0xf bank_mask:0x1
    s_nop 1
    v_fmac_f32_dpp v48, v31, v7 quad_perm:[3,3,3,3] row_mask:0xf bank_mask:0x1
    s_waitcnt vmcnt(7)
    s_cbranch_vccz L_pc_113
    s_waitcnt vmcnt(5)
L_pc_113:
    v_mfma_f32_16x16x32_bf16 v[28:31], v[56:59], v[12:15], 0
    buffer_load_dwordx4 v[20:23], v4, s[28:31], s87 offen offset:256 nt
    s_nop 6
    v_fmac_f32_dpp v48, v28, v7 quad_perm:[0,0,0,0] row_mask:0xf bank_mask:0x2
    s_nop 1
    v_fmac_f32_dpp v48, v29, v7 quad_perm:[1,1,1,1] row_mask:0xf bank_mask:0x2
    s_nop 1
    v_fmac_f32_dpp v48, v30, v7 quad_perm:[2,2,2,2] row_mask:0xf bank_mask:0x2
    s_nop 1
    v_fmac_f32_dpp v48, v31, v7 quad_perm:[3,3,3,3] row_mask:0xf bank_mask:0x2
    s_waitcnt vmcnt(7)
    s_cbranch_vccz L_pc_114
    s_waitcnt vmcnt(5)
L_pc_114:
    v_mfma_f32_16x16x32_bf16 v[28:31], v[60:63], v[12:15], 0
    buffer_load_dwordx4 v[36:39], v4, s[28:31], s87 offen offset:2048 nt
    s_nop 6
    v_fmac_f32_dpp v48, v28, v7 quad_perm:[0,0,0,0] row_mask:0xf bank_mask:0x4
    s_nop 1
    v_fmac_f32_dpp v48, v29, v7 quad_perm:[1,1,1,1] row_mask:0xf bank_mask:0x4
    s_nop 1
    v_fmac_f32_dpp v48, v30, v7 quad_perm:[2,2,2,2] row_mask:0xf bank_mask:0x4
    s_nop 1
    v_fmac_f32_dpp v48, v31, v7 quad_perm:[3,3,3,3] row_mask:0xf bank_mask:0x4
    s_waitcnt vmcnt(7)
    s_cbranch_vccz L_pc_115
    s_waitcnt vmcnt(5)
L_pc_115:
    v_mfma_f32_16x16x32_bf16 v[28:31], v[64:67], v[12:15], 0
    buffer_load_dwordx4 v[8:11], v4, s[28:31], s87 offen offset:2304 nt
    s_nop 6
    v_fmac_f32_dpp v48, v28, v7 quad_perm:[0,0,0,0] row_mask:0xf bank_mask:0x8
    s_nop 1
    v_fmac_f32_dpp v48, v29, v7 quad_perm:[1,1,1,1] row_mask:0xf bank_mask:0x8
    s_nop 1
    v_fmac_f32_dpp v48, v30, v7 quad_perm:[2,2,2,2] row_mask:0xf bank_mask:0x8
    s_nop 1
    v_fmac_f32_dpp v48, v31, v7 quad_perm:[3,3,3,3] row_mask:0xf bank_mask:0x8
    s_waitcnt vmcnt(7)
    s_cbranch_vccz L_pc_116
    s_waitcnt vmcnt(5)
L_pc_116:
    v_mfma_f32_16x16x32_bf16 v[28:31], v[68:71], v[12:15], 0
    s_add_u32 s87, s44, 0x4004000
    buffer_load_dwordx4 v[16:19], v4, s[28:31], s87 offen offset:0 nt
    v_mov_b32_dpp v7, v7 quad_perm:[3,2,2,2] row_mask:0xf bank_mask:0xf
    s_nop 4
    v_mul_f32_dpp v49, v28, v7 quad_perm:[0,0,0,0] row_mask:0xf bank_mask:0x1
    s_nop 1
    v_fmac_f32_dpp v49, v29, v7 quad_perm:[1,1,1,1] row_mask:0xf bank_mask:0x1
    s_nop 1
    v_fmac_f32_dpp v49, v30, v7 quad_perm:[2,2,2,2] row_mask:0xf bank_mask:0x1
    s_nop 1
    v_fmac_f32_dpp v49, v31, v7 quad_perm:[3,3,3,3] row_mask:0xf bank_mask:0x1
    s_waitcnt vmcnt(7)
    s_cbranch_vccz L_pc_117
    s_waitcnt vmcnt(5)
L_pc_117:
    v_mfma_f32_16x16x32_bf16 v[28:31], v[72:75], v[12:15], 0
    buffer_load_dwordx4 v[24:27], v4, s[28:31], s87 offen offset:256 nt
    s_nop 6
    v_mul_f32_dpp v49, v28, v7 quad_perm:[0,0,0,0] row_mask:0xf bank_mask:0x2
    s_nop 1
    v_fmac_f32_dpp v49, v29, v7 quad_perm:[1,1,1,1] row_mask:0xf bank_mask:0x2
    s_nop 1
    v_fmac_f32_dpp v49, v30, v7 quad_perm:[2,2,2,2] row_mask:0xf bank_mask:0x2
    s_nop 1
    v_fmac_f32_dpp v49, v31, v7 quad_perm:[3,3,3,3] row_mask:0xf bank_mask:0x2
    s_waitcnt vmcnt(7)
    s_cbranch_vccz L_pc_118
    s_waitcnt vmcnt(5)
L_pc_118:
    v_mfma_f32_16x16x32_bf16 v[28:31], v[76:79], v[12:15], 0
    buffer_load_dwordx4 v[44:47], v4, s[28:31], s87 offen offset:2048 nt
    s_nop 6
    v_mul_f32_dpp v49, v28, v7 quad_perm:[0,0,0,0] row_mask:0xf bank_mask:0x4
    s_nop 1
    v_fmac_f32_dpp v49, v29, v7 quad_perm:[1,1,1,1] row_mask:0xf bank_mask:0x4
    s_nop 1
    v_fmac_f32_dpp v49, v30, v7 quad_perm:[2,2,2,2] row_mask:0xf bank_mask:0x4
    s_nop 1
    v_fmac_f32_dpp v49, v31, v7 quad_perm:[3,3,3,3] row_mask:0xf bank_mask:0x4
    s_waitcnt vmcnt(7)
    s_cbranch_vccz L_pc_119
    s_waitcnt vmcnt(5)
L_pc_119:
    v_mfma_f32_16x16x32_bf16 v[28:31], v[80:83], v[12:15], 0
    buffer_load_dwordx4 v[0:3], v4, s[28:31], s87 offen offset:2304 nt
    s_nop 6
    v_mul_f32_dpp v49, v28, v7 quad_perm:[0,0,0,0] row_mask:0xf bank_mask:0x8
    s_nop 1
    v_fmac_f32_dpp v49, v29, v7 quad_perm:[1,1,1,1] row_mask:0xf bank_mask:0x8
    s_nop 1
    v_fmac_f32_dpp v49, v30, v7 quad_perm:[2,2,2,2] row_mask:0xf bank_mask:0x8
    s_nop 1
    v_fmac_f32_dpp v49, v31, v7 quad_perm:[3,3,3,3] row_mask:0xf bank_mask:0x8
    s_waitcnt vmcnt(7)
    s_cbranch_vccz L_pc_120
    s_waitcnt vmcnt(5)
L_pc_120:
    v_mfma_f32_16x16x32_bf16 v[28:31], v[32:35], v[12:15], 0
    s_add_u32 s87, s44, 0x4014000
    buffer_load_dwordx4 v[52:55], v4, s[28:31], s87 offen offset:0
L_wa7:
    s_cbranch_execz L_wr1
    s_nop 4
    v_fmac_f32_dpp v48, v28, v7 quad_perm:[0,0,0,0] row_mask:0xf bank_mask:0x1
    s_nop 1
    v_fmac_f32_dpp v48, v29, v7 quad_perm:[1,1,1,1] row_mask:0xf bank_mask:0x1
    s_nop 1
    v_fmac_f32_dpp v48, v30, v7 quad_perm:[2,2,2,2] row_mask:0xf bank_mask:0x1
    s_nop 1
    v_fmac_f32_dpp v48, v31, v7 quad_perm:[3,3,3,3] row_mask:0xf bank_mask:0x1
    s_waitcnt vmcnt(7)
    s_cbranch_vccz L_pc_121
    s_waitcnt vmcnt(5)
L_pc_121:
    v_mfma_f32_16x16x32_bf16 v[28:31], v[20:23], v[12:15], 0
    buffer_load_dwordx4 v[56:59], v4, s[28:31], s87 offen offset:256
    s_nop 6
    v_fmac_f32_dpp v48, v28, v7 quad_perm:[0,0,0,0] row_mask:0xf bank_mask:0x2
    s_nop 1
    v_fmac_f32_dpp v48, v29, v7 quad_perm:[1,1,1,1] row_mask:0xf bank_mask:0x2
    s_nop 1
    v_fmac_f32_dpp v48, v30, v7 quad_perm:[2,2,2,2] row_mask:0xf bank_mask:0x2
    s_nop 1
    v_fmac_f32_dpp v48, v31, v7 quad_perm:[3,3,3,3] row_mask:0xf bank_mask:0x2
    s_waitcnt vmcnt(7)
    s_cbranch_vccz L_pc_122
    s_waitcnt vmcnt(5)
L_pc_122:
    v_mfma_f32_16x16x32_bf16 v[28:31], v[36:39], v[12:15], 0
    buffer_load_dwordx4 v[60:63], v4, s[28:31], s87 offen offset:2048
    s_nop 6
    v_fmac_f32_dpp v48, v28, v7 quad_perm:[0,0,0,0] row_mask:0xf bank_mask:0x4
    s_nop 1
    v_fmac_f32_dpp v48, v29, v7 quad_perm:[1,1,1,1] row_mask:0xf bank_mask:0x4
    s_nop 1
    v_fmac_f32_dpp v48, v30, v7 quad_perm:[2,2,2,2] row_mask:0xf bank_mask:0x4
    s_nop 1
    v_fmac_f32_dpp v48, v31, v7 quad_perm:[3,3,3,3] row_mask:0xf bank_mask:0x4
    s_waitcnt vmcnt(7)
    s_cbranch_vccz L_pc_123
    s_waitcnt vmcnt(5)
L_pc_123:
    v_mfma_f32_16x16x32_bf16 v[28:31], v[8:11], v[12:15], 0
    buffer_load_dwordx4 v[64:67], v4, s[28:31], s87 offen offset:2304
    s_nop 6
    v_fmac_f32_dpp v48, v28, v7 quad_perm:[0,0,0,0] row_mask:0xf bank_mask:0x8
    s_nop 1
    v_fmac_f32_dpp v48, v29, v7 quad_perm:[1,1,1,1] row_mask:0xf bank_mask:0x8
    s_nop 1
    v_fmac_f32_dpp v48, v30, v7 quad_perm:[2,2,2,2] row_mask:0xf bank_mask:0x8
    s_nop 1
    v_fmac_f32_dpp v48, v31, v7 quad_perm:[3,3,3,3] row_mask:0xf bank_mask:0x8
    s_waitcnt vmcnt(7)
    s_cbranch_vccz L_pc_124
    s_waitcnt vmcnt(5)
L_pc_124:
    v_mfma_f32_16x16x32_bf16 v[28:31], v[16:19], v[12:15], 0
    s_add_u32 s87, s86, 0x4018000
    buffer_load_dwordx4 v[68:71], v4, s[28:31], s87 offen offset:0
    v_mov_b32_dpp v7, v7 quad_perm:[1,0,1,1] row_mask:0xf bank_mask:0xf
    s_nop 4
    v_fmac_f32_dpp v48, v28, v7 quad_perm:[0,0,0,0] row_mask:0xf bank_mask:0x1
    s_nop 1
    v_fmac_f32_dpp v48, v29, v7 quad_perm:[1,1,1,1] row_mask:0xf bank_mask:0x1
    s_nop 1
    v_fmac_f32_dpp v48, v30, v7 quad_perm:[2,2,2,2] row_mask:0xf bank_mask:0x1
    s_nop 1
    v_fmac_f32_dpp v48, v31, v7 quad_perm:[3,3,3,3] row_mask:0xf bank_mask:0x1
    s_waitcnt vmcnt(7)
    s_cbranch_vccz L_pc_125
    s_waitcnt vmcnt(5)
L_pc_125:
    v_mfma_f32_16x16x32_bf16 v[28:31], v[24:27], v[12:15], 0
    buffer_load_dwordx4 v[72:75], v4, s[28:31], s87 offen offset:256
    s_nop 6
    v_fmac_f32_dpp v48, v28, v7 quad_perm:[0,0,0,0] row_mask:0xf bank_mask:0x2
    s_nop 1
    v_fmac_f32_dpp v48, v29, v7 quad_perm:[1,1,1,1] row_mask:0xf bank_mask:0x2
    s_nop 1
    v_fmac_f32_dpp v48, v30, v7 quad_perm:[2,2,2,2] row_mask:0xf bank_mask:0x2
    s_nop 1
    v_fmac_f32_dpp v48, v31, v7 quad_perm:[3,3,3,3] row_mask:0xf bank_mask:0x2
    s_waitcnt vmcnt(7)
    s_cbranch_vccz L_pc_126
    s_waitcnt vmcnt(5)
L_pc_126:
    v_mfma_f32_16x16x32_bf16 v[28:31], v[44:47], v[12:15], 0
    buffer_load_dwordx4 v[76:79], v4, s[28:31], s87 offen offset:2048
    s_nop 6
    v_fmac_f32_dpp v48, v28, v7 quad_perm:[0,0,0,0] row_mask:0xf bank_mask:0x4
    s_nop 1
    v_fmac_f32_dpp v48, v29, v7 quad_perm:[1,1,1,1] row_mask:0xf bank_mask:0x4
    s_nop 1
    v_fmac_f32_dpp v48, v30, v7 quad_perm:[2,2,2,2] row_mask:0xf bank_mask:0x4
    s_nop 1
    v_fmac_f32_dpp v48, v31, v7 quad_perm:[3,3,3,3] row_mask:0xf bank_mask:0x4
    s_waitcnt vmcnt(7)
    s_cbranch_vccz L_pc_127
    s_waitcnt vmcnt(5)
L_pc_127:
    v_mfma_f32_16x16x32_bf16 v[28:31], v[0:3], v[12:15], 0
    buffer_load_dwordx4 v[80:83], v4, s[28:31], s87 offen offset:2304
    s_nop 6
    v_fmac_f32_dpp v48, v28, v7 quad_perm:[0,0,0,0] row_mask:0xf bank_mask:0x8
    s_nop 1
    v_fmac_f32_dpp v48, v29, v7 quad_perm:[1,1,1,1] row_mask:0xf bank_mask:0x8
    s_nop 1
    v_fmac_f32_dpp v48, v30, v7 quad_perm:[2,2,2,2] row_mask:0xf bank_mask:0x8
    s_nop 1
    v_fmac_f32_dpp v48, v31, v7 quad_perm:[3,3,3,3] row_mask:0xf bank_mask:0x8
    s_waitcnt vmcnt(7)
    s_cbranch_vccz L_pc_128
    s_waitcnt vmcnt(5)
L_pc_128:
    v_mfma_f32_16x16x32_bf16 v[28:31], v[52:55], v[12:15], 0
    s_add_u32 s87, s44, 0x401c000
    buffer_load_dwordx4 v[52:55], v4, s[28:31], s87 offen offset:0
    s_nop 5
    v_fmac_f32_dpp v49, v28, v7 quad_perm:[0,0,0,0] row_mask:0xf bank_mask:0x1
    s_nop 1
    v_fmac_f32_dpp v49, v29, v7 quad_perm:[1,1,1,1] row_mask:0xf bank_mask:0x1
    s_nop 1
    v_fmac_f32_dpp v49, v30, v7 quad_perm:[2,2,2,2] row_mask:0xf bank_mask:0x1
    s_nop 1
    v_fmac_f32_dpp v49, v31, v7 quad_perm:[3,3,3,3] row_mask:0xf bank_mask:0x1
    s_cmp_eq_u32 s3, 1
    s_cbranch_scc0 L_nv_129
    s_mov_b64 exec, 2
    buffer_store_byte v5, off, s[36:39], s101 offset:4
    s_mov_b32 exec_lo, -1
L_nv_129:
    s_mov_b32 exec_hi, 0
    buffer_load_ubyte v40, v5, s[36:39], s96 offen offset:4 sc1
    s_mov_b32 exec_hi, -1
    s_waitcnt vmcnt(8)
    s_cbranch_vccz L_pc_130
    s_waitcnt vmcnt(6)
L_pc_130:
    v_mfma_f32_16x16x32_bf16 v[28:31], v[56:59], v[12:15], 0
    buffer_load_dwordx4 v[56:59], v4, s[28:31], s87 offen offset:256
    s_nop 6
    v_fmac_f32_dpp v49, v28, v7 quad_perm:[0,0,0,0] row_mask:0xf bank_mask:0x2
    s_nop 1
    v_fmac_f32_dpp v49, v29, v7 quad_perm:[1,1,1,1] row_mask:0xf bank_mask:0x2
    s_nop 1
    v_fmac_f32_dpp v49, v30, v7 quad_perm:[2,2,2,2] row_mask:0xf bank_mask:0x2
    s_nop 1
    v_fmac_f32_dpp v49, v31, v7 quad_perm:[3,3,3,3] row_mask:0xf bank_mask:0x2
    s_waitcnt vmcnt(8)
    s_cbranch_vccz L_pc_131
    s_waitcnt vmcnt(6)
L_pc_131:
    v_mfma_f32_16x16x32_bf16 v[28:31], v[60:63], v[12:15], 0
    buffer_load_dwordx4 v[60:63], v4, s[28:31], s87 offen offset:2048
    s_nop 6
    v_fmac_f32_dpp v49, v28, v7 quad_perm:[0,0,0,0] row_mask:0xf bank_mask:0x4
    s_nop 1
    v_fmac_f32_dpp v49, v29, v7 quad_perm:[1,1,1,1] row_mask:0xf bank_mask:0x4
    s_nop 1
    v_fmac_f32_dpp v49, v30, v7 quad_perm:[2,2,2,2] row_mask:0xf bank_mask:0x4
    s_nop 1
    v_fmac_f32_dpp v49, v31, v7 quad_perm:[3,3,3,3] row_mask:0xf bank_mask:0x4
    s_waitcnt vmcnt(8)
    s_cbranch_vccz L_pc_132
    s_waitcnt vmcnt(6)
L_pc_132:
    v_mfma_f32_16x16x32_bf16 v[28:31], v[64:67], v[12:15], 0
    buffer_load_dwordx4 v[64:67], v4, s[28:31], s87 offen offset:2304
    s_nop 6
    v_fmac_f32_dpp v49, v28, v7 quad_perm:[0,0,0,0] row_mask:0xf bank_mask:0x8
    s_nop 1
    v_fmac_f32_dpp v49, v29, v7 quad_perm:[1,1,1,1] row_mask:0xf bank_mask:0x8
    s_nop 1
    v_fmac_f32_dpp v49, v30, v7 quad_perm:[2,2,2,2] row_mask:0xf bank_mask:0x8
    s_nop 1
    v_fmac_f32_dpp v49, v31, v7 quad_perm:[3,3,3,3] row_mask:0xf bank_mask:0x8
    s_waitcnt vmcnt(8)
    s_cbranch_vccz L_pc_133
    s_waitcnt vmcnt(6)
L_pc_133:
    v_mfma_f32_16x16x32_bf16 v[28:31], v[68:71], v[12:15], 0
    s_add_u32 s87, s86, 0x4020000
    buffer_load_dwordx4 v[68:71], v4, s[28:31], s87 offen offset:0
    v_mov_b32_dpp v7, v7 quad_perm:[0,0,1,0] row_mask:0xf bank_mask:0xf
    s_nop 4
    v_fmac_f32_dpp v49, v28, v7 quad_perm:[0,0,0,0] row_mask:0xf bank_mask:0x1
    s_nop 1
    v_fmac_f32_dpp v49, v29, v7 quad_perm:[1,1,1,1] row_mask:0xf bank_mask:0x1
    s_nop 1
    v_fmac_f32_dpp v49, v30, v7 quad_perm:[2,2,2,2] row_mask:0xf bank_mask:0x1
    s_nop 1
    v_fmac_f32_dpp v49, v31, v7 quad_perm:[3,3,3,3] row_mask:0xf bank_mask:0x1
    s_waitcnt vmcnt(8)
    s_cbranch_vccz L_pc_134
    s_waitcnt vmcnt(6)
L_pc_134:
    v_mfma_f32_16x16x32_bf16 v[28:31], v[72:75], v[12:15], 0
    buffer_load_dwordx4 v[72:75], v4, s[28:31], s87 offen offset:256
    s_nop 6
    v_fmac_f32_dpp v49, v28, v7 quad_perm:[0,0,0,0] row_mask:0xf bank_mask:0x2
L_wa8:
    s_cbranch_execz L_wr2
    s_nop 0
    v_fmac_f32_dpp v49, v29, v7 quad_perm:[1,1,1,1] row_mask:0xf bank_mask:0x2
    s_nop 1
    v_fmac_f32_dpp v49, v30, v7 quad_perm:[2,2,2,2] row_mask:0xf bank_mask:0x2
    s_nop 1
    v_fmac_f32_dpp v49, v31, v7 quad_perm:[3,3,3,3] row_mask:0xf bank_mask:0x2
    s_waitcnt vmcnt(8)
    s_cbranch_vccz L_pc_135
    s_waitcnt vmcnt(6)
L_pc_135:
    v_mfma_f32_16x16x32_bf16 v[28:31], v[76:79], v[12:15], 0
    buffer_load_dwordx4 v[76:79], v4, s[28:31], s87 offen offset:2048 nt
    s_nop 6
    v_fmac_f32_dpp v49, v28, v7 quad_perm:[0,0,0,0] row_mask:0xf bank_mask:0x4
    s_nop 1
    v_fmac_f32_dpp v49, v29, v7 quad_perm:[1,1,1,1] row_mask:0xf bank_mask:0x4
    s_nop 1
    v_fmac_f32_dpp v49, v30, v7 quad_perm:[2,2,2,2] row_mask:0xf bank_mask:0x4
    s_nop 1
    v_fmac_f32_dpp v49, v31, v7 quad_perm:[3,3,3,3] row_mask:0xf bank_mask:0x4
    s_waitcnt vmcnt(6)
    v_cmp_ne_u32 vcc, 0, v40
    s_nop 0
    s_and_b32 vcc_lo, vcc_lo, 0x0fffffff
    s_bcnt1_i32_b32 s100, vcc_lo
    s_cmp_lt_u32 s100, 18
    s_cselect_b32 s100, -1, 0
    s_mov_b32 vcc_lo, s100
    s_mov_b32 vcc_hi, 0
    s_cbranch_vccz L_pc_136
    s_waitcnt vmcnt(5)
L_pc_136:
    v_mfma_f32_16x16x32_bf16 v[28:31], v[80:83], v[12:15], 0
    buffer_load_dwordx4 v[80:83], v4, s[28:31], s87 offen offset:2304 nt
    s_nop 6
    v_fmac_f32_dpp v49, v28, v7 quad_perm:[0,0,0,0] row_mask:0xf bank_mask:0x8
    s_nop 1
    v_fmac_f32_dpp v49, v29, v7 quad_perm:[1,1,1,1] row_mask:0xf bank_mask:0x8
    s_nop 1
    v_fmac_f32_dpp v49, v30, v7 quad_perm:[2,2,2,2] row_mask:0xf bank_mask:0x8
    s_nop 1
    v_fmac_f32_dpp v49, v31, v7 quad_perm:[3,3,3,3] row_mask:0xf bank_mask:0x8
    v_mfma_f32_16x16x32_bf16 v[28:31], v[52:55], v[12:15], 0
    v_mov_b32_dpp v7, v7 quad_perm:[3,3,3,2] row_mask:0xf bank_mask:0xf
    s_nop 6
    v_fmac_f32_dpp v49, v28, v7 quad_perm:[0,0,0,0] row_mask:0xf bank_mask:0x1
    s_nop 1
    v_fmac_f32_dpp v49, v29, v7 quad_perm:[1,1,1,1] row_mask:0xf bank_mask:0x1
    s_nop 1
    v_fmac_f32_dpp v49, v30, v7 quad_perm:[2,2,2,2] row_mask:0xf bank_mask:0x1
    s_nop 1
    v_fmac_f32_dpp v49, v31, v7 quad_perm:[3,3,3,3] row_mask:0xf bank_mask:0x1
    s_cbranch_vccz L_pc_137
    s_waitcnt vmcnt(5)
L_pc_137:
    v_mov_b32 v52, -1
    v_mov_b32 v53, -1
    s_lshl3_add_u32 s73, s99, s92
    s_add_u32 s73, s73, 4096
    s_mov_b64 exec, 0xffff
    s_cmp_eq_u32 s98, 0
    s_cbranch_scc0 L_st_fill1
    buffer_store_dwordx2 v[52:53], v5, s[36:39], s73 offen
L_str_fill1:
    s_mov_b64 exec, -1
    s_add_u32 s87, s44, 0x4024000
    buffer_load_dwordx4 v[52:55], v4, s[28:31], s87 offen offset:0 nt
    s_waitcnt vmcnt(8)
    s_cbranch_vccz L_pc_138
    s_waitcnt vmcnt(6)
L_pc_138:
    v_mfma_f32_16x16x32_bf16 v[28:31], v[56:59], v[12:15], 0
    buffer_load_dwordx4 v[56:59], v4, s[28:31], s87 offen offset:256 nt
    s_nop 6
    v_fmac_f32_dpp v49, v28, v7 quad_perm:[0,0,0,0] row_mask:0xf bank_mask:0x2
    s_nop 1
    v_fmac_f32_dpp v49, v29, v7 quad_perm:[1,1,1,1] row_mask:0xf bank_mask:0x2
    s_nop 1
    v_fmac_f32_dpp v49, v30, v7 quad_perm:[2,2,2,2] row_mask:0xf bank_mask:0x2
    s_nop 1
    v_fmac_f32_dpp v49, v31, v7 quad_perm:[3,3,3,3] row_mask:0xf bank_mask:0x2
    s_waitcnt vmcnt(8)
    s_cbranch_vccz L_pc_139
    s_waitcnt vmcnt(6)
L_pc_139:
    v_mfma_f32_16x16x32_bf16 v[28:31], v[60:63], v[12:15], 0
    buffer_load_dwordx4 v[60:63], v4, s[28:31], s87 offen offset:2048 nt
    s_nop 6
    v_fmac_f32_dpp v49, v28, v7 quad_perm:[0,0,0,0] row_mask:0xf bank_mask:0x4
    s_nop 1
    v_fmac_f32_dpp v49, v29, v7 quad_perm:[1,1,1,1] row_mask:0xf bank_mask:0x4
    s_nop 1
    v_fmac_f32_dpp v49, v30, v7 quad_perm:[2,2,2,2] row_mask:0xf bank_mask:0x4
    s_nop 1
    v_fmac_f32_dpp v49, v31, v7 quad_perm:[3,3,3,3] row_mask:0xf bank_mask:0x4
    s_waitcnt vmcnt(8)
    s_cbranch_vccz L_pc_140
    s_waitcnt vmcnt(6)
L_pc_140:
    v_mfma_f32_16x16x32_bf16 v[28:31], v[64:67], v[12:15], 0
    buffer_load_dwordx4 v[64:67], v4, s[28:31], s87 offen offset:2304 nt
    s_nop 6
    v_fmac_f32_dpp v49, v28, v7 quad_perm:[0,0,0,0] row_mask:0xf bank_mask:0x8
    s_nop 1
    v_fmac_f32_dpp v49, v29, v7 quad_perm:[1,1,1,1] row_mask:0xf bank_mask:0x8
    s_nop 1
    v_fmac_f32_dpp v49, v30, v7 quad_perm:[2,2,2,2] row_mask:0xf bank_mask:0x8
    s_nop 1
    v_fmac_f32_dpp v49, v31, v7 quad_perm:[3,3,3,3] row_mask:0xf bank_mask:0x8
    s_waitcnt vmcnt(8)
    s_cbranch_vccz L_pc_141
    s_waitcnt vmcnt(6)
L_pc_141:
    v_mfma_f32_16x16x32_bf16 v[28:31], v[68:71], v[12:15], 0
    s_add_u32 s87, s86, 0x4028000
    buffer_load_dwordx4 v[68:71], v4, s[28:31], s87 offen offset:0 nt
    v_mov_b32_dpp v7, v7 quad_perm:[3,2,2,2] row_mask:0xf bank_mask:0xf
    s_nop 4
    v_mul_f32_dpp v50, v28, v7 quad_perm:[0,0,0,0] row_mask:0xf bank_mask:0x1
    s_nop 1
    v_fmac_f32_dpp v50, v29, v7 quad_perm:[1,1,1,1] row_mask:0xf bank_mask:0x1
    s_nop 1
    v_fmac_f32_dpp v50, v30, v7 quad_perm:[2,2,2,2] row_mask:0xf bank_mask:0x1
    s_nop 1
    v_fmac_f32_dpp v50, v31, v7 quad_perm:[3,3,3,3] row_mask:0xf bank_mask:0x1
    s_waitcnt vmcnt(8)
    s_cbranch_vccz L_pc_142
    s_waitcnt vmcnt(6)
L_pc_142:
    v_mfma_f32_16x16x32_bf16 v[28:31], v[72:75], v[12:15], 0
    buffer_load_dwordx4 v[72:75], v4, s[28:31], s87 offen offset:256 nt
    s_nop 6
    v_mul_f32_dpp v50, v28, v7 quad_perm:[0,0,0,0] row_mask:0xf bank_mask:0x2
    s_nop 1
    v_fmac_f32_dpp v50, v29, v7 quad_perm:[1,1,1,1] row_mask:0xf bank_mask:0x2
    s_nop 1
    v_fmac_f32_dpp v50, v30, v7 quad_perm:[2,2,2,2] row_mask:0xf bank_mask:0x2
    s_nop 1
    v_fmac_f32_dpp v50, v31, v7 quad_perm:[3,3,3,3] row_mask:0xf bank_mask:0x2
    s_waitcnt vmcnt(8)
    s_cbranch_vccz L_pc_143
    s_waitcnt vmcnt(5)
L_pc_143:
    v_mfma_f32_16x16x32_bf16 v[28:31], v[76:79], v[12:15], 0
    buffer_load_dwordx4 v[76:79], v4, s[28:31], s87 offen offset:2048 nt
    s_nop 6
    v_mul_f32_dpp v50, v28, v7 quad_perm:[0,0,0,0] row_mask:0xf bank_mask:0x4
    s_nop 1
    v_fmac_f32_dpp v50, v29, v7 quad_perm:[1,1,1,1] row_mask:0xf bank_mask:0x4
    s_nop 1
    v_fmac_f32_dpp v50, v30, v7 quad_perm:[2,2,2,2] row_mask:0xf bank_mask:0x4
    s_nop 1
    v_fmac_f32_dpp v50, v31, v7 quad_perm:[3,3,3,3] row_mask:0xf bank_mask:0x4
    s_waitcnt vmcnt(8)
    s_cbranch_vccz L_pc_144
    s_waitcnt vmcnt(5)
L_pc_144:
    v_mfma_f32_16x16x32_bf16 v[28:31], v[80:83], v[12:15], 0
    buffer_load_dwordx4 v[80:83], v4, s[28:31], s87 offen offset:2304 nt
    s_nop 6
    v_mul_f32_dpp v50, v28, v7 quad_perm:[0,0,0,0] row_mask:0xf bank_mask:0x8
    s_nop 1
    v_fmac_f32_dpp v50, v29, v7 quad_perm:[1,1,1,1] row_mask:0xf bank_mask:0x8
    s_nop 1
    v_fmac_f32_dpp v50, v30, v7 quad_perm:[2,2,2,2] row_mask:0xf bank_mask:0x8
    s_nop 1
    v_fmac_f32_dpp v50, v31, v7 quad_perm:[3,3,3,3] row_mask:0xf bank_mask:0x8
    s_waitcnt vmcnt(7)
    s_cbranch_vccz L_pc_145
    s_waitcnt vmcnt(5)
L_pc_145:
    v_mfma_f32_16x16x32_bf16 v[28:31], v[52:55], v[12:15], 0
    s_add_u32 s87, s44, 0x402c000
    buffer_load_dwordx4 v[52:55], v4, s[28:31], s87 offen offset:0 nt
    v_mov_b32_dpp v7, v7 quad_perm:[1,0,1,1] row_mask:0xf bank_mask:0xf
    s_nop 4
    v_fmac_f32_dpp v50, v28, v7 quad_perm:[0,0,0,0] row_mask:0xf bank_mask:0x1
    s_nop 1
    v_fmac_f32_dpp v50, v29, v7 quad_perm:[1,1,1,1] row_mask:0xf bank_mask:0x1
    s_nop 1
    v_fmac_f32_dpp v50, v30, v7 quad_perm:[2,2,2,2] row_mask:0xf bank_mask:0x1
    s_nop 1
    v_fmac_f32_dpp v50, v31, v7 quad_perm:[3,3,3,3] row_mask:0xf bank_mask:0x1
    s_waitcnt vmcnt(7)
    s_cbranch_vccz L_pc_146
    s_waitcnt vmcnt(5)
L_pc_146:
    v_mfma_f32_16x16x32_bf16 v[28:31], v[56:59], v[12:15], 0
    buffer_load_dwordx4 v[56:59], v4, s[28:31], s87 offen offset:256 nt
    s_add_u32 s73, s89, 0x600
    buffer_load_dwordx4 v[40:43], v6, s[36:39], s73 offen sc1
    s_nop 4
    v_fmac_f32_dpp v50, v28, v7 quad_perm:[0,0,0,0] row_mask:0xf bank_mask:0x2
    s_nop 1
    v_fmac_f32_dpp v50, v29, v7 quad_perm:[1,1,1,1] row_mask:0xf bank_mask:0x2
    s_nop 1
    v_fmac_f32_dpp v50, v30, v7 quad_perm:[2,2,2,2] row_mask:0xf bank_mask:0x2
L_wa9:
    s_cbranch_execz L_wr2
    s_nop 0
    v_fmac_f32_dpp v50, v31, v7 quad_perm:[3,3,3,3] row_mask:0xf bank_mask:0x2
    s_waitcnt vmcnt(8)
    s_cbranch_vccz L_pc_147
    s_waitcnt vmcnt(6)
L_pc_147:
    v_mfma_f32_16x16x32_bf16 v[28:31], v[60:63], v[12:15], 0
    buffer_load_dwordx4 v[60:63], v4, s[28:31], s87 offen offset:2048 nt
    s_nop 6
    v_fmac_f32_dpp v50, v28, v7 quad_perm:[0,0,0,0] row_mask:0xf bank_mask:0x4
    s_nop 1
    v_fmac_f32_dpp v50, v29, v7 quad_perm:[1,1,1,1] row_mask:0xf bank_mask:0x4
    s_nop 1
    v_fmac_f32_dpp v50, v30, v7 quad_perm:[2,2,2,2] row_mask:0xf bank_mask:0x4
    s_nop 1
    v_fmac_f32_dpp v50, v31, v7 quad_perm:[3,3,3,3] row_mask:0xf bank_mask:0x4
    s_waitcnt vmcnt(8)
    s_cbranch_vccz L_pc_148
    s_waitcnt vmcnt(6)
L_pc_148:
    v_mfma_f32_16x16x32_bf16 v[28:31], v[64:67], v[12:15], 0
    buffer_load_dwordx4 v[64:67], v4, s[28:31], s87 offen offset:2304 nt
    s_nop 6
    v_fmac_f32_dpp v50, v28, v7 quad_perm:[0,0,0,0] row_mask:0xf bank_mask:0x8
    s_nop 1
    v_fmac_f32_dpp v50, v29, v7 quad_perm:[1,1,1,1] row_mask:0xf bank_mask:0x8
    s_nop 1
    v_fmac_f32_dpp v50, v30, v7 quad_perm:[2,2,2,2] row_mask:0xf bank_mask:0x8
    s_nop 1
    v_fmac_f32_dpp v50, v31, v7 quad_perm:[3,3,3,3] row_mask:0xf bank_mask:0x8
    s_waitcnt vmcnt(8)
    s_cbranch_vccz L_pc_149
    s_waitcnt vmcnt(6)
L_pc_149:
    v_mfma_f32_16x16x32_bf16 v[28:31], v[68:71], v[12:15], 0
    s_add_u32 s87, s86, 0x4030000
    buffer_load_dwordx4 v[68:71], v4, s[28:31], s87 offen offset:0 nt
    v_mov_b32_dpp v7, v7 quad_perm:[0,0,1,0] row_mask:0xf bank_mask:0xf
    s_nop 4
    v_fmac_f32_dpp v50, v28, v7 quad_perm:[0,0,0,0] row_mask:0xf bank_mask:0x1
    s_nop 1
    v_fmac_f32_dpp v50, v29, v7 quad_perm:[1,1,1,1] row_mask:0xf bank_mask:0x1
    s_nop 1
    v_fmac_f32_dpp v50, v30, v7 quad_perm:[2,2,2,2] row_mask:0xf bank_mask:0x1
    s_nop 1
    v_fmac_f32_dpp v50, v31, v7 quad_perm:[3,3,3,3] row_mask:0xf bank_mask:0x1
    s_waitcnt vmcnt(8)
    s_cbranch_vccz L_pc_150
    s_waitcnt vmcnt(6)
L_pc_150:
    v_mfma_f32_16x16x32_bf16 v[28:31], v[72:75], v[12:15], 0
    buffer_load_dwordx4 v[72:75], v4, s[28:31], s87 offen offset:256 nt
    s_nop 6
    v_fmac_f32_dpp v50, v28, v7 quad_perm:[0,0,0,0] row_mask:0xf bank_mask:0x2
    s_nop 1
    v_fmac_f32_dpp v50, v29, v7 quad_perm:[1,1,1,1] row_mask:0xf bank_mask:0x2
    s_nop 1
    v_fmac_f32_dpp v50, v30, v7 quad_perm:[2,2,2,2] row_mask:0xf bank_mask:0x2
    s_nop 1
    v_fmac_f32_dpp v50, v31, v7 quad_perm:[3,3,3,3] row_mask:0xf bank_mask:0x2
    s_waitcnt vmcnt(8)
    s_cbranch_vccz L_pc_151
    s_waitcnt vmcnt(6)
L_pc_151:
    v_mfma_f32_16x16x32_bf16 v[28:31], v[76:79], v[12:15], 0
    buffer_load_dwordx4 v[76:79], v4, s[28:31], s87 offen offset:2048 nt
    s_nop 6
    v_fmac_f32_dpp v50, v28, v7 quad_perm:[0,0,0,0] row_mask:0xf bank_mask:0x4
    s_nop 1
    v_fmac_f32_dpp v50, v29, v7 quad_perm:[1,1,1,1] row_mask:0xf bank_mask:0x4
    s_nop 1
    v_fmac_f32_dpp v50, v30, v7 quad_perm:[2,2,2,2] row_mask:0xf bank_mask:0x4
    s_nop 1
    v_fmac_f32_dpp v50, v31, v7 quad_perm:[3,3,3,3] row_mask:0xf bank_mask:0x4
    s_waitcnt vmcnt(8)
    s_cbranch_vccz L_pc_152
    s_waitcnt vmcnt(6)
L_pc_152:
    v_mfma_f32_16x16x32_bf16 v[28:31], v[80:83], v[12:15], 0
    buffer_load_dwordx4 v[80:83], v4, s[28:31], s87 offen offset:2304 nt
    s_nop 6
    v_fmac_f32_dpp v50, v28, v7 quad_perm:[0,0,0,0] row_mask:0xf bank_mask:0x8
    s_nop 1
    v_fmac_f32_dpp v50, v29, v7 quad_perm:[1,1,1,1] row_mask:0xf bank_mask:0x8
    s_nop 1
    v_fmac_f32_dpp v50, v30, v7 quad_perm:[2,2,2,2] row_mask:0xf bank_mask:0x8
    s_nop 1
    v_fmac_f32_dpp v50, v31, v7 quad_perm:[3,3,3,3] row_mask:0xf bank_mask:0x8
M_j2:
    s_mov_b32 s56, 0x000f000f
    s_mov_b32 s57, 0x000f000f
    s_mov_b32 s64, 0x00030003
    s_mov_b32 s65, 0x00030003
    s_mov_b32 s58, 0x00f000f0
    s_mov_b32 s59, 0x00f000f0
    s_mov_b32 s66, 0x000c000c
    s_mov_b32 s67, 0x000c000c
    s_mov_b32 s60, 0x0f000f00
    s_mov_b32 s61, 0x0f000f00
    s_mov_b32 s68, 0x00300030
    s_mov_b32 s69, 0x00300030
    s_mov_b32 s62, 0xf000f000
    s_mov_b32 s63, 0xf000f000
    s_mov_b32 s70, 0x00c000c0
    s_mov_b32 s71, 0x00c000c0
    s_mov_b32 s80, 0xffff
    s_waitcnt vmcnt(6)
L_qc_153:
    v_max3_u32 v28, v40, v41, v42
    v_max_u32 v28, v28, v43
    v_cmp_eq_u32 vcc, -1, v28
    s_nop 4
    s_cbranch_vccz L_qok_154
    s_add_u32 s73, s89, 0x600
    buffer_load_dwordx4 v[40:43], v6, s[36:39], s73 offen sc1
    s_waitcnt vmcnt(0)
    s_sub_u32 s72, s72, 1
    s_cbranch_scc0 L_qc_153
    s_endpgm
L_qok_154:
    s_add_u32 s90, s92, 0x1000
    s_add_u32 s91, s93, 0x40
    s_mov_b64 vcc, -1
    v_cndmask_b32 v12, 0, v40, s[56:57]
    v_cndmask_b32 v13, 0, v41, s[56:57]
    v_cndmask_b32 v14, 0, v42, s[56:57]
    v_cndmask_b32 v15, 0, v43, s[56:57]
    s_nop 1
    v_mfma_f32_16x16x32_bf16 v[28:31], a[0:3], v[12:15], 0
    v_accvgpr_write_b32 a0, v32
    v_accvgpr_write_b32 a1, v33
    v_accvgpr_write_b32 a2, v34
    v_accvgpr_write_b32 a3, v35
    v_mfma_f32_16x16x32_bf16 v[32:35], a[16:19], v[12:15], 0
    v_accvgpr_write_b32 a16, v16
    v_accvgpr_write_b32 a17, v17
    v_accvgpr_write_b32 a18, v18
    v_accvgpr_write_b32 a19, v19
    v_cndmask_b32 v16, 0, v40, s[58:59]
    v_cndmask_b32 v17, 0, v41, s[58:59]
    v_cndmask_b32 v18, 0, v42, s[58:59]
    v_cndmask_b32 v19, 0, v43, s[58:59]
L_wa10:
    s_cbranch_execz L_wr2
    s_nop 0
    v_mfma_f32_16x16x32_bf16 v[28:31], a[4:7], v[16:19], v[28:31]
    v_accvgpr_write_b32 a4, v20
    v_accvgpr_write_b32 a5, v21
    v_accvgpr_write_b32 a6, v22
    v_accvgpr_write_b32 a7, v23
    v_cndmask_b32 v20, 0, v40, s[60:61]
    v_cndmask_b32 v21, 0, v41, s[60:61]
    v_cndmask_b32 v22, 0, v42, s[60:61]
    v_cndmask_b32 v23, 0, v43, s[60:61]
    v_mfma_f32_16x16x32_bf16 v[32:35], a[20:23], v[16:19], v[32:35]
    v_accvgpr_write_b32 a20, v24
    v_accvgpr_write_b32 a21, v25
    v_accvgpr_write_b32 a22, v26
    v_accvgpr_write_b32 a23, v27
    v_cndmask_b32 v24, 0, v40, s[62:63]
    v_cndmask_b32 v25, 0, v41, s[62:63]
    v_cndmask_b32 v26, 0, v42, s[62:63]
    v_cndmask_b32 v27, 0, v43, s[62:63]
    v_mfma_f32_16x16x32_bf16 v[28:31], a[8:11], v[20:23], v[28:31]
    v_accvgpr_write_b32 a8, v36
    v_accvgpr_write_b32 a9, v37
    v_accvgpr_write_b32 a10, v38
    v_accvgpr_write_b32 a11, v39
    v_mfma_f32_16x16x32_bf16 v[32:35], a[24:27], v[20:23], v[32:35]
    v_accvgpr_write_b32 a24, v44
    v_accvgpr_write_b32 a25, v45
    v_accvgpr_write_b32 a26, v46
    v_accvgpr_write_b32 a27, v47
    v_mfma_f32_16x16x32_bf16 v[28:31], a[12:15], v[24:27], v[28:31]
    v_accvgpr_write_b32 a12, v8
    v_accvgpr_write_b32 a13, v9
    v_accvgpr_write_b32 a14, v10
    v_accvgpr_write_b32 a15, v11
    v_mov_b32_dpp v8, v7 quad_perm:[3,2,3,3] row_mask:0xf bank_mask:0xf
    v_mov_b32_dpp v9, v7 quad_perm:[3,3,2,3] row_mask:0xf bank_mask:0xf
    v_mov_b32_dpp v10, v7 quad_perm:[3,3,3,2] row_mask:0xf bank_mask:0xf
    v_mov_b32_dpp v7, v7 quad_perm:[2,3,3,3] row_mask:0xf bank_mask:0xf
    v_lshl_add_u32 v11, v5, 1, s88
    v_mfma_f32_16x16x32_bf16 v[32:35], a[28:31], v[24:27], v[32:35]
    v_accvgpr_write_b32 a28, v0
    v_accvgpr_write_b32 a29, v1
    v_accvgpr_write_b32 a30, v2
    v_accvgpr_write_b32 a31, v3
    v_lshlrev_b32 v1, 1, v5
    v_and_b32 v0, 16, v1
    v_lshlrev_b32 v0, v0, s80
    v_cndmask_b32 v44, 0, v0, s[64:65]
    v_cndmask_b32 v45, 0, v0, s[66:67]
    v_cndmask_b32 v46, 0, v0, s[68:69]
    v_cndmask_b32 v47, 0, v0, s[70:71]
    v_mov_b32 v0, 0xff800000
    s_nop 1
    s_branch L_p2b
    s_endpgm
    s_endpgm
    s_endpgm
    s_endpgm
L_p2b:
    s_nop 0
    v_mfma_f32_16x16x32_bf16 v[36:39], a[192:195], v[12:15], 0
    s_nop 0
    s_nop 0
    v_mfma_f32_16x16x32_bf16 v[36:39], a[196:199], v[16:19], v[36:39]
    v_mul_f32_dpp v40, v28, v7 quad_perm:[0,0,0,0] row_mask:0xf bank_mask:0xf
    s_nop 0
    v_mfma_f32_16x16x32_bf16 v[36:39], a[200:203], v[20:23], v[36:39]
    v_fmac_f32_dpp v40, v29, v7 quad_perm:[1,1,1,1] row_mask:0xf bank_mask:0xf
    s_nop 0
    v_mfma_f32_16x16x32_bf16 v[36:39], a[204:207], v[24:27], v[36:39]
    v_fmac_f32_dpp v40, v30, v7 quad_perm:[2,2,2,2] row_mask:0xf bank_mask:0xf
    s_nop 0
    s_nop 0
    v_fmac_f32_dpp v40, v31, v7 quad_perm:[3,3,3,3] row_mask:0xf bank_mask:0xf
    v_mfma_f32_16x16x32_bf16 v[28:31], a[144:147], v[12:15], 0
    s_cbranch_vccnz L_sk_155o
L_sk_155:
    v_fmac_f32_dpp v40, v32, v8 quad_perm:[0,0,0,0] row_mask:0xf bank_mask:0xf
    v_mfma_f32_16x16x32_bf16 v[28:31], a[148:151], v[16:19], v[28:31]
    v_mul_f32_dpp v43, v36, v9 quad_perm:[0,0,0,0] row_mask:0xf bank_mask:0xf
    v_fmac_f32_dpp v40, v33, v8 quad_perm:[1,1,1,1] row_mask:0xf bank_mask:0xf
    v_mfma_f32_16x16x32_bf16 v[28:31], a[152:155], v[20:23], v[28:31]
    ds_read_b128 a[144:147], v11 offset:38912
    v_fmac_f32_dpp v40, v34, v8 quad_perm:[2,2,2,2] row_mask:0xf bank_mask:0xf
    v_mfma_f32_16x16x32_bf16 v[28:31], a[156:159], v[24:27], v[28:31]
    v_fmac_f32_dpp v43, v37, v9 quad_perm:[1,1,1,1] row_mask:0xf bank_mask:0xf
    v_fmac_f32_dpp v40, v35, v8 quad_perm:[3,3,3,3] row_mask:0xf bank_mask:0xf
    v_mfma_f32_16x16x32_bf16 v[32:35], a[208:211], v[12:15], 0
    ds_read_b128 a[152:155], v11 offset:32768
    v_fmac_f32_dpp v43, v38, v9 quad_perm:[2,2,2,2] row_mask:0xf bank_mask:0xf
    v_mfma_f32_16x16x32_bf16 v[32:35], a[212:215], v[16:19], v[32:35]
    ds_read_b128 a[156:159], v11 offset:33792
    v_fmac_f32_dpp v43, v39, v9 quad_perm:[3,3,3,3] row_mask:0xf bank_mask:0xf
    v_mfma_f32_16x16x32_bf16 v[32:35], a[216:219], v[20:23], v[32:35]
    v_mul_f32_dpp v42, v28, v8 quad_perm:[0,0,0,0] row_mask:0xf bank_mask:0xf
    s_nop 0
    v_mfma_f32_16x16x32_bf16 v[32:35], a[220:223], v[24:27], v[32:35]
    v_fmac_f32_dpp v42, v29, v8 quad_perm:[1,1,1,1] row_mask:0xf bank_mask:0xf
    s_nop 0
    v_mfma_f32_16x16x32_bf16 v[36:39], v[84:87], v[12:15], 0
    s_cbranch_vccnz L_sk_156o
L_sk_156:
    v_fmac_f32_dpp v42, v30, v8 quad_perm:[2,2,2,2] row_mask:0xf bank_mask:0xf
    v_mfma_f32_16x16x32_bf16 v[36:39], v[88:91], v[16:19], v[36:39]
    v_mov_b64 v[84:85], 0
    v_fmac_f32_dpp v42, v31, v8 quad_perm:[3,3,3,3] row_mask:0xf bank_mask:0xf
    v_mfma_f32_16x16x32_bf16 v[36:39], v[92:95], v[20:23], v[36:39]
    v_fmac_f32_dpp v43, v32, v10 quad_perm:[0,0,0,0] row_mask:0xf bank_mask:0xf
    v_mov_b64 v[86:87], 0
    v_mfma_f32_16x16x32_bf16 v[36:39], v[96:99], v[24:27], v[36:39]
    v_fmac_f32_dpp v43, v33, v10 quad_perm:[1,1,1,1] row_mask:0xf bank_mask:0xf
    v_mov_b64 v[88:89], 0
    v_mfma_f32_16x16x32_bf16 v[28:31], a[240:243], v[12:15], 0
    v_fmac_f32_dpp v43, v34, v10 quad_perm:[2,2,2,2] row_mask:0xf bank_mask:0xf
    v_mov_b64 v[90:91], 0
    v_mfma_f32_16x16x32_bf16 v[28:31], a[244:247], v[16:19], v[28:31]
    v_fmac_f32_dpp v43, v35, v10 quad_perm:[3,3,3,3] row_mask:0xf bank_mask:0xf
    v_mov_b64 v[92:93], 0
    v_mfma_f32_16x16x32_bf16 v[28:31], a[248:251], v[20:23], v[28:31]
    v_fmac_f32_dpp v43, v36, v7 quad_perm:[0,0,0,0] row_mask:0xf bank_mask:0xf
    v_mov_b64 v[94:95], 0
    v_mfma_f32_16x16x32_bf16 v[28:31], a[252:255], v[24:27], v[28:31]
    v_fmac_f32_dpp v43, v37, v7 quad_perm:[1,1,1,1] row_mask:0xf bank_mask:0xf
    s_nop 0
    v_mfma_f32_16x16x32_bf16 v[32:35], v[100:103], v[12:15], 0
    v_fmac_f32_dpp v43, v38, v7 quad_perm:[2,2,2,2] row_mask:0xf bank_mask:0xf
    s_nop 0
    v_mfma_f32_16x16x32_bf16 v[32:35], v[104:107], v[16:19], v[32:35]
    v_fmac_f32_dpp v43, v39, v7 quad_perm:[3,3,3,3] row_mask:0xf bank_mask:0xf
    v_mov_b64 v[100:101], 0
    v_mfma_f32_16x16x32_bf16 v[32:35], v[108:111], v[20:23], v[32:35]
    v_mul_f32_dpp v2, v28, v8 quad_perm:[0,0,0,0] row_mask:0xf bank_mask:0xf
    v_mov_b64 v[102:103], 0
    v_mfma_f32_16x16x32_bf16 v[32:35], v[112:115], v[24:27], v[32:35]
    v_fmac_f32_dpp v2, v29, v8 quad_perm:[1,1,1,1] row_mask:0xf bank_mask:0xf
    v_mov_b64 v[104:105], 0
    v_mfma_f32_16x16x32_bf16 v[36:39], v[116:119], v[12:15], 0
    v_fmac_f32_dpp v2, v30, v8 quad_perm:[2,2,2,2] row_mask:0xf bank_mask:0xf
    v_mov_b64 v[106:107], 0
    s_nop 0
    v_fmac_f32_dpp v2, v31, v8 quad_perm:[3,3,3,3] row_mask:0xf bank_mask:0xf
    v_mfma_f32_16x16x32_bf16 v[28:31], a[224:227], v[12:15], 0
    v_fmac_f32_dpp v43, v32, v8 quad_perm:[0,0,0,0] row_mask:0xf bank_mask:0xf
    v_bfe_u32 v117, v1, 4, 2
    v_mfma_f32_16x16x32_bf16 v[28:31], a[228:231], v[16:19], v[28:31]
    v_fmac_f32_dpp v43, v33, v8 quad_perm:[1,1,1,1] row_mask:0xf bank_mask:0xf
    v_fmac_f32_dpp v2, v36, v9 quad_perm:[0,0,0,0] row_mask:0xf bank_mask:0xf
    v_mfma_f32_16x16x32_bf16 v[28:31], a[232:235], v[20:23], v[28:31]
    v_fmac_f32_dpp v43, v34, v8 quad_perm:[2,2,2,2] row_mask:0xf bank_mask:0xf
    v_fmac_f32_dpp v2, v37, v9 quad_perm:[1,1,1,1] row_mask:0xf bank_mask:0xf
    v_mfma_f32_16x16x32_bf16 v[28:31], a[236:239], v[24:27], v[28:31]
    v_fmac_f32_dpp v43, v35, v8 quad_perm:[3,3,3,3] row_mask:0xf bank_mask:0xf
    v_fmac_f32_dpp v2, v38, v9 quad_perm:[2,2,2,2] row_mask:0xf bank_mask:0xf
    v_mfma_f32_16x16x32_bf16 v[32:35], a[32:35], v[12:15], 0
L_wa11:
    s_cbranch_execz L_wr2
    s_cbranch_vccnz L_sk_157o
L_sk_157:
    v_fmac_f32_dpp v2, v39, v9 quad_perm:[3,3,3,3] row_mask:0xf bank_mask:0xf
    v_mfma_f32_16x16x32_bf16 v[32:35], a[36:39], v[16:19], v[32:35]
    ds_read_b128 a[32:35], v11 offset:34816
    v_mul_u32_u24 v117, 0x4444, v117
    v_mfma_f32_16x16x32_bf16 v[32:35], a[40:43], v[20:23], v[32:35]
    ds_read_b128 a[36:39], v11 offset:35840
    v_fmac_f32_dpp v2, v28, v7 quad_perm:[0,0,0,0] row_mask:0xf bank_mask:0xf
    v_mfma_f32_16x16x32_bf16 v[32:35], a[44:47], v[24:27], v[32:35]
    ds_read_b128 a[40:43], v11 offset:36864
    v_fmac_f32_dpp v2, v29, v7 quad_perm:[1,1,1,1] row_mask:0xf bank_mask:0xf
    v_mfma_f32_16x16x32_bf16 v[36:39], a[48:51], v[12:15], 0
    ds_read_b128 a[44:47], v11 offset:37888
    v_fmac_f32_dpp v2, v30, v7 quad_perm:[2,2,2,2] row_mask:0xf bank_mask:0xf
    v_mfma_f32_16x16x32_bf16 v[36:39], a[52:55], v[16:19], v[36:39]
    ds_read_b128 a[48:51], v11 offset:0
    v_fmac_f32_dpp v2, v31, v7 quad_perm:[3,3,3,3] row_mask:0xf bank_mask:0xf
    v_mfma_f32_16x16x32_bf16 v[36:39], a[56:59], v[20:23], v[36:39]
    v_cndmask_b32 v2, v0, v2, s[78:79]
    v_fmac_f32_dpp v40, v32, v9 quad_perm:[0,0,0,0] row_mask:0xf bank_mask:0xf
    v_mfma_f32_16x16x32_bf16 v[36:39], a[60:63], v[24:27], v[36:39]
    v_max3_f32 v118, v43, v2, v43
    v_fmac_f32_dpp v40, v33, v9 quad_perm:[1,1,1,1] row_mask:0xf bank_mask:0xf
    v_mfma_f32_16x16x32_bf16 v[28:31], a[64:67], v[12:15], 0
    v_max_f32_dpp v118, v118, v118 quad_perm:[1,0,3,2] row_mask:0xf bank_mask:0xf
    v_fmac_f32_dpp v40, v34, v9 quad_perm:[2,2,2,2] row_mask:0xf bank_mask:0xf
    v_mfma_f32_16x16x32_bf16 v[28:31], a[68:71], v[16:19], v[28:31]
    v_max_f32_dpp v118, v118, v118 quad_perm:[2,3,0,1] row_mask:0xf bank_mask:0xf
    v_fmac_f32_dpp v40, v35, v9 quad_perm:[3,3,3,3] row_mask:0xf bank_mask:0xf
    v_mfma_f32_16x16x32_bf16 v[28:31], a[72:75], v[20:23], v[28:31]
    v_max_f32_dpp v118, v118, v118 row_ror:4 row_mask:0xf bank_mask:0xf
    v_fmac_f32_dpp v40, v36, v10 quad_perm:[0,0,0,0] row_mask:0xf bank_mask:0xf
    v_mfma_f32_16x16x32_bf16 v[28:31], a[76:79], v[24:27], v[28:31]
    v_max_f32_dpp v118, v118, v118 row_ror:8 row_mask:0xf bank_mask:0xf
    v_fmac_f32_dpp v40, v37, v10 quad_perm:[1,1,1,1] row_mask:0xf bank_mask:0xf
    v_mfma_f32_16x16x32_bf16 v[32:35], a[128:131], v[12:15], 0
    v_max_f32_dpp v118, v118, v118 row_bcast:15 row_mask:0xa bank_mask:0xf
    v_fmac_f32_dpp v40, v38, v10 quad_perm:[2,2,2,2] row_mask:0xf bank_mask:0xf
    v_mfma_f32_16x16x32_bf16 v[32:35], a[132:135], v[16:19], v[32:35]
    v_max_f32_dpp v118, v118, v118 row_bcast:31 row_mask:0xc bank_mask:0xf
    v_fmac_f32_dpp v40, v39, v10 quad_perm:[3,3,3,3] row_mask:0xf bank_mask:0xf
    v_mfma_f32_16x16x32_bf16 v[32:35], a[136:139], v[20:23], v[32:35]
    v_mul_f32_dpp v41, v28, v7 quad_perm:[0,0,0,0] row_mask:0xf bank_mask:0xf
    v_readlane_b32 s73, v118, 63
    v_mfma_f32_16x16x32_bf16 v[32:35], a[140:143], v[24:27], v[32:35]
    v_fmac_f32_dpp v41, v29, v7 quad_perm:[1,1,1,1] row_mask:0xf bank_mask:0xf
    v_subrev_f32 v2, s73, v2
    v_mfma_f32_16x16x32_bf16 v[36:39], a[80:83], v[12:15], 0
    v_fmac_f32_dpp v41, v30, v7 quad_perm:[2,2,2,2] row_mask:0xf bank_mask:0xf
    v_exp_f32 v2, v2
    v_mfma_f32_16x16x32_bf16 v[36:39], a[84:87], v[16:19], v[36:39]
    v_fmac_f32_dpp v41, v31, v7 quad_perm:[3,3,3,3] row_mask:0xf bank_mask:0xf
    v_cvt_pk_bf16_f32 v2, 0, v2
    v_mfma_f32_16x16x32_bf16 v[36:39], a[88:91], v[20:23], v[36:39]
    v_fmac_f32_dpp v42, v32, v7 quad_perm:[0,0,0,0] row_mask:0xf bank_mask:0xf
    v_mov_b32_dpp v116, v2 row_half_mirror row_mask:0xf bank_mask:0xf
    v_mfma_f32_16x16x32_bf16 v[36:39], a[92:95], v[24:27], v[36:39]
    v_fmac_f32_dpp v42, v33, v7 quad_perm:[1,1,1,1] row_mask:0xf bank_mask:0xf
    v_lshrrev_b32 v0, 16, v2
    v_mfma_f32_16x16x32_bf16 v[28:31], a[96:99], v[12:15], 0
    v_fmac_f32_dpp v42, v34, v7 quad_perm:[2,2,2,2] row_mask:0xf bank_mask:0xf
    v_or_b32 v0, v0, v2
    v_mfma_f32_16x16x32_bf16 v[28:31], a[100:103], v[16:19], v[28:31]
    v_fmac_f32_dpp v42, v35, v7 quad_perm:[3,3,3,3] row_mask:0xf bank_mask:0xf
    v_and_b32_dpp v108, v0, v44 row_newbcast:2 row_mask:0xf bank_mask:0xf
    v_mfma_f32_16x16x32_bf16 v[28:31], a[104:107], v[20:23], v[28:31]
    v_fmac_f32_dpp v41, v36, v8 quad_perm:[0,0,0,0] row_mask:0xf bank_mask:0xf
    v_and_b32_dpp v109, v0, v45 row_newbcast:2 row_mask:0xf bank_mask:0xf
    v_mfma_f32_16x16x32_bf16 v[28:31], a[108:111], v[24:27], v[28:31]
    v_fmac_f32_dpp v41, v37, v8 quad_perm:[1,1,1,1] row_mask:0xf bank_mask:0xf
    v_and_b32_dpp v110, v0, v46 row_newbcast:2 row_mask:0xf bank_mask:0xf
    v_mfma_f32_16x16x32_bf16 v[32:35], a[160:163], v[12:15], 0
    v_fmac_f32_dpp v41, v38, v8 quad_perm:[2,2,2,2] row_mask:0xf bank_mask:0xf
    v_and_b32_dpp v111, v0, v47 row_newbcast:2 row_mask:0xf bank_mask:0xf
    s_waitcnt lgkmcnt(7)
    s_nop 0
    v_mfma_f32_16x16x32_bf16 v[96:99], v[108:111], a[144:147], 0
    ds_read_b128 a[52:55], v11 offset:1024
    ds_read_b128 a[56:59], v11 offset:2048
    s_cbranch_vccnz L_sk_158o
L_sk_158:
    v_mov_b32_dpp v84, v2 quad_perm:[0,0,0,0] row_mask:0xf bank_mask:0x5
    v_mfma_f32_16x16x32_bf16 v[32:35], a[164:167], v[16:19], v[32:35]
    v_fmac_f32_dpp v41, v39, v8 quad_perm:[3,3,3,3] row_mask:0xf bank_mask:0xf
    v_subrev_f32 v43, s73, v43
    v_mfma_f32_16x16x32_bf16 v[32:35], a[168:171], v[20:23], v[32:35]
    v_fmac_f32_dpp v41, v28, v9 quad_perm:[0,0,0,0] row_mask:0xf bank_mask:0xf
    v_exp_f32 v43, v43
    v_mfma_f32_16x16x32_bf16 v[32:35], a[172:175], v[24:27], v[32:35]
    v_fmac_f32_dpp v41, v29, v9 quad_perm:[1,1,1,1] row_mask:0xf bank_mask:0xf
    v_cvt_pk_bf16_f32 v43, 0, v43
    v_mfma_f32_16x16x32_bf16 v[36:39], a[112:115], v[12:15], 0
    v_fmac_f32_dpp v41, v30, v9 quad_perm:[2,2,2,2] row_mask:0xf bank_mask:0xf
    v_mov_b32_dpp v115, v43 row_half_mirror row_mask:0xf bank_mask:0xf
    v_mfma_f32_16x16x32_bf16 v[36:39], a[116:119], v[16:19], v[36:39]
    v_fmac_f32_dpp v41, v31, v9 quad_perm:[3,3,3,3] row_mask:0xf bank_mask:0xf
    v_add_f32 v119, v2, v43
    v_mfma_f32_16x16x32_bf16 v[36:39], a[120:123], v[20:23], v[36:39]
    v_fmac_f32_dpp v42, v32, v9 quad_perm:[0,0,0,0] row_mask:0xf bank_mask:0xf
    v_mov_b32 v118, s73
    v_mfma_f32_16x16x32_bf16 v[36:39], a[124:127], v[24:27], v[36:39]
    v_fmac_f32_dpp v42, v33, v9 quad_perm:[1,1,1,1] row_mask:0xf bank_mask:0xf
    v_max_f32 v0, s73, v40
    v_mfma_f32_16x16x32_bf16 v[28:31], a[176:179], v[12:15], 0
    v_fmac_f32_dpp v42, v34, v9 quad_perm:[2,2,2,2] row_mask:0xf bank_mask:0xf
    v_mov_b32_dpp v85, v116 quad_perm:[3,3,3,3] row_mask:0xf bank_mask:0xa
    v_mfma_f32_16x16x32_bf16 v[28:31], a[180:183], v[16:19], v[28:31]
    v_fmac_f32_dpp v42, v35, v9 quad_perm:[3,3,3,3] row_mask:0xf bank_mask:0xf
    v_mov_b32_dpp v86, v116 quad_perm:[3,3,3,3] row_mask:0xf bank_mask:0x5
    v_mfma_f32_16x16x32_bf16 v[28:31], a[184:187], v[20:23], v[28:31]
    v_fmac_f32_dpp v41, v36, v10 quad_perm:[0,0,0,0] row_mask:0xf bank_mask:0xf
    v_mov_b32_dpp v87, v2 quad_perm:[0,0,0,0] row_mask:0xf bank_mask:0xa
    v_mfma_f32_16x16x32_bf16 v[28:31], a[188:191], v[24:27], v[28:31]
    v_fmac_f32_dpp v41, v37, v10 quad_perm:[1,1,1,1] row_mask:0xf bank_mask:0xf
    v_mov_b32_dpp v88, v2 quad_perm:[1,1,1,1] row_mask:0xf bank_mask:0x5
    v_smfmac_f32_16x16x64_bf16 v[96:99], v[84:87], v[224:231], v117
    ds_read_b128 a[60:63], v11 offset:3072
    v_fmac_f32_dpp v41, v38, v10 quad_perm:[2,2,2,2] row_mask:0xf bank_mask:0xf
    v_mov_b32_dpp v89, v116 quad_perm:[2,2,2,2] row_mask:0xf bank_mask:0xa
    v_mov_b32_dpp v90, v116 quad_perm:[2,2,2,2] row_mask:0xf bank_mask:0x5
    v_fmac_f32_dpp v41, v39, v10 quad_perm:[3,3,3,3] row_mask:0xf bank_mask:0xf
    v_smfmac_f32_16x16x64_bf16 v[100:103], v[84:87], v[232:239], v117
    ds_read_b128 a[64:67], v11 offset:4096
    ds_read_b128 a[68:71], v11 offset:5120
    v_fmac_f32_dpp v42, v28, v10 quad_perm:[0,0,0,0] row_mask:0xf bank_mask:0xf
    v_mov_b32_dpp v91, v2 quad_perm:[1,1,1,1] row_mask:0xf bank_mask:0xa
    v_mov_b32_dpp v92, v43 quad_perm:[0,0,0,0] row_mask:0xf bank_mask:0x5
    v_fmac_f32_dpp v42, v29, v10 quad_perm:[1,1,1,1] row_mask:0xf bank_mask:0xf
    v_smfmac_f32_16x16x64_bf16 v[96:99], v[88:91], v[240:247], v117
    ds_read_b128 a[72:75], v11 offset:6144
    v_fmac_f32_dpp v42, v30, v10 quad_perm:[2,2,2,2] row_mask:0xf bank_mask:0xf
    v_mov_b32_dpp v93, v115 quad_perm:[3,3,3,3] row_mask:0xf bank_mask:0xa
    v_mov_b32_dpp v94, v115 quad_perm:[3,3,3,3] row_mask:0xf bank_mask:0x5
    v_fmac_f32_dpp v42, v31, v10 quad_perm:[3,3,3,3] row_mask:0xf bank_mask:0xf
    v_smfmac_f32_16x16x64_bf16 v[100:103], v[88:91], v[248:255], v117
    ds_read_b128 a[76:79], v11 offset:7168
    s_waitcnt lgkmcnt(7)
    ds_read_b128 a[128:131], v11 offset:8192
    v_max3_f32 v26, v41, v42, v0
    v_mov_b32_dpp v95, v43 quad_perm:[0,0,0,0] row_mask:0xf bank_mask:0xa
    v_mov_b32_dpp v84, v43 quad_perm:[1,1,1,1] row_mask:0xf bank_mask:0x5
    v_max_f32_dpp v26, v26, v26 quad_perm:[1,0,3,2] row_mask:0xf bank_mask:0xf
    v_smfmac_f32_16x16x64_bf16 v[96:99], v[92:95], v[160:167], v117
L_wa12:
    s_cbranch_execz L_wr3
    ds_read_b128 a[132:135], v11 offset:9216
    v_max_f32_dpp v26, v26, v26 quad_perm:[2,3,0,1] row_mask:0xf bank_mask:0xf
    v_mov_b32_dpp v85, v115 quad_perm:[2,2,2,2] row_mask:0xf bank_mask:0xa
    v_mov_b32_dpp v86, v115 quad_perm:[2,2,2,2] row_mask:0xf bank_mask:0x5
    v_max_f32_dpp v26, v26, v26 row_ror:4 row_mask:0xf bank_mask:0xf
    v_smfmac_f32_16x16x64_bf16 v[100:103], v[92:95], v[168:175], v117
    ds_read_b128 a[136:139], v11 offset:10240
    ds_read_b128 a[140:143], v11 offset:11264
    v_max_f32_dpp v26, v26, v26 row_ror:8 row_mask:0xf bank_mask:0xf
    v_mov_b32_dpp v87, v43 quad_perm:[1,1,1,1] row_mask:0xf bank_mask:0xa
    v_mov_b32_dpp v88, v43 quad_perm:[2,2,2,2] row_mask:0xf bank_mask:0x5
    v_max_f32_dpp v26, v26, v26 row_bcast:15 row_mask:0xa bank_mask:0xf
    v_smfmac_f32_16x16x64_bf16 v[96:99], v[84:87], v[176:183], v117
    ds_read_b128 a[80:83], v11 offset:12288
    v_max_f32_dpp v26, v26, v26 row_bcast:31 row_mask:0xc bank_mask:0xf
    v_mov_b32_dpp v89, v115 quad_perm:[1,1,1,1] row_mask:0xf bank_mask:0xa
    v_mov_b32_dpp v90, v115 quad_perm:[1,1,1,1] row_mask:0xf bank_mask:0x5
    v_readlane_b32 s74, v26, 63
    v_smfmac_f32_16x16x64_bf16 v[100:103], v[84:87], v[184:191], v117
    ds_read_b128 a[84:87], v11 offset:13312
    ds_read_b128 a[88:91], v11 offset:14336
    v_subrev_f32 v42, s74, v42
    v_mov_b32_dpp v91, v43 quad_perm:[2,2,2,2] row_mask:0xf bank_mask:0xa
    v_mov_b32_dpp v92, v43 quad_perm:[3,3,3,3] row_mask:0xf bank_mask:0x5
    v_exp_f32 v42, v42
    v_smfmac_f32_16x16x64_bf16 v[96:99], v[88:91], v[192:199], v117
    s_waitcnt lgkmcnt(7)
    ds_read_b128 a[92:95], v11 offset:15360
    v_cvt_pk_bf16_f32 v42, 0, v42
    v_mov_b32_dpp v93, v115 quad_perm:[0,0,0,0] row_mask:0xf bank_mask:0xa
    v_mov_b32_dpp v94, v115 quad_perm:[0,0,0,0] row_mask:0xf bank_mask:0x5
    v_mov_b32_dpp v114, v42 row_half_mirror row_mask:0xf bank_mask:0xf
    v_smfmac_f32_16x16x64_bf16 v[100:103], v[88:91], v[200:207], v117
    ds_read_b128 a[96:99], v11 offset:16384
    ds_read_b128 a[100:103], v11 offset:17408
    v_mov_b32 v25, s99
    v_and_b32 v24, 0x30, v1
    s_brev_b64 exec, 1
    ds_write_b32 v25, v26 offset:2048
    s_mov_b64 exec, -1
    v_mov_b32_dpp v95, v43 quad_perm:[3,3,3,3] row_mask:0xf bank_mask:0xa
    v_mov_b32_dpp v84, v42 quad_perm:[2,2,2,2] row_mask:0xf bank_mask:0x5
    s_nop 0
    v_smfmac_f32_16x16x64_bf16 v[96:99], v[92:95], v[208:215], v117
    ds_read_b128 a[104:107], v11 offset:18432
    s_cbranch_vccnz L_sk_159o
L_sk_159:
    v_subrev_f32 v40, s74, v40
    v_mov_b32_dpp v85, v114 quad_perm:[1,1,1,1] row_mask:0xf bank_mask:0xa
    v_mov_b32_dpp v86, v114 quad_perm:[1,1,1,1] row_mask:0xf bank_mask:0x5
    v_smfmac_f32_16x16x64_bf16 v[100:103], v[92:95], v[216:223], v117
    ds_read_b128 a[108:111], v11 offset:19456
    ds_read_b128 a[160:163], v11 offset:20480
    v_exp_f32 v40, v40
    v_mov_b32_dpp v87, v42 quad_perm:[2,2,2,2] row_mask:0xf bank_mask:0xa
    v_mov_b32_dpp v88, v42 quad_perm:[3,3,3,3] row_mask:0xf bank_mask:0x5
    v_mov_b32_dpp v89, v114 quad_perm:[0,0,0,0] row_mask:0xf bank_mask:0xa
    v_mov_b32_dpp v90, v114 quad_perm:[0,0,0,0] row_mask:0xf bank_mask:0x5
    v_mov_b32_dpp v91, v42 quad_perm:[3,3,3,3] row_mask:0xf bank_mask:0xa
    v_mov_b32_dpp v92, v42 quad_perm:[0,0,0,0] row_mask:0xf bank_mask:0x5
    v_mov_b32_dpp v93, v114 quad_perm:[3,3,3,3] row_mask:0xf bank_mask:0xa
    v_mov_b32_dpp v94, v114 quad_perm:[3,3,3,3] row_mask:0xf bank_mask:0x5
    v_mov_b32_dpp v95, v42 quad_perm:[0,0,0,0] row_mask:0xf bank_mask:0xa
    v_cvt_pk_bf16_f32 v40, 0, v40
    v_mov_b64 v[108:109], 0
    v_mov_b64 v[110:111], 0
    v_smfmac_f32_16x16x64_bf16 v[104:107], v[84:87], v[128:135], v117
    s_waitcnt lgkmcnt(7)
    ds_read_b128 a[164:167], v11 offset:21504
    v_mov_b32_dpp v112, v40 row_half_mirror row_mask:0xf bank_mask:0xf
    v_subrev_f32 v20, s74, v118
    v_smfmac_f32_16x16x64_bf16 v[108:111], v[84:87], v[136:143], v117
    ds_read_b128 a[168:171], v11 offset:22528
    ds_read_b128 a[172:175], v11 offset:23552
    v_add_f32 v27, v42, v40
    v_exp_f32 v20, v20
    v_smfmac_f32_16x16x64_bf16 v[104:107], v[88:91], v[144:151], v117
    ds_read_b128 a[112:115], v11 offset:24576
    s_waitcnt lgkmcnt(7)
    s_barrier
    ds_read_b32 v24, v24 offset:2048
    v_mov_b32_dpp v84, v42 quad_perm:[1,1,1,1] row_mask:0xf bank_mask:0x5
    v_mov_b32_dpp v85, v114 quad_perm:[2,2,2,2] row_mask:0xf bank_mask:0xa
    v_fmac_f32 v27, v119, v20
    v_smfmac_f32_16x16x64_bf16 v[108:111], v[88:91], v[152:159], v117
    ds_read_b128 a[116:119], v11 offset:25600
    ds_read_b128 a[120:123], v11 offset:26624
    v_min_u32 v26, -2, v26
    v_mov_b32_dpp v86, v114 quad_perm:[2,2,2,2] row_mask:0xf bank_mask:0x5
    v_mov_b32_dpp v87, v42 quad_perm:[1,1,1,1] row_mask:0xf bank_mask:0xa
    v_subrev_f32 v41, s74, v41
    v_smfmac_f32_16x16x64_bf16 v[104:107], v[92:95], a[152:159], v117
    ds_read_b128 a[124:127], v11 offset:27648
    v_exp_f32 v41, v41
    v_mov_b32_dpp v88, v40 quad_perm:[0,0,0,0] row_mask:0xf bank_mask:0x5
    v_mov_b32_dpp v89, v112 quad_perm:[3,3,3,3] row_mask:0xf bank_mask:0xa
    v_cvt_pk_bf16_f32 v41, 0, v41
    v_smfmac_f32_16x16x64_bf16 v[108:111], v[92:95], a[32:39], v117
    ds_read_b128 a[176:179], v11 offset:28672
    ds_read_b128 a[180:183], v11 offset:29696
    v_mov_b32_dpp v113, v41 row_half_mirror row_mask:0xf bank_mask:0xf
    v_mov_b32_dpp v90, v112 quad_perm:[3,3,3,3] row_mask:0xf bank_mask:0x5
    v_mov_b32_dpp v91, v40 quad_perm:[0,0,0,0] row_mask:0xf bank_mask:0xa
    v_add_f32 v27, v27, v41
    v_smfmac_f32_16x16x64_bf16 v[104:107], v[84:87], a[40:47], v117
    ds_read_b128 a[184:187], v11 offset:30720
    v_add_f32_dpp v27, v27, v27 quad_perm:[1,0,3,2] row_mask:0xf bank_mask:0xf
    v_mov_b32_dpp v92, v40 quad_perm:[1,1,1,1] row_mask:0xf bank_mask:0x5
    v_mov_b32_dpp v93, v112 quad_perm:[2,2,2,2] row_mask:0xf bank_mask:0xa
    v_add_f32_dpp v27, v27, v27 quad_perm:[2,3,0,1] row_mask:0xf bank_mask:0xf
    v_smfmac_f32_16x16x64_bf16 v[108:111], v[84:87], v[120:127], v117
    s_waitcnt lgkmcnt(7)
    ds_read_b128 a[188:191], v11 offset:31744
    v_add_f32_dpp v27, v27, v27 row_ror:4 row_mask:0xf bank_mask:0xf
    v_mov_b32_dpp v94, v112 quad_perm:[2,2,2,2] row_mask:0xf bank_mask:0x5
    v_mov_b32_dpp v95, v40 quad_perm:[1,1,1,1] row_mask:0xf bank_mask:0xa
    v_add_f32_dpp v27, v27, v27 row_ror:8 row_mask:0xf bank_mask:0xf
    v_smfmac_f32_16x16x64_bf16 v[104:107], v[88:91], a[48:55], v117
    v_mov_b32_dpp v84, v40 quad_perm:[2,2,2,2] row_mask:0xf bank_mask:0x5
    v_mov_b32_dpp v85, v112 quad_perm:[1,1,1,1] row_mask:0xf bank_mask:0xa
    v_add_f32_dpp v27, v27, v27 row_bcast:15 row_mask:0xa bank_mask:0xf
    v_smfmac_f32_16x16x64_bf16 v[108:111], v[88:91], a[56:63], v117
    v_mov_b32_dpp v86, v112 quad_perm:[1,1,1,1] row_mask:0xf bank_mask:0x5
    v_mov_b32_dpp v87, v40 quad_perm:[2,2,2,2] row_mask:0xf bank_mask:0xa
    v_add_f32_dpp v27, v27, v27 row_bcast:31 row_mask:0xc bank_mask:0xf
    v_smfmac_f32_16x16x64_bf16 v[104:107], v[92:95], a[64:71], v117
    v_min_u32 v27, -2, v27
    v_mov_b32_dpp v88, v40 quad_perm:[3,3,3,3] row_mask:0xf bank_mask:0x5
    v_mov_b32_dpp v89, v112 quad_perm:[0,0,0,0] row_mask:0xf bank_mask:0xa
    v_smfmac_f32_16x16x64_bf16 v[108:111], v[92:95], a[72:79], v117
    s_waitcnt lgkmcnt(7)
    v_mov_b32_dpp v90, v112 quad_perm:[0,0,0,0] row_mask:0xf bank_mask:0x5
    v_mov_b32_dpp v91, v40 quad_perm:[3,3,3,3] row_mask:0xf bank_mask:0xa
    v_max_f32_dpp v24, v24, v24 quad_perm:[1,0,3,2] row_mask:0xf bank_mask:0xf
    v_smfmac_f32_16x16x64_bf16 v[104:107], v[84:87], a[128:135], v117
    s_brev_b64 exec, 1
    s_cmp_eq_u32 s98, 0
    s_cbranch_scc0 L_st_sp
    buffer_store_dwordx2 v[26:27], off, s[36:39], s91
L_str_sp:
    s_mov_b64 exec, -1
    v_mov_b32_dpp v92, v41 quad_perm:[0,0,0,0] row_mask:0xf bank_mask:0x5
    v_mov_b32_dpp v93, v113 quad_perm:[3,3,3,3] row_mask:0xf bank_mask:0xa
    v_max_f32_dpp v24, v24, v24 quad_perm:[2,3,0,1] row_mask:0xf bank_mask:0xf
    v_smfmac_f32_16x16x64_bf16 v[108:111], v[84:87], a[136:143], v117
    s_cbranch_vccnz L_sk_160o
L_sk_160:
    v_sub_f32 v24, s74, v24
    v_mov_b32_dpp v94, v113 quad_perm:[3,3,3,3] row_mask:0xf bank_mask:0x5
    v_mov_b32_dpp v95, v41 quad_perm:[0,0,0,0] row_mask:0xf bank_mask:0xa
    v_exp_f32 v24, v24
    v_smfmac_f32_16x16x64_bf16 v[104:107], v[88:91], a[80:87], v117
    v_mov_b32_dpp v84, v41 quad_perm:[1,1,1,1] row_mask:0xf bank_mask:0x5
    v_mov_b32_dpp v85, v113 quad_perm:[2,2,2,2] row_mask:0xf bank_mask:0xa
    v_smfmac_f32_16x16x64_bf16 v[108:111], v[88:91], a[88:95], v117
L_wa13:
    s_cbranch_execz L_wr3
    v_mov_b32_dpp v86, v113 quad_perm:[2,2,2,2] row_mask:0xf bank_mask:0x5
    v_mov_b32_dpp v87, v41 quad_perm:[1,1,1,1] row_mask:0xf bank_mask:0xa
    v_smfmac_f32_16x16x64_bf16 v[104:107], v[92:95], a[96:103], v117
    v_mov_b32_dpp v88, v41 quad_perm:[2,2,2,2] row_mask:0xf bank_mask:0x5
    v_mov_b32_dpp v89, v113 quad_perm:[1,1,1,1] row_mask:0xf bank_mask:0xa
    v_smfmac_f32_16x16x64_bf16 v[108:111], v[92:95], a[104:111], v117
    v_mov_b32_dpp v90, v113 quad_perm:[1,1,1,1] row_mask:0xf bank_mask:0x5
    v_mov_b32_dpp v91, v41 quad_perm:[2,2,2,2] row_mask:0xf bank_mask:0xa
    v_smfmac_f32_16x16x64_bf16 v[104:107], v[84:87], a[160:167], v117
    v_mov_b32_dpp v92, v41 quad_perm:[3,3,3,3] row_mask:0xf bank_mask:0x5
    v_mov_b32_dpp v93, v113 quad_perm:[0,0,0,0] row_mask:0xf bank_mask:0xa
    v_smfmac_f32_16x16x64_bf16 v[108:111], v[84:87], a[168:175], v117
    v_mov_b32_dpp v94, v113 quad_perm:[0,0,0,0] row_mask:0xf bank_mask:0x5
    v_mov_b32_dpp v95, v41 quad_perm:[3,3,3,3] row_mask:0xf bank_mask:0xa
    v_permlane32_swap_b32 v96, v98
    s_waitcnt lgkmcnt(6)
    v_smfmac_f32_16x16x64_bf16 v[104:107], v[88:91], a[112:119], v117
    v_permlane32_swap_b32 v97, v99
    s_waitcnt lgkmcnt(4)
    v_smfmac_f32_16x16x64_bf16 v[108:111], v[88:91], a[120:127], v117
    v_permlane32_swap_b32 v100, v102
    s_waitcnt lgkmcnt(2)
    v_smfmac_f32_16x16x64_bf16 v[104:107], v[92:95], a[176:183], v117
    v_permlane32_swap_b32 v101, v103
    s_waitcnt lgkmcnt(0)
    v_smfmac_f32_16x16x64_bf16 v[108:111], v[92:95], a[184:191], v117
    v_mul_f32 v20, v20, v24
    s_cmp_lg_u32 s3, 0
    v_pk_add_f32 v[22:23], v[96:97], v[102:103]
    v_lshl_add_u32 v0, v25, 5, v5
    v_pk_mul_f32 v[22:23], v[22:23], v[20:21] op_sel_hi:[1,0]
    v_permlane32_swap_b32 v104, v106
    v_permlane32_swap_b32 v105, v107
    s_nop 0
    v_permlane32_swap_b32 v108, v110
    v_permlane32_swap_b32 v109, v111
    v_add_f32 v104, v104, v110
    v_add_f32 v105, v105, v111
    v_pk_fma_f32 v[104:105], v[104:105], v[24:25], v[22:23] op_sel_hi:[1,0,1]
    ds_write_b64 v0, v[104:105] offset:0
    v_lshrrev_b32 v28, 8, v5
    v_and_b32 v29, 0xf8, v5
    v_lshl_or_b32 v34, v28, 2, v29
    s_waitcnt lgkmcnt(0)
    s_barrier
    s_cbranch_scc1 L_npp
    ds_read_b64 v[28:29], v5 offset:512
    ds_read_b64 v[30:31], v5 offset:1024
    ds_read_b64 v[32:33], v5 offset:1536
    s_waitcnt lgkmcnt(2)
    v_pk_add_f32 v[104:105], v[104:105], v[28:29]
    s_waitcnt lgkmcnt(0)
    v_pk_add_f32 v[30:31], v[30:31], v[32:33]
    v_pk_add_f32 v[104:105], v[104:105], v[30:31]
    v_cvt_pk_bf16_f32 v104, v104, v105
    v_min_u32 v104, -2, v104
    s_cmp_eq_u32 s98, 0
    s_cbranch_scc0 L_st_op
    buffer_store_dword v104, v34, s[36:39], s90 offen
L_str_op:
L_npp:
    s_cbranch_vccnz L_p2ret
    s_endpgm
L_sk_155o:
    s_add_u32 s87, s86, 0x4038000
    buffer_load_dwordx4 a[192:195], v4, s[28:31], s87 offen offset:0 nt
    buffer_load_dwordx4 a[196:199], v4, s[28:31], s87 offen offset:256 nt
    buffer_load_dwordx4 a[200:203], v4, s[28:31], s87 offen offset:2048 nt
    buffer_load_dwordx4 a[204:207], v4, s[28:31], s87 offen offset:2304 nt
    s_branch L_sk_155
L_sk_156o:
    s_waitcnt vmcnt(9)
    s_add_u32 s87, s44, 0x403c000
    buffer_load_dwordx4 a[208:211], v4, s[28:31], s87 offen offset:0 nt
    s_waitcnt vmcnt(9)
    buffer_load_dwordx4 a[212:215], v4, s[28:31], s87 offen offset:256 nt
    s_waitcnt vmcnt(9)
    buffer_load_dwordx4 a[216:219], v4, s[28:31], s87 offen offset:2048 nt
    s_waitcnt vmcnt(9)
    buffer_load_dwordx4 a[220:223], v4, s[28:31], s87 offen offset:2304 nt
    s_branch L_sk_156
L_sk_157o:
    s_waitcnt vmcnt(9)
    s_add_u32 s87, s86, 0x4040000
    buffer_load_dwordx4 a[224:227], v4, s[28:31], s87 offen offset:0 nt
    s_waitcnt vmcnt(9)
    buffer_load_dwordx4 a[228:231], v4, s[28:31], s87 offen offset:256 nt
    s_waitcnt vmcnt(9)
    buffer_load_dwordx4 a[232:235], v4, s[28:31], s87 offen offset:2048 nt
    s_waitcnt vmcnt(9)
    buffer_load_dwordx4 a[236:239], v4, s[28:31], s87 offen offset:2304 nt
    s_branch L_sk_157
L_sk_158o:
    s_waitcnt vmcnt(9)
    s_add_u32 s87, s44, 0x4044000
    buffer_load_dwordx4 a[240:243], v4, s[28:31], s87 offen offset:0 nt
    s_waitcnt vmcnt(9)
    buffer_load_dwordx4 a[244:247], v4, s[28:31], s87 offen offset:256 nt
    s_waitcnt vmcnt(9)
    buffer_load_dwordx4 a[248:251], v4, s[28:31], s87 offen offset:2048 nt
    s_waitcnt vmcnt(9)
    buffer_load_dwordx4 a[252:255], v4, s[28:31], s87 offen offset:2304 nt
    s_branch L_sk_158
L_sk_159o:
    s_waitcnt vmcnt(9)
    s_add_u32 s87, s86, 0x4000000
    s_add_u32 m0, s88, 0x0
    s_nop 0
    buffer_load_dwordx4 v1, s[32:35], s87 offen offset:0 nt lds
    s_waitcnt vmcnt(9)
    buffer_load_dwordx4 v1, s[32:35], s87 offen offset:1024 nt lds
    s_waitcnt vmcnt(9)
    buffer_load_dwordx4 v1, s[32:35], s87 offen offset:2048 nt lds
    s_waitcnt vmcnt(9)
    buffer_load_dwordx4 v1, s[32:35], s87 offen offset:3072 nt lds
    s_branch L_sk_159
L_sk_160o:
    s_waitcnt vmcnt(10)
    s_add_u32 s87, s44, 0x4004000
    s_add_u32 m0, s88, 0x1000
    s_nop 0
    buffer_load_dwordx4 v1, s[32:35], s87 offen offset:0 nt lds
    s_waitcnt vmcnt(10)
    buffer_load_dwordx4 v1, s[32:35], s87 offen offset:1024 nt lds
    s_branch L_sk_160
L_p2ret:
    s_mov_b32 vcc_lo, s100
    s_mov_b32 vcc_hi, 0
    s_add_u32 s73, s89, 0x500
    buffer_load_dwordx4 v[40:43], v6, s[36:39], s73 offen sc1
    s_waitcnt vmcnt(9)
    s_cbranch_vccz L_pc_161
    s_waitcnt vmcnt(7)
L_pc_161:
    s_add_u32 s87, s44, 0x4034000
    buffer_load_dwordx4 v[100:103], v4, s[28:31], s87 offen offset:0 nt
    s_waitcnt vmcnt(9)
    s_cbranch_vccz L_pc_162
    s_waitcnt vmcnt(7)
L_pc_162:
    buffer_load_dwordx4 v[104:107], v4, s[28:31], s87 offen offset:256 nt
    s_waitcnt vmcnt(9)
    s_cbranch_vccz L_pc_163
    s_waitcnt vmcnt(7)
L_pc_163:
    buffer_load_dwordx4 v[108:111], v4, s[28:31], s87 offen offset:2048 nt
    s_waitcnt vmcnt(9)
    s_cbranch_vccz L_pc_164
    s_waitcnt vmcnt(7)
L_pc_164:
    buffer_load_dwordx4 v[112:115], v4, s[28:31], s87 offen offset:2304 nt
L_wa14:
    s_cbranch_execz L_wr3
    s_waitcnt vmcnt(9)
    s_cbranch_vccz L_pc_165
    s_waitcnt vmcnt(6)
L_pc_165:
    s_add_u32 s87, s95, 0x4000000
    buffer_load_dwordx4 v[116:119], v4, s[28:31], s87 offen offset:0 nt
    s_cmp_eq_u32 s3, 1
    s_cbranch_scc0 L_nv_166
    s_mov_b64 exec, 2
    buffer_store_byte v5, off, s[36:39], s101 offset:5
    s_mov_b32 exec_lo, -1
L_nv_166:
    s_mov_b32 exec_hi, 0
    buffer_load_ubyte v2, v5, s[36:39], s96 offen offset:5 sc1
    s_mov_b32 exec_hi, -1
    s_waitcnt vmcnt(10)
    s_cbranch_vccz L_pc_167
    s_waitcnt vmcnt(7)
L_pc_167:
    s_add_u32 s87, s44, 0x4004000
    s_add_u32 m0, s88, 0x1000
    s_nop 0
    buffer_load_dwordx4 v1, s[32:35], s87 offen offset:2048 nt lds
    s_waitcnt vmcnt(9)
    s_cbranch_vccz L_pc_168
    s_waitcnt vmcnt(6)
L_pc_168:
    buffer_load_dwordx4 v1, s[32:35], s87 offen offset:3072 nt lds
    s_waitcnt vmcnt(9)
    s_cbranch_vccz L_pc_169
    s_waitcnt vmcnt(6)
L_pc_169:
    s_add_u32 s87, s86, 0x4008000
    s_add_u32 m0, s88, 0x2000
    s_nop 0
    buffer_load_dwordx4 v1, s[32:35], s87 offen offset:0 nt lds
    s_waitcnt vmcnt(8)
    s_cbranch_vccz L_pc_170
    s_waitcnt vmcnt(6)
L_pc_170:
    buffer_load_dwordx4 v1, s[32:35], s87 offen offset:1024 nt lds
    s_mov_b32 s80, 0x000f000f
    s_mov_b32 s81, 0x000f000f
    v_cndmask_b32 v12, 0, v40, s[80:81]
    v_cndmask_b32 v13, 0, v41, s[80:81]
    v_cndmask_b32 v14, 0, v42, s[80:81]
    v_cndmask_b32 v15, 0, v43, s[80:81]
    s_mov_b32 s80, 0x00f000f0
    s_mov_b32 s81, 0x00f000f0
    v_cndmask_b32 v16, 0, v40, s[80:81]
    v_cndmask_b32 v17, 0, v41, s[80:81]
    v_cndmask_b32 v18, 0, v42, s[80:81]
    v_cndmask_b32 v19, 0, v43, s[80:81]
    s_mov_b32 s80, 0x0f000f00
    s_mov_b32 s81, 0x0f000f00
    v_cndmask_b32 v20, 0, v40, s[80:81]
    v_cndmask_b32 v21, 0, v41, s[80:81]
    v_cndmask_b32 v22, 0, v42, s[80:81]
    v_cndmask_b32 v23, 0, v43, s[80:81]
    s_mov_b32 s80, 0xf000f000
    s_mov_b32 s81, 0xf000f000
    v_cndmask_b32 v24, 0, v40, s[80:81]
    v_cndmask_b32 v25, 0, v41, s[80:81]
    v_cndmask_b32 v26, 0, v42, s[80:81]
    v_cndmask_b32 v27, 0, v43, s[80:81]
    v_mfma_f32_16x16x32_bf16 v[36:39], v[52:55], v[12:15], 0
    v_accvgpr_write_b32 a176, v52
    v_accvgpr_write_b32 a177, v53
    v_accvgpr_write_b32 a178, v54
    v_accvgpr_write_b32 a179, v55
    v_mfma_f32_16x16x32_bf16 v[36:39], v[56:59], v[16:19], v[36:39]
    v_accvgpr_write_b32 a180, v56
    v_accvgpr_write_b32 a181, v57
    v_accvgpr_write_b32 a182, v58
    v_accvgpr_write_b32 a183, v59
    v_mfma_f32_16x16x32_bf16 v[36:39], v[60:63], v[20:23], v[36:39]
    v_accvgpr_write_b32 a184, v60
    v_accvgpr_write_b32 a185, v61
    v_accvgpr_write_b32 a186, v62
    v_accvgpr_write_b32 a187, v63
    v_mfma_f32_16x16x32_bf16 v[36:39], v[64:67], v[24:27], v[36:39]
    s_nop 7
    v_fmac_f32_dpp v50, v36, v10 quad_perm:[0,0,0,0] row_mask:0xf bank_mask:0xf
    s_nop 1
    v_fmac_f32_dpp v50, v37, v10 quad_perm:[1,1,1,1] row_mask:0xf bank_mask:0xf
    s_nop 1
    v_fmac_f32_dpp v50, v38, v10 quad_perm:[2,2,2,2] row_mask:0xf bank_mask:0xf
    s_nop 1
    v_fmac_f32_dpp v50, v39, v10 quad_perm:[3,3,3,3] row_mask:0xf bank_mask:0xf
    s_waitcnt vmcnt(8)
    s_cbranch_vccz L_pc_171
    s_waitcnt vmcnt(6)
L_pc_171:
    buffer_load_dwordx4 v1, s[32:35], s87 offen offset:2048 nt lds
    v_accvgpr_write_b32 a188, v64
    v_accvgpr_write_b32 a189, v65
    v_accvgpr_write_b32 a190, v66
    v_accvgpr_write_b32 a191, v67
    v_mfma_f32_16x16x32_bf16 v[28:31], v[68:71], v[12:15], 0
    v_mov_b32 v84, v68
    v_mov_b32 v85, v69
    v_mov_b32 v86, v70
    v_mov_b32 v87, v71
    v_mfma_f32_16x16x32_bf16 v[28:31], v[72:75], v[16:19], v[28:31]
    v_mov_b32 v88, v72
    v_mov_b32 v89, v73
    v_mov_b32 v90, v74
    v_mov_b32 v91, v75
    v_mfma_f32_16x16x32_bf16 v[28:31], v[76:79], v[20:23], v[28:31]
    v_mov_b32 v92, v76
    v_mov_b32 v93, v77
    v_mov_b32 v94, v78
    v_mov_b32 v95, v79
    v_mfma_f32_16x16x32_bf16 v[28:31], v[80:83], v[24:27], v[28:31]
    s_nop 7
    v_mul_f32_dpp v51, v28, v7 quad_perm:[0,0,0,0] row_mask:0xf bank_mask:0xf
    s_nop 1
    v_fmac_f32_dpp v51, v29, v7 quad_perm:[1,1,1,1] row_mask:0xf bank_mask:0xf
    s_nop 1
    v_fmac_f32_dpp v51, v30, v7 quad_perm:[2,2,2,2] row_mask:0xf bank_mask:0xf
    s_nop 1
    v_fmac_f32_dpp v51, v31, v7 quad_perm:[3,3,3,3] row_mask:0xf bank_mask:0xf
    s_waitcnt vmcnt(8)
    s_cbranch_vccz L_pc_172
    s_waitcnt vmcnt(6)
L_pc_172:
    buffer_load_dwordx4 v1, s[32:35], s87 offen offset:3072 nt lds
    v_mov_b32 v96, v80
    v_mov_b32 v97, v81
    v_mov_b32 v98, v82
    v_mov_b32 v99, v83
    v_mfma_f32_16x16x32_bf16 v[32:35], v[100:103], v[12:15], 0
    v_mfma_f32_16x16x32_bf16 v[32:35], v[104:107], v[16:19], v[32:35]
    v_mfma_f32_16x16x32_bf16 v[32:35], v[108:111], v[20:23], v[32:35]
    s_waitcnt vmcnt(6)
    v_cmp_ne_u32 vcc, 0, v2
    s_nop 0
    s_and_b32 vcc_lo, vcc_lo, 0x0fffffff
    s_bcnt1_i32_b32 s100, vcc_lo
    s_cmp_lt_u32 s100, 18
    s_cselect_b32 s100, -1, 0
    s_mov_b32 vcc_lo, s100
    s_mov_b32 vcc_hi, 0
    s_cbranch_vccz L_pc_173
    s_waitcnt vmcnt(5)
L_pc_173:
    s_add_u32 s87, s44, 0x400c000
    s_add_u32 m0, s88, 0x3000
    s_nop 0
    buffer_load_dwordx4 v1, s[32:35], s87 offen offset:0 nt lds
    v_mfma_f32_16x16x32_bf16 v[32:35], v[112:115], v[24:27], v[32:35]
    s_nop 7
    v_fmac_f32_dpp v51, v32, v8 quad_perm:[0,0,0,0] row_mask:0xf bank_mask:0xf
    s_nop 1
    v_fmac_f32_dpp v51, v33, v8 quad_perm:[1,1,1,1] row_mask:0xf bank_mask:0xf
    s_nop 1
    v_fmac_f32_dpp v51, v34, v8 quad_perm:[2,2,2,2] row_mask:0xf bank_mask:0xf
    s_nop 1
    v_fmac_f32_dpp v51, v35, v8 quad_perm:[3,3,3,3] row_mask:0xf bank_mask:0xf
    v_mfma_f32_16x16x32_bf16 v[36:39], a[192:195], v[12:15], 0
    v_mfma_f32_16x16x32_bf16 v[36:39], a[196:199], v[16:19], v[36:39]
    v_mfma_f32_16x16x32_bf16 v[36:39], a[200:203], v[20:23], v[36:39]
    v_mfma_f32_16x16x32_bf16 v[36:39], a[204:207], v[24:27], v[36:39]
    s_nop 7
    v_fmac_f32_dpp v51, v36, v9 quad_perm:[0,0,0,0] row_mask:0xf bank_mask:0xf
    s_nop 1
    v_fmac_f32_dpp v51, v37, v9 quad_perm:[1,1,1,1] row_mask:0xf bank_mask:0xf
    s_nop 1
    v_fmac_f32_dpp v51, v38, v9 quad_perm:[2,2,2,2] row_mask:0xf bank_mask:0xf
    s_nop 1
    v_fmac_f32_dpp v51, v39, v9 quad_perm:[3,3,3,3] row_mask:0xf bank_mask:0xf
    s_cbranch_vccz L_pc_174
    s_waitcnt vmcnt(5)
L_pc_174:
    buffer_load_dwordx4 v1, s[32:35], s87 offen offset:1024 nt lds
    v_mfma_f32_16x16x32_bf16 v[28:31], a[208:211], v[12:15], 0
    v_mfma_f32_16x16x32_bf16 v[28:31], a[212:215], v[16:19], v[28:31]
    v_mfma_f32_16x16x32_bf16 v[28:31], a[216:219], v[20:23], v[28:31]
    v_mfma_f32_16x16x32_bf16 v[28:31], a[220:223], v[24:27], v[28:31]
    s_nop 7
    v_fmac_f32_dpp v51, v28, v10 quad_perm:[0,0,0,0] row_mask:0xf bank_mask:0xf
    s_nop 1
    v_fmac_f32_dpp v51, v29, v10 quad_perm:[1,1,1,1] row_mask:0xf bank_mask:0xf
    s_nop 1
    v_fmac_f32_dpp v51, v30, v10 quad_perm:[2,2,2,2] row_mask:0xf bank_mask:0xf
L_wa15:
    s_cbranch_execz L_wr3
    s_nop 0
    v_fmac_f32_dpp v51, v31, v10 quad_perm:[3,3,3,3] row_mask:0xf bank_mask:0xf
    v_mfma_f32_16x16x32_bf16 v[32:35], a[224:227], v[12:15], 0
    v_mfma_f32_16x16x32_bf16 v[32:35], a[228:231], v[16:19], v[32:35]
    v_mfma_f32_16x16x32_bf16 v[32:35], a[232:235], v[20:23], v[32:35]
    v_mfma_f32_16x16x32_bf16 v[32:35], a[236:239], v[24:27], v[32:35]
    s_nop 7
    v_mul_f32_dpp v3, v32, v7 quad_perm:[0,0,0,0] row_mask:0xf bank_mask:0xf
    s_nop 1
    v_fmac_f32_dpp v3, v33, v7 quad_perm:[1,1,1,1] row_mask:0xf bank_mask:0xf
    s_nop 1
    v_fmac_f32_dpp v3, v34, v7 quad_perm:[2,2,2,2] row_mask:0xf bank_mask:0xf
    s_nop 1
    v_fmac_f32_dpp v3, v35, v7 quad_perm:[3,3,3,3] row_mask:0xf bank_mask:0xf
    s_waitcnt vmcnt(7)
    s_cbranch_vccz L_pc_175
    s_waitcnt vmcnt(5)
L_pc_175:
    buffer_load_dwordx4 v1, s[32:35], s87 offen offset:2048 nt lds
    v_mfma_f32_16x16x32_bf16 v[36:39], a[240:243], v[12:15], 0
    v_mfma_f32_16x16x32_bf16 v[36:39], a[244:247], v[16:19], v[36:39]
    v_mfma_f32_16x16x32_bf16 v[36:39], a[248:251], v[20:23], v[36:39]
    v_mfma_f32_16x16x32_bf16 v[36:39], a[252:255], v[24:27], v[36:39]
    s_nop 7
    v_fmac_f32_dpp v3, v36, v8 quad_perm:[0,0,0,0] row_mask:0xf bank_mask:0xf
    s_nop 1
    v_fmac_f32_dpp v3, v37, v8 quad_perm:[1,1,1,1] row_mask:0xf bank_mask:0xf
    s_nop 1
    v_fmac_f32_dpp v3, v38, v8 quad_perm:[2,2,2,2] row_mask:0xf bank_mask:0xf
    s_nop 1
    v_fmac_f32_dpp v3, v39, v8 quad_perm:[3,3,3,3] row_mask:0xf bank_mask:0xf
    v_mfma_f32_16x16x32_bf16 v[28:31], v[116:119], v[12:15], 0
    s_nop 7
    v_fmac_f32_dpp v3, v28, v9 quad_perm:[0,0,0,0] row_mask:0xf bank_mask:0xf
    s_nop 1
    v_fmac_f32_dpp v3, v29, v9 quad_perm:[1,1,1,1] row_mask:0xf bank_mask:0xf
    s_nop 1
    v_fmac_f32_dpp v3, v30, v9 quad_perm:[2,2,2,2] row_mask:0xf bank_mask:0xf
    s_nop 1
    v_fmac_f32_dpp v3, v31, v9 quad_perm:[3,3,3,3] row_mask:0xf bank_mask:0xf
    s_waitcnt vmcnt(7)
    s_cbranch_vccz L_pc_176
    s_waitcnt vmcnt(5)
L_pc_176:
    buffer_load_dwordx4 v1, s[32:35], s87 offen offset:3072 nt lds
    s_add_u32 s90, s92, 0x100
    s_add_u32 s91, s93, 0x20
    v_mov_b32 v0, 0xff800000
    v_cndmask_b32 v3, v0, v3, s[78:79]
    v_max3_f32 v26, v48, v49, v50
    v_max3_f32 v26, v26, v51, v3
    v_mov_b32 v28, 0
    v_mov_b32 v29, 0
    v_max_f32_dpp v26, v26, v26 quad_perm:[1,0,3,2] row_mask:0xf bank_mask:0xf
    v_mov_b32 v30, 0
    v_mov_b32 v31, 0
    v_max_f32_dpp v26, v26, v26 quad_perm:[2,3,0,1] row_mask:0xf bank_mask:0xf
    v_mov_b32 v32, 0
    v_mov_b32 v33, 0
    v_max_f32_dpp v26, v26, v26 row_ror:4 row_mask:0xf bank_mask:0xf
    v_mov_b32 v34, 0
    v_mov_b32 v35, 0
    v_max_f32_dpp v26, v26, v26 row_ror:8 row_mask:0xf bank_mask:0xf
    v_mov_b32 v0, v26
    v_mov_b32 v36, 0
    v_mov_b32 v37, 0
    v_permlane16_swap_b32 v26, v0
    v_max_f32 v26, v26, v0
    v_mov_b32 v0, v26
    v_mov_b32 v38, 0
    v_mov_b32 v39, 0
    v_permlane32_swap_b32 v26, v0
    v_max_f32 v26, v26, v0
    v_sub_f32 v48, v48, v26
    v_sub_f32 v49, v49, v26
    v_sub_f32 v50, v50, v26
    v_sub_f32 v51, v51, v26
    v_sub_f32 v3, v3, v26
    v_exp_f32 v48, v48
    v_exp_f32 v49, v49
    v_exp_f32 v50, v50
    v_exp_f32 v51, v51
    v_exp_f32 v3, v3
    v_cvt_pk_bf16_f32 v48, 0, v48
    v_cvt_pk_bf16_f32 v49, 0, v49
    v_cvt_pk_bf16_f32 v50, 0, v50
    v_cvt_pk_bf16_f32 v51, 0, v51
    v_cvt_pk_bf16_f32 v3, 0, v3
    v_add_f32 v27, v48, v49
    v_add_f32 v0, v50, v51
    v_add_f32 v27, v27, v3
    v_add_f32 v27, v27, v0
    v_mov_b32 v12, 0
    v_mov_b32 v13, 0
    v_add_f32_dpp v27, v27, v27 quad_perm:[1,0,3,2] row_mask:0xf bank_mask:0xf
    v_mov_b32 v14, 0
    v_mov_b32 v15, 0
    v_add_f32_dpp v27, v27, v27 quad_perm:[2,3,0,1] row_mask:0xf bank_mask:0xf
    v_mov_b32 v16, 0
    v_mov_b32 v17, 0
    v_add_f32_dpp v27, v27, v27 row_ror:4 row_mask:0xf bank_mask:0xf
    v_mov_b32 v18, 0
    v_mov_b32 v19, 0
    v_add_f32_dpp v27, v27, v27 row_ror:8 row_mask:0xf bank_mask:0xf
    v_mov_b32 v0, v27
    v_bfe_u32 v25, v1, 4, 2
    v_mul_u32_u24 v25, 0x4444, v25
    v_permlane16_swap_b32 v27, v0
    v_add_f32 v27, v27, v0
    v_mov_b32 v0, v27
    v_mov_b32_dpp v20, v48 row_half_mirror row_mask:0xf bank_mask:0xf
    v_mov_b32_dpp v21, v49 row_half_mirror row_mask:0xf bank_mask:0xf
    v_permlane32_swap_b32 v27, v0
    v_add_f32 v27, v27, v0
    v_min_u32 v26, -2, v26
    v_min_u32 v27, -2, v27
    v_mov_b32 v0, s99
    s_mov_b64 exec, 1
    s_cmp_eq_u32 s98, 0
    s_cbranch_scc0 L_st_s1
    buffer_store_dwordx2 v[26:27], off, s[36:39], s91
L_str_s1:
    ds_write_b32 v0, v26 offset:2048
    s_mov_b64 exec, -1
    v_mov_b32_dpp v22, v50 row_half_mirror row_mask:0xf bank_mask:0xf
    v_mov_b32_dpp v23, v51 row_half_mirror row_mask:0xf bank_mask:0xf
    v_mov_b32_dpp v24, v3 row_half_mirror row_mask:0xf bank_mask:0xf
    v_mov_b32_dpp v28, v48 quad_perm:[0,0,0,0] row_mask:0xf bank_mask:0x5
    v_mov_b32_dpp v29, v20 quad_perm:[3,3,3,3] row_mask:0xf bank_mask:0xa
    v_mov_b32_dpp v30, v20 quad_perm:[3,3,3,3] row_mask:0xf bank_mask:0x5
    v_mov_b32_dpp v31, v48 quad_perm:[0,0,0,0] row_mask:0xf bank_mask:0xa
    v_mov_b32_dpp v32, v48 quad_perm:[1,1,1,1] row_mask:0xf bank_mask:0x5
    v_mov_b32_dpp v33, v20 quad_perm:[2,2,2,2] row_mask:0xf bank_mask:0xa
    v_mov_b32_dpp v34, v20 quad_perm:[2,2,2,2] row_mask:0xf bank_mask:0x5
    v_mov_b32_dpp v35, v48 quad_perm:[1,1,1,1] row_mask:0xf bank_mask:0xa
    s_waitcnt vmcnt(8)
    s_cbranch_vccz L_pc_177
    s_waitcnt vmcnt(6)
L_pc_177:
    s_add_u32 s87, s86, 0x4010000
    s_add_u32 m0, s88, 0x4000
    s_nop 0
    buffer_load_dwordx4 v1, s[32:35], s87 offen offset:0 nt lds
    ds_read_b128 v[52:55], v11 offset:0
    ds_read_b128 v[56:59], v11 offset:1024
    v_mov_b32_dpp v36, v48 quad_perm:[2,2,2,2] row_mask:0xf bank_mask:0x5
    v_mov_b32_dpp v37, v20 quad_perm:[1,1,1,1] row_mask:0xf bank_mask:0xa
    s_waitcnt lgkmcnt(0)
    v_smfmac_f32_16x16x64_bf16 v[12:15], v[28:31], v[52:59], v25
    ds_read_b128 v[60:63], v11 offset:2048
    ds_read_b128 v[64:67], v11 offset:3072
    v_mov_b32_dpp v38, v20 quad_perm:[1,1,1,1] row_mask:0xf bank_mask:0x5
    v_mov_b32_dpp v39, v48 quad_perm:[2,2,2,2] row_mask:0xf bank_mask:0xa
    s_waitcnt lgkmcnt(0)
    v_smfmac_f32_16x16x64_bf16 v[16:19], v[28:31], v[60:67], v25
    s_waitcnt vmcnt(8)
    s_cbranch_vccz L_pc_178
    s_waitcnt vmcnt(6)
L_pc_178:
    buffer_load_dwordx4 v1, s[32:35], s87 offen offset:1024 nt lds
    ds_read_b128 v[52:55], v11 offset:4096
    ds_read_b128 v[56:59], v11 offset:5120
    v_mov_b32_dpp v28, v48 quad_perm:[3,3,3,3] row_mask:0xf bank_mask:0x5
    v_mov_b32_dpp v29, v20 quad_perm:[0,0,0,0] row_mask:0xf bank_mask:0xa
    s_waitcnt lgkmcnt(0)
    v_smfmac_f32_16x16x64_bf16 v[12:15], v[32:35], v[52:59], v25
    ds_read_b128 v[60:63], v11 offset:6144
    ds_read_b128 v[64:67], v11 offset:7168
    v_mov_b32_dpp v30, v20 quad_perm:[0,0,0,0] row_mask:0xf bank_mask:0x5
    v_mov_b32_dpp v31, v48 quad_perm:[3,3,3,3] row_mask:0xf bank_mask:0xa
    s_waitcnt lgkmcnt(0)
    v_smfmac_f32_16x16x64_bf16 v[16:19], v[32:35], v[60:67], v25
    s_waitcnt vmcnt(8)
    s_cbranch_vccz L_pc_179
    s_waitcnt vmcnt(6)
L_pc_179:
    buffer_load_dwordx4 v1, s[32:35], s87 offen offset:2048 nt lds
    v_and_b32 v27, 0x30, v1
    s_barrier
    ds_read_b32 v27, v27 offset:2048
    ds_read_b128 v[52:55], v11 offset:8192
    ds_read_b128 v[56:59], v11 offset:9216
    v_mov_b32_dpp v32, v49 quad_perm:[0,0,0,0] row_mask:0xf bank_mask:0x5
    v_mov_b32_dpp v33, v21 quad_perm:[3,3,3,3] row_mask:0xf bank_mask:0xa
    s_waitcnt lgkmcnt(0)
    v_smfmac_f32_16x16x64_bf16 v[12:15], v[36:39], v[52:59], v25
L_wa16:
    s_cbranch_execz L_wr4
    s_waitcnt vmcnt(8)
    s_cbranch_vccz L_pc_180
    s_waitcnt vmcnt(6)
L_pc_180:
    buffer_load_dwordx4 v1, s[32:35], s87 offen offset:3072 nt lds
    ds_read_b128 v[60:63], v11 offset:10240
    ds_read_b128 v[64:67], v11 offset:11264
    v_mov_b32_dpp v34, v21 quad_perm:[3,3,3,3] row_mask:0xf bank_mask:0x5
    v_mov_b32_dpp v35, v49 quad_perm:[0,0,0,0] row_mask:0xf bank_mask:0xa
    s_waitcnt lgkmcnt(0)
    v_smfmac_f32_16x16x64_bf16 v[16:19], v[36:39], v[60:67], v25
    v_max_f32_dpp v27, v27, v27 quad_perm:[1,0,3,2] row_mask:0xf bank_mask:0xf
    s_nop 1
    v_max_f32_dpp v27, v27, v27 quad_perm:[2,3,0,1] row_mask:0xf bank_mask:0xf
    v_sub_f32 v27, v26, v27
    v_exp_f32 v27, v27
    s_waitcnt vmcnt(8)
    s_cbranch_vccz L_pc_181
    s_waitcnt vmcnt(6)
L_pc_181:
    s_add_u32 s87, s44, 0x4014000
    s_add_u32 m0, s88, 0x5000
    s_nop 0
    buffer_load_dwordx4 v1, s[32:35], s87 offen offset:0 nt lds
    s_waitcnt vmcnt(8)
    s_cbranch_vccz L_pc_182
    s_waitcnt vmcnt(6)
L_pc_182:
    buffer_load_dwordx4 v1, s[32:35], s87 offen offset:1024 nt lds
    ds_read_b128 v[52:55], v11 offset:12288
    ds_read_b128 v[56:59], v11 offset:13312
    v_mov_b32_dpp v36, v49 quad_perm:[1,1,1,1] row_mask:0xf bank_mask:0x5
    v_mov_b32_dpp v37, v21 quad_perm:[2,2,2,2] row_mask:0xf bank_mask:0xa
    s_waitcnt lgkmcnt(0)
    v_smfmac_f32_16x16x64_bf16 v[12:15], v[28:31], v[52:59], v25
    s_waitcnt vmcnt(8)
    s_cbranch_vccz L_pc_183
    s_waitcnt vmcnt(5)
L_pc_183:
    buffer_load_dwordx4 v1, s[32:35], s87 offen offset:2048 nt lds
    s_waitcnt vmcnt(8)
    s_cbranch_vccz L_pc_184
    s_waitcnt vmcnt(5)
L_pc_184:
    buffer_load_dwordx4 v1, s[32:35], s87 offen offset:3072 nt lds
    ds_read_b128 v[60:63], v11 offset:14336
    ds_read_b128 v[64:67], v11 offset:15360
    v_mov_b32_dpp v38, v21 quad_perm:[2,2,2,2] row_mask:0xf bank_mask:0x5
    v_mov_b32_dpp v39, v49 quad_perm:[1,1,1,1] row_mask:0xf bank_mask:0xa
    s_waitcnt lgkmcnt(0)
    v_smfmac_f32_16x16x64_bf16 v[16:19], v[28:31], v[60:67], v25
    s_waitcnt vmcnt(7)
    s_cbranch_vccz L_pc_185
    s_waitcnt vmcnt(5)
L_pc_185:
    s_add_u32 s87, s86, 0x4018000
    s_add_u32 m0, s88, 0x6000
    s_nop 0
    buffer_load_dwordx4 v1, s[32:35], s87 offen offset:0 nt lds
    s_waitcnt vmcnt(7)
    s_cbranch_vccz L_pc_186
    s_waitcnt vmcnt(5)
L_pc_186:
    buffer_load_dwordx4 v1, s[32:35], s87 offen offset:1024 nt lds
    ds_read_b128 v[52:55], v11 offset:16384
    ds_read_b128 v[56:59], v11 offset:17408
    v_mov_b32_dpp v28, v49 quad_perm:[2,2,2,2] row_mask:0xf bank_mask:0x5
    v_mov_b32_dpp v29, v21 quad_perm:[1,1,1,1] row_mask:0xf bank_mask:0xa
    s_waitcnt lgkmcnt(0)
    v_smfmac_f32_16x16x64_bf16 v[12:15], v[32:35], v[52:59], v25
    s_waitcnt vmcnt(7)
    s_cbranch_vccz L_pc_187
    s_waitcnt vmcnt(5)
L_pc_187:
    buffer_load_dwordx4 v1, s[32:35], s87 offen offset:2048 nt lds
    s_waitcnt vmcnt(7)
    s_cbranch_vccz L_pc_188
    s_waitcnt vmcnt(5)
L_pc_188:
    buffer_load_dwordx4 v1, s[32:35], s87 offen offset:3072 nt lds
    ds_read_b128 v[60:63], v11 offset:18432
    ds_read_b128 v[64:67], v11 offset:19456
    v_mov_b32_dpp v30, v21 quad_perm:[1,1,1,1] row_mask:0xf bank_mask:0x5
    v_mov_b32_dpp v31, v49 quad_perm:[2,2,2,2] row_mask:0xf bank_mask:0xa
    s_waitcnt lgkmcnt(0)
    v_smfmac_f32_16x16x64_bf16 v[16:19], v[32:35], v[60:67], v25
    s_waitcnt vmcnt(7)
    s_cbranch_vccz L_pc_189
    s_waitcnt vmcnt(5)
L_pc_189:
    s_add_u32 s87, s44, 0x401c000
    s_add_u32 m0, s88, 0x7000
    s_nop 0
    buffer_load_dwordx4 v1, s[32:35], s87 offen offset:0 nt lds
    s_waitcnt vmcnt(7)
    s_cbranch_vccz L_pc_190
    s_waitcnt vmcnt(5)
L_pc_190:
    buffer_load_dwordx4 v1, s[32:35], s87 offen offset:1024 nt lds
    ds_read_b128 v[52:55], v11 offset:20480
    ds_read_b128 v[56:59], v11 offset:21504
    v_mov_b32_dpp v32, v49 quad_perm:[3,3,3,3] row_mask:0xf bank_mask:0x5
    v_mov_b32_dpp v33, v21 quad_perm:[0,0,0,0] row_mask:0xf bank_mask:0xa
    s_waitcnt lgkmcnt(0)
    v_smfmac_f32_16x16x64_bf16 v[12:15], v[36:39], v[52:59], v25
    s_waitcnt vmcnt(7)
    s_cbranch_vccz L_pc_191
    s_waitcnt vmcnt(5)
L_pc_191:
    buffer_load_dwordx4 v1, s[32:35], s87 offen offset:2048 nt lds
    s_cmp_eq_u32 s3, 1
    s_cbranch_scc0 L_nv_192
    s_mov_b64 exec, 2
    buffer_store_byte v5, off, s[36:39], s101 offset:6
    s_mov_b32 exec_lo, -1
L_nv_192:
    s_mov_b32 exec_hi, 0
    buffer_load_ubyte v2, v5, s[36:39], s96 offen offset:6 sc1
    s_mov_b32 exec_hi, -1
    s_waitcnt vmcnt(8)
    s_cbranch_vccz L_pc_193
    s_waitcnt vmcnt(6)
L_pc_193:
    buffer_load_dwordx4 v1, s[32:35], s87 offen offset:3072 nt lds
    ds_read_b128 v[60:63], v11 offset:22528
    ds_read_b128 v[64:67], v11 offset:23552
    v_mov_b32_dpp v34, v21 quad_perm:[0,0,0,0] row_mask:0xf bank_mask:0x5
    v_mov_b32_dpp v35, v49 quad_perm:[3,3,3,3] row_mask:0xf bank_mask:0xa
    s_waitcnt lgkmcnt(0)
    v_smfmac_f32_16x16x64_bf16 v[16:19], v[36:39], v[60:67], v25
    s_waitcnt vmcnt(8)
    s_cbranch_vccz L_pc_194
    s_waitcnt vmcnt(6)
L_pc_194:
    s_add_u32 s87, s86, 0x4020000
    s_add_u32 m0, s88, 0x8000
    s_nop 0
    buffer_load_dwordx4 v1, s[32:35], s87 offen offset:0 nt lds
    s_waitcnt vmcnt(8)
    s_cbranch_vccz L_pc_195
    s_waitcnt vmcnt(6)
L_pc_195:
    buffer_load_dwordx4 v1, s[32:35], s87 offen offset:1024 nt lds
    ds_read_b128 v[52:55], v11 offset:24576
    ds_read_b128 v[56:59], v11 offset:25600
    v_mov_b32_dpp v36, v50 quad_perm:[0,0,0,0] row_mask:0xf bank_mask:0x5
    v_mov_b32_dpp v37, v22 quad_perm:[3,3,3,3] row_mask:0xf bank_mask:0xa
    s_waitcnt lgkmcnt(0)
    v_smfmac_f32_16x16x64_bf16 v[12:15], v[28:31], v[52:59], v25
    s_waitcnt vmcnt(8)
    s_cbranch_vccz L_pc_196
    s_waitcnt vmcnt(6)
L_pc_196:
    buffer_load_dwordx4 v1, s[32:35], s87 offen offset:2048 nt lds
    s_waitcnt vmcnt(8)
    s_cbranch_vccz L_pc_197
    s_waitcnt vmcnt(6)
L_pc_197:
    buffer_load_dwordx4 v1, s[32:35], s87 offen offset:3072 nt lds
    ds_read_b128 v[60:63], v11 offset:26624
    ds_read_b128 v[64:67], v11 offset:27648
    v_mov_b32_dpp v38, v22 quad_perm:[3,3,3,3] row_mask:0xf bank_mask:0x5
    v_mov_b32_dpp v39, v50 quad_perm:[0,0,0,0] row_mask:0xf bank_mask:0xa
    s_waitcnt lgkmcnt(0)
    v_smfmac_f32_16x16x64_bf16 v[16:19], v[28:31], v[60:67], v25
    s_waitcnt vmcnt(8)
    s_cbranch_vccz L_pc_198
    s_waitcnt vmcnt(6)
L_pc_198:
    s_add_u32 s87, s44, 0x4024000
    s_add_u32 m0, s88, 0x9000
    s_nop 0
    buffer_load_dwordx4 v1, s[32:35], s87 offen offset:0 nt lds
    s_waitcnt vmcnt(6)
    v_cmp_ne_u32 vcc, 0, v2
    s_nop 0
    s_and_b32 vcc_lo, vcc_lo, 0x0fffffff
    s_bcnt1_i32_b32 s100, vcc_lo
    s_cmp_lt_u32 s100, 18
    s_cselect_b32 s100, -1, 0
    s_mov_b32 vcc_lo, s100
    s_mov_b32 vcc_hi, 0
    s_cbranch_vccz L_pc_199
    s_waitcnt vmcnt(5)
L_pc_199:
    buffer_load_dwordx4 v1, s[32:35], s87 offen offset:1024 nt lds
    ds_read_b128 v[52:55], v11 offset:28672
    ds_read_b128 v[56:59], v11 offset:29696
    v_mov_b32_dpp v28, v50 quad_perm:[1,1,1,1] row_mask:0xf bank_mask:0x5
    v_mov_b32_dpp v29, v22 quad_perm:[2,2,2,2] row_mask:0xf bank_mask:0xa
    s_waitcnt lgkmcnt(0)
    v_smfmac_f32_16x16x64_bf16 v[12:15], v[32:35], v[52:59], v25
    s_cbranch_vccz L_pc_200
    s_waitcnt vmcnt(5)
L_pc_200:
    s_add_u32 s87, s95, 0x4000000
    s_add_u32 m0, s88, 0x9800
    v_and_b32 v0, 0x300, v1
    v_add_u32 v0, v0, v1
    buffer_load_dwordx4 v0, s[32:35], s87 offen offset:0 nt lds
    s_waitcnt vmcnt(7)
    s_cbranch_vccz L_pc_201
    s_waitcnt vmcnt(5)
L_pc_201:
    s_add_u32 s87, s44, 0x4024000
    buffer_load_dwordx4 v[120:123], v1, s[32:35], s87 offen offset:2048 nt
    ds_read_b128 v[60:63], v11 offset:30720
    ds_read_b128 v[64:67], v11 offset:31744
    v_mov_b32_dpp v30, v22 quad_perm:[2,2,2,2] row_mask:0xf bank_mask:0x5
    v_mov_b32_dpp v31, v50 quad_perm:[1,1,1,1] row_mask:0xf bank_mask:0xa
L_wa17:
    s_cbranch_execz L_wr4
    s_waitcnt lgkmcnt(0)
    v_smfmac_f32_16x16x64_bf16 v[16:19], v[32:35], v[60:67], v25
    s_waitcnt vmcnt(7)
    s_cbranch_vccz L_pc_202
    s_waitcnt vmcnt(5)
L_pc_202:
    buffer_load_dwordx4 v[124:127], v1, s[32:35], s87 offen offset:3072 nt
    s_waitcnt vmcnt(7)
    s_cbranch_vccz L_pc_203
    s_waitcnt vmcnt(5)
L_pc_203:
    s_add_u32 s87, s86, 0x4028000
    buffer_load_dwordx4 v[128:131], v1, s[32:35], s87 offen offset:0 nt
    ds_read_b128 v[52:55], v11 offset:32768
    ds_read_b128 v[56:59], v11 offset:33792
    v_mov_b32_dpp v32, v50 quad_perm:[2,2,2,2] row_mask:0xf bank_mask:0x5
    v_mov_b32_dpp v33, v22 quad_perm:[1,1,1,1] row_mask:0xf bank_mask:0xa
    s_waitcnt lgkmcnt(0)
    v_smfmac_f32_16x16x64_bf16 v[12:15], v[36:39], v[52:59], v25
    s_waitcnt vmcnt(7)
    s_cbranch_vccz L_pc_204
    s_waitcnt vmcnt(5)
L_pc_204:
    buffer_load_dwordx4 v[132:135], v1, s[32:35], s87 offen offset:1024 nt
    s_waitcnt vmcnt(7)
    s_cbranch_vccz L_pc_205
    s_waitcnt vmcnt(5)
L_pc_205:
    buffer_load_dwordx4 v[136:139], v1, s[32:35], s87 offen offset:2048 nt
    ds_read_b128 v[60:63], v11 offset:34816
    ds_read_b128 v[64:67], v11 offset:35840
    v_mov_b32_dpp v34, v22 quad_perm:[1,1,1,1] row_mask:0xf bank_mask:0x5
    v_mov_b32_dpp v35, v50 quad_perm:[2,2,2,2] row_mask:0xf bank_mask:0xa
    s_waitcnt lgkmcnt(0)
    v_smfmac_f32_16x16x64_bf16 v[16:19], v[36:39], v[60:67], v25
    s_waitcnt vmcnt(7)
    s_cbranch_vccz L_pc_206
    s_waitcnt vmcnt(5)
L_pc_206:
    buffer_load_dwordx4 v[140:143], v1, s[32:35], s87 offen offset:3072 nt
    s_waitcnt vmcnt(7)
    s_cbranch_vccz L_pc_207
    s_waitcnt vmcnt(5)
L_pc_207:
    s_add_u32 s87, s44, 0x402c000
    buffer_load_dwordx4 v[144:147], v1, s[32:35], s87 offen offset:0 nt
    ds_read_b128 v[52:55], v11 offset:36864
    ds_read_b128 v[56:59], v11 offset:37888
    v_mov_b32_dpp v36, v50 quad_perm:[3,3,3,3] row_mask:0xf bank_mask:0x5
    v_mov_b32_dpp v37, v22 quad_perm:[0,0,0,0] row_mask:0xf bank_mask:0xa
    s_waitcnt lgkmcnt(0)
    v_smfmac_f32_16x16x64_bf16 v[12:15], v[28:31], v[52:59], v25
    s_waitcnt vmcnt(7)
    s_cbranch_vccz L_pc_208
    s_waitcnt vmcnt(5)
L_pc_208:
    buffer_load_dwordx4 v[148:151], v1, s[32:35], s87 offen offset:1024 nt
    ds_read_b128 v[60:63], v11 offset:38912
    v_lshrrev_b32 v0, 16, v3
    v_or_b32 v0, v0, v3
    s_nop 1
    v_and_b32_dpp v64, v0, v44 row_newbcast:2 row_mask:0xf bank_mask:0xf
    v_and_b32_dpp v65, v0, v45 row_newbcast:2 row_mask:0xf bank_mask:0xf
    v_and_b32_dpp v66, v0, v46 row_newbcast:2 row_mask:0xf bank_mask:0xf
    v_and_b32_dpp v67, v0, v47 row_newbcast:2 row_mask:0xf bank_mask:0xf
    s_waitcnt lgkmcnt(0)
    s_nop 0
    v_mfma_f32_16x16x32_bf16 v[12:15], v[64:67], v[60:63], v[12:15]
    s_waitcnt vmcnt(7)
    s_cbranch_vccz L_pc_209
    s_waitcnt vmcnt(5)
L_pc_209:
    buffer_load_dwordx4 v[152:155], v1, s[32:35], s87 offen offset:2048 nt
    s_waitcnt vmcnt(7)
    s_cbranch_vccz L_pc_210
    s_waitcnt vmcnt(5)
L_pc_210:
    buffer_load_dwordx4 v[156:159], v1, s[32:35], s87 offen offset:3072 nt
    v_smfmac_f32_16x16x64_bf16 v[16:19], v[28:31], v[120:127], v25
    v_mov_b32_dpp v38, v22 quad_perm:[0,0,0,0] row_mask:0xf bank_mask:0x5
    v_mov_b32_dpp v39, v50 quad_perm:[3,3,3,3] row_mask:0xf bank_mask:0xa
    s_waitcnt vmcnt(7)
    s_cbranch_vccz L_pc_211
    s_waitcnt vmcnt(5)
L_pc_211:
    s_add_u32 s87, s86, 0x4030000
    buffer_load_dwordx4 v[160:163], v1, s[32:35], s87 offen offset:0 nt
    s_waitcnt vmcnt(7)
    s_cbranch_vccz L_pc_212
    s_waitcnt vmcnt(5)
L_pc_212:
    buffer_load_dwordx4 v[164:167], v1, s[32:35], s87 offen offset:1024 nt
    v_smfmac_f32_16x16x64_bf16 v[12:15], v[32:35], v[128:135], v25
    v_mov_b32_dpp v28, v51 quad_perm:[0,0,0,0] row_mask:0xf bank_mask:0x5
    v_mov_b32_dpp v29, v23 quad_perm:[3,3,3,3] row_mask:0xf bank_mask:0xa
    s_cmp_eq_u32 s3, 1
    s_cbranch_scc0 L_nv_213
    s_mov_b64 exec, 2
    buffer_store_byte v5, off, s[36:39], s101 offset:7
    s_mov_b32 exec_lo, -1
L_nv_213:
    s_mov_b32 exec_hi, 0
    buffer_load_ubyte v2, v5, s[36:39], s96 offen offset:7 sc1
    s_mov_b32 exec_hi, -1
    s_waitcnt vmcnt(8)
    s_cbranch_vccz L_pc_214
    s_waitcnt vmcnt(6)
L_pc_214:
    buffer_load_dwordx4 v[168:171], v1, s[32:35], s87 offen offset:2048 nt
    s_waitcnt vmcnt(8)
    s_cbranch_vccz L_pc_215
    s_waitcnt vmcnt(6)
L_pc_215:
    buffer_load_dwordx4 v[172:175], v1, s[32:35], s87 offen offset:3072 nt
    v_smfmac_f32_16x16x64_bf16 v[16:19], v[32:35], v[136:143], v25
    v_mov_b32_dpp v30, v23 quad_perm:[3,3,3,3] row_mask:0xf bank_mask:0x5
    v_mov_b32_dpp v31, v51 quad_perm:[0,0,0,0] row_mask:0xf bank_mask:0xa
    s_waitcnt vmcnt(8)
    s_cbranch_vccz L_pc_216
    s_waitcnt vmcnt(6)
L_pc_216:
    s_add_u32 s87, s44, 0x4034000
    buffer_load_dwordx4 v[176:179], v1, s[32:35], s87 offen offset:0 nt
    s_waitcnt vmcnt(8)
    s_cbranch_vccz L_pc_217
    s_waitcnt vmcnt(6)
L_pc_217:
    buffer_load_dwordx4 v[180:183], v1, s[32:35], s87 offen offset:1024 nt
    v_smfmac_f32_16x16x64_bf16 v[12:15], v[36:39], v[144:151], v25
    v_mov_b32_dpp v32, v51 quad_perm:[1,1,1,1] row_mask:0xf bank_mask:0x5
    v_mov_b32_dpp v33, v23 quad_perm:[2,2,2,2] row_mask:0xf bank_mask:0xa
    s_waitcnt vmcnt(8)
    s_cbranch_vccz L_pc_218
    s_waitcnt vmcnt(6)
L_pc_218:
    buffer_load_dwordx4 v[184:187], v1, s[32:35], s87 offen offset:2048 nt
    s_waitcnt vmcnt(8)
    s_cbranch_vccz L_pc_219
    s_waitcnt vmcnt(6)
L_pc_219:
    buffer_load_dwordx4 v[188:191], v1, s[32:35], s87 offen offset:3072 nt
    v_smfmac_f32_16x16x64_bf16 v[16:19], v[36:39], v[152:159], v25
    v_mov_b32_dpp v34, v23 quad_perm:[2,2,2,2] row_mask:0xf bank_mask:0x5
    v_mov_b32_dpp v35, v51 quad_perm:[1,1,1,1] row_mask:0xf bank_mask:0xa
    s_waitcnt vmcnt(6)
    v_cmp_ne_u32 vcc, 0, v2
    s_nop 0
    s_and_b32 vcc_lo, vcc_lo, 0x0fffffff
    s_bcnt1_i32_b32 s100, vcc_lo
    s_cmp_lt_u32 s100, 18
    s_cselect_b32 s100, -1, 0
    s_mov_b32 vcc_lo, s100
    s_mov_b32 vcc_hi, 0
    s_cbranch_vccz L_pc_220
L_wa18:
    s_cbranch_execz L_wr4
    s_waitcnt vmcnt(5)
L_pc_220:
    s_add_u32 s87, s86, 0x4038000
    buffer_load_dwordx4 v[192:195], v1, s[32:35], s87 offen offset:0 nt
    v_smfmac_f32_16x16x64_bf16 v[12:15], v[28:31], v[160:167], v25
    v_mov_b32_dpp v36, v51 quad_perm:[2,2,2,2] row_mask:0xf bank_mask:0x5
    v_mov_b32_dpp v37, v23 quad_perm:[1,1,1,1] row_mask:0xf bank_mask:0xa
    s_cbranch_vccz L_pc_221
    s_waitcnt vmcnt(5)
L_pc_221:
    buffer_load_dwordx4 v[196:199], v1, s[32:35], s87 offen offset:1024 nt
    s_waitcnt vmcnt(7)
    s_cbranch_vccz L_pc_222
    s_waitcnt vmcnt(5)
L_pc_222:
    buffer_load_dwordx4 v[200:203], v1, s[32:35], s87 offen offset:2048 nt
    s_waitcnt vmcnt(7)
    s_cbranch_vccz L_pc_223
    s_waitcnt vmcnt(5)
L_pc_223:
    buffer_load_dwordx4 v[204:207], v1, s[32:35], s87 offen offset:3072 nt
    v_smfmac_f32_16x16x64_bf16 v[16:19], v[28:31], v[168:175], v25
    v_mov_b32_dpp v38, v23 quad_perm:[1,1,1,1] row_mask:0xf bank_mask:0x5
    v_mov_b32_dpp v39, v51 quad_perm:[2,2,2,2] row_mask:0xf bank_mask:0xa
    s_waitcnt vmcnt(7)
    s_cbranch_vccz L_pc_224
    s_waitcnt vmcnt(5)
L_pc_224:
    s_add_u32 s87, s44, 0x403c000
    buffer_load_dwordx4 v[208:211], v1, s[32:35], s87 offen offset:0 nt
    s_waitcnt vmcnt(7)
    s_cbranch_vccz L_pc_225
    s_waitcnt vmcnt(5)
L_pc_225:
    buffer_load_dwordx4 v[212:215], v1, s[32:35], s87 offen offset:1024 nt
    v_smfmac_f32_16x16x64_bf16 v[12:15], v[32:35], v[176:183], v25
    v_mov_b32_dpp v28, v51 quad_perm:[3,3,3,3] row_mask:0xf bank_mask:0x5
    v_mov_b32_dpp v29, v23 quad_perm:[0,0,0,0] row_mask:0xf bank_mask:0xa
    s_waitcnt vmcnt(7)
    s_cbranch_vccz L_pc_226
    s_waitcnt vmcnt(5)
L_pc_226:
    buffer_load_dwordx4 v[216:219], v1, s[32:35], s87 offen offset:2048 nt
    s_waitcnt vmcnt(7)
    s_cbranch_vccz L_pc_227
    s_waitcnt vmcnt(5)
L_pc_227:
    buffer_load_dwordx4 v[220:223], v1, s[32:35], s87 offen offset:3072 nt
    v_smfmac_f32_16x16x64_bf16 v[16:19], v[32:35], v[184:191], v25
    v_mov_b32_dpp v30, v23 quad_perm:[0,0,0,0] row_mask:0xf bank_mask:0x5
    v_mov_b32_dpp v31, v51 quad_perm:[3,3,3,3] row_mask:0xf bank_mask:0xa
    s_waitcnt vmcnt(7)
    s_cbranch_vccz L_pc_228
    s_waitcnt vmcnt(5)
L_pc_228:
    s_add_u32 s87, s86, 0x4040000
    buffer_load_dwordx4 v[224:227], v1, s[32:35], s87 offen offset:0 nt
    s_waitcnt vmcnt(7)
    s_cbranch_vccz L_pc_229
    s_waitcnt vmcnt(5)
L_pc_229:
    buffer_load_dwordx4 v[228:231], v1, s[32:35], s87 offen offset:1024 nt
    v_smfmac_f32_16x16x64_bf16 v[12:15], v[36:39], v[192:199], v25
    v_mov_b32_dpp v32, v3 quad_perm:[0,0,0,0] row_mask:0xf bank_mask:0x5
    v_mov_b32_dpp v33, v24 quad_perm:[3,3,3,3] row_mask:0xf bank_mask:0xa
    s_waitcnt vmcnt(7)
    s_cbranch_vccz L_pc_230
    s_waitcnt vmcnt(5)
L_pc_230:
    buffer_load_dwordx4 v[232:235], v1, s[32:35], s87 offen offset:2048 nt
    s_waitcnt vmcnt(7)
    s_cbranch_vccz L_pc_231
    s_waitcnt vmcnt(5)
L_pc_231:
    buffer_load_dwordx4 v[236:239], v1, s[32:35], s87 offen offset:3072 nt
    v_smfmac_f32_16x16x64_bf16 v[16:19], v[36:39], v[200:207], v25
    v_mov_b32_dpp v34, v24 quad_perm:[3,3,3,3] row_mask:0xf bank_mask:0x5
    v_mov_b32_dpp v35, v3 quad_perm:[0,0,0,0] row_mask:0xf bank_mask:0xa
    s_waitcnt vmcnt(7)
    s_cbranch_vccz L_pc_232
    s_waitcnt vmcnt(5)
L_pc_232:
    s_add_u32 s87, s44, 0x4044000
    buffer_load_dwordx4 v[240:243], v1, s[32:35], s87 offen offset:0 nt
    s_waitcnt vmcnt(7)
    s_cbranch_vccz L_pc_233
    s_waitcnt vmcnt(5)
L_pc_233:
    buffer_load_dwordx4 v[244:247], v1, s[32:35], s87 offen offset:1024 nt
    v_smfmac_f32_16x16x64_bf16 v[12:15], v[28:31], v[208:215], v25
    v_mov_b32_dpp v36, v3 quad_perm:[1,1,1,1] row_mask:0xf bank_mask:0x5
    v_mov_b32_dpp v37, v24 quad_perm:[2,2,2,2] row_mask:0xf bank_mask:0xa
    s_waitcnt vmcnt(7)
    s_cbranch_vccz L_pc_234
    s_waitcnt vmcnt(5)
L_pc_234:
    buffer_load_dwordx4 v[248:251], v1, s[32:35], s87 offen offset:2048 nt
M_e1:
    s_waitcnt vmcnt(7)
    s_cbranch_vccz L_pc_235
    s_waitcnt vmcnt(5)
L_pc_235:
    buffer_load_dwordx4 v[252:255], v1, s[32:35], s87 offen offset:3072 nt
    v_smfmac_f32_16x16x64_bf16 v[16:19], v[28:31], v[216:223], v25
    v_mov_b32_dpp v38, v24 quad_perm:[2,2,2,2] row_mask:0xf bank_mask:0x5
    v_mov_b32_dpp v39, v3 quad_perm:[1,1,1,1] row_mask:0xf bank_mask:0xa
    s_waitcnt vmcnt(1)
    v_smfmac_f32_16x16x64_bf16 v[12:15], v[32:35], v[224:231], v25
    v_smfmac_f32_16x16x64_bf16 v[16:19], v[32:35], v[232:239], v25
    v_smfmac_f32_16x16x64_bf16 v[12:15], v[36:39], v[240:247], v25
    s_add_u32 s87, s86, 0x4008000
    buffer_load_dwordx4 a[32:35], v4, s[28:31], s87 offen offset:0 nt
    s_waitcnt vmcnt(1)
    v_smfmac_f32_16x16x64_bf16 v[16:19], v[36:39], v[248:255], v25
M_pub1:
    s_lshl_b32 s73, s99, 5
    v_add_u32 v0, s73, v5
    s_nop 1
    v_permlane32_swap_b32 v12, v14
    v_permlane32_swap_b32 v13, v15
    s_nop 1
    v_permlane32_swap_b32 v16, v18
    v_permlane32_swap_b32 v17, v19
    v_add_f32 v12, v12, v18
    v_add_f32 v13, v13, v19
    v_mul_f32 v12, v12, v27
    v_mul_f32 v13, v13, v27
    s_cmp_lg_u32 s3, 0
    ds_write_b64 v0, v[12:13] offset:0
    v_lshrrev_b32 v28, 8, v5
    v_and_b32 v29, 0xf8, v5
    v_lshl_or_b32 v34, v28, 2, v29
    s_waitcnt lgkmcnt(0)
    s_barrier
    s_cbranch_scc1 L_np1
    ds_read_b64 v[28:29], v5 offset:512
    ds_read_b64 v[30:31], v5 offset:1024
    ds_read_b64 v[32:33], v5 offset:1536
    s_waitcnt lgkmcnt(2)
    v_pk_add_f32 v[12:13], v[12:13], v[28:29]
    s_waitcnt lgkmcnt(0)
    v_pk_add_f32 v[30:31], v[30:31], v[32:33]
    v_pk_add_f32 v[12:13], v[12:13], v[30:31]
    v_cvt_pk_bf16_f32 v12, v12, v13
    v_min_u32 v12, -2, v12
    s_cmp_eq_u32 s98, 0
    s_cbranch_scc0 L_st_o1
    buffer_store_dword v12, v34, s[36:39], s90 offen
L_str_o1:
L_np1:
    buffer_load_dwordx4 a[36:39], v4, s[28:31], s87 offen offset:256 nt
    s_waitcnt vmcnt(1)
    buffer_load_dwordx4 a[40:43], v4, s[28:31], s87 offen offset:2048 nt
    s_waitcnt vmcnt(1)
    buffer_load_dwordx4 a[44:47], v4, s[28:31], s87 offen offset:2304 nt
    s_waitcnt vmcnt(1)
    s_add_u32 s87, s44, 0x400c000
    buffer_load_dwordx4 a[48:51], v4, s[28:31], s87 offen offset:0 nt
    s_waitcnt vmcnt(1)
    buffer_load_dwordx4 a[52:55], v4, s[28:31], s87 offen offset:256 nt
    s_add_u32 s87, s86, 0x4020000
    buffer_load_dwordx4 a[136:139], v4, s[28:31], s87 offen offset:2048 nt
    buffer_load_dwordx4 a[140:143], v4, s[28:31], s87 offen offset:2304 nt
    s_add_u32 s87, s44, 0x4024000
    buffer_load_dwordx4 a[144:147], v4, s[28:31], s87 offen offset:0 nt
    s_waitcnt vmcnt(4)
    buffer_load_dwordx4 a[148:151], v4, s[28:31], s87 offen offset:256 nt
    s_waitcnt vmcnt(4)
    buffer_load_dwordx4 a[152:155], v4, s[28:31], s87 offen offset:2048 nt
    s_waitcnt vmcnt(4)
    buffer_load_dwordx4 a[156:159], v4, s[28:31], s87 offen offset:2304 nt
    s_waitcnt vmcnt(4)
    s_add_u32 s87, s86, 0x4028000
    buffer_load_dwordx4 a[160:163], v4, s[28:31], s87 offen offset:0 nt
    s_waitcnt vmcnt(4)
    buffer_load_dwordx4 a[164:167], v4, s[28:31], s87 offen offset:256 nt
    s_waitcnt vmcnt(4)
    buffer_load_dwordx4 a[168:171], v4, s[28:31], s87 offen offset:2048 nt
    s_waitcnt vmcnt(4)
    buffer_load_dwordx4 a[172:175], v4, s[28:31], s87 offen offset:2304 nt
    s_add_u32 s87, s44, 0x400c000
    buffer_load_dwordx4 a[56:59], v4, s[28:31], s87 offen offset:2048 nt
    buffer_load_dwordx4 a[60:63], v4, s[28:31], s87 offen offset:2304 nt
    s_add_u32 s87, s86, 0x4010000
    buffer_load_dwordx4 a[64:67], v4, s[28:31], s87 offen offset:0 nt
    buffer_load_dwordx4 a[68:71], v4, s[28:31], s87 offen offset:256 nt
    buffer_load_dwordx4 a[72:75], v4, s[28:31], s87 offen offset:2048 nt
    buffer_load_dwordx4 a[76:79], v4, s[28:31], s87 offen offset:2304 nt
    s_add_u32 s87, s44, 0x4014000
    buffer_load_dwordx4 a[80:83], v4, s[28:31], s87 offen offset:0 nt
    s_waitcnt vmcnt(11)
    buffer_load_dwordx4 a[84:87], v4, s[28:31], s87 offen offset:256 nt
    s_waitcnt vmcnt(11)
    buffer_load_dwordx4 a[88:91], v4, s[28:31], s87 offen offset:2048 nt
    s_waitcnt vmcnt(11)
    buffer_load_dwordx4 a[92:95], v4, s[28:31], s87 offen offset:2304 nt
L_wa19:
    s_cbranch_execz L_wr4
    s_waitcnt vmcnt(11)
    s_add_u32 s87, s86, 0x4018000
    buffer_load_dwordx4 a[96:99], v4, s[28:31], s87 offen offset:0 nt
    s_waitcnt vmcnt(11)
    buffer_load_dwordx4 a[100:103], v4, s[28:31], s87 offen offset:256 nt
    s_waitcnt vmcnt(11)
    buffer_load_dwordx4 a[104:107], v4, s[28:31], s87 offen offset:2048 nt
    s_waitcnt vmcnt(11)
    buffer_load_dwordx4 a[108:111], v4, s[28:31], s87 offen offset:2304 nt
    s_waitcnt vmcnt(11)
    s_add_u32 s87, s44, 0x401c000
    buffer_load_dwordx4 a[112:115], v4, s[28:31], s87 offen offset:0 nt
    s_waitcnt vmcnt(11)
    buffer_load_dwordx4 a[116:119], v4, s[28:31], s87 offen offset:256 nt
    s_waitcnt vmcnt(11)
    buffer_load_dwordx4 a[120:123], v4, s[28:31], s87 offen offset:2048 nt
    s_waitcnt vmcnt(11)
    buffer_load_dwordx4 a[124:127], v4, s[28:31], s87 offen offset:2304 nt
    s_waitcnt vmcnt(11)
    s_add_u32 s87, s86, 0x4020000
    buffer_load_dwordx4 a[128:131], v4, s[28:31], s87 offen offset:0 nt
    s_waitcnt vmcnt(11)
    buffer_load_dwordx4 a[132:135], v4, s[28:31], s87 offen offset:256 nt
    s_add_u32 s90, s92, 0x1100
    s_add_u32 s91, s93, 0x60
    s_add_u32 s73, s89, 0x700
    buffer_load_dwordx4 v[40:43], v6, s[36:39], s73 offen sc1
    v_mov_b64 v[12:13], 0
    v_mov_b64 v[14:15], 0
    v_mov_b64 v[16:17], 0
    v_mov_b64 v[18:19], 0
    v_mov_b64 v[20:21], 0
    v_mov_b64 v[22:23], 0
    v_mov_b64 v[24:25], 0
    v_mov_b64 v[26:27], 0
    s_cmp_eq_u32 s3, s3
    s_nop 0
    s_branch L_p2
    s_endpgm
    s_endpgm
    s_endpgm
L_q3r:
    buffer_load_dwordx4 v[40:43], v6, s[36:39], s73 offen sc1
    s_sub_u32 s72, s72, 1
    s_cbranch_scc0 L_q3
    s_endpgm
L_q3:
    s_cmp_lg_u32 s3, s3
    s_waitcnt vmcnt(0)
    v_max3_u32 v36, v40, v41, v42
    v_max_u32 v36, v36, v43
    v_cmp_eq_u32 vcc, -1, v36
    v_mov_b32_dpp v12, v40 quad_perm:[0,1,2,3] row_mask:0xf bank_mask:0x1
    v_mov_b32_dpp v13, v41 quad_perm:[0,1,2,3] row_mask:0xf bank_mask:0x1
    v_mov_b32_dpp v14, v42 quad_perm:[0,1,2,3] row_mask:0xf bank_mask:0x1
    v_mov_b32_dpp v15, v43 quad_perm:[0,1,2,3] row_mask:0xf bank_mask:0x1
    v_mov_b32_dpp v16, v40 quad_perm:[0,1,2,3] row_mask:0xf bank_mask:0x2
    v_mov_b32_dpp v17, v41 quad_perm:[0,1,2,3] row_mask:0xf bank_mask:0x2
    s_cbranch_vccnz L_q3r
L_p2:
    v_mfma_f32_16x16x32_bf16 v[28:31], a[0:3], v[12:15], 0
    v_mov_b32_dpp v18, v42 quad_perm:[0,1,2,3] row_mask:0xf bank_mask:0x2
    v_mov_b32_dpp v19, v43 quad_perm:[0,1,2,3] row_mask:0xf bank_mask:0x2
    v_mfma_f32_16x16x32_bf16 v[32:35], a[16:19], v[12:15], 0
    v_mov_b32_dpp v20, v40 quad_perm:[0,1,2,3] row_mask:0xf bank_mask:0x4
    v_mov_b32_dpp v21, v41 quad_perm:[0,1,2,3] row_mask:0xf bank_mask:0x4
    v_mfma_f32_16x16x32_bf16 v[28:31], a[4:7], v[16:19], v[28:31]
    v_mov_b32_dpp v22, v42 quad_perm:[0,1,2,3] row_mask:0xf bank_mask:0x4
    v_mov_b32_dpp v23, v43 quad_perm:[0,1,2,3] row_mask:0xf bank_mask:0x4
    v_mfma_f32_16x16x32_bf16 v[32:35], a[20:23], v[16:19], v[32:35]
    v_mov_b32_dpp v24, v40 quad_perm:[0,1,2,3] row_mask:0xf bank_mask:0x8
    v_mov_b32_dpp v25, v41 quad_perm:[0,1,2,3] row_mask:0xf bank_mask:0x8
    v_mfma_f32_16x16x32_bf16 v[28:31], a[8:11], v[20:23], v[28:31]
    v_mov_b32_dpp v26, v42 quad_perm:[0,1,2,3] row_mask:0xf bank_mask:0x8
    v_mov_b32_dpp v27, v43 quad_perm:[0,1,2,3] row_mask:0xf bank_mask:0x8
    v_mfma_f32_16x16x32_bf16 v[32:35], a[24:27], v[20:23], v[32:35]
    v_mov_b32 v0, 0xff800000
    v_mfma_f32_16x16x32_bf16 v[28:31], a[12:15], v[24:27], v[28:31]
    s_nop 0
    s_cbranch_scc1 L_q3
    v_mfma_f32_16x16x32_bf16 v[32:35], a[28:31], v[24:27], v[32:35]
    s_branch L_p2b
L_service:
    v_lshlrev_b32 v1, 4, v0
    v_and_b32 v32, 7, v0
    v_lshlrev_b32 v6, 5, v32
    v_lshrrev_b32 v32, 5, v0
    v_lshl_or_b32 v6, v32, 4, v6
    v_bfe_u32 v32, v0, 3, 1
    v_lshl_or_b32 v6, v32, 3, v6
    v_bfe_u32 v32, v0, 4, 1
    v_lshl_or_b32 v6, v32, 2, v6
    s_lshl_b32 s73, s3, 8
    v_add_u32 v6, s73, v6
    v_lshlrev_b32 v34, 5, v32
    v_lshrrev_b32 v32, 5, v0
    v_lshl_or_b32 v34, v32, 1, v34
    v_and_b32 v33, 0xf0, v1
    v_lshl_or_b32 v35, v34, 13, v33
    s_lshl_b32 s73, s3, 20
    s_lshl_b32 s74, s2, 8
    s_add_u32 s73, s73, s74
    s_waitcnt lgkmcnt(0)
    s_mov_b32 s44, s10
    s_mov_b32 s45, s11
    s_mov_b32 s46, 0x400000
    s_mov_b32 s47, 0x00020000
    s_mov_b32 s64, s4
    s_mov_b32 s65, s5
    s_mov_b32 s66, 0x800
    s_mov_b32 s67, 0x00020000
    s_mov_b32 s36, s26
    s_mov_b32 s37, s27
    s_mov_b32 s38, 0x108800
    s_mov_b32 s39, 0x00020000
    v_lshlrev_b32 v2, 3, v0
    s_mul_i32 s89, s2, 11264
    v_mov_b32 v28, -1
    v_mov_b32 v29, -1
    v_mov_b32 v30, -1
    v_mov_b32 v31, -1
    s_lshl_b32 s95, s3, 8
    s_add_u32 s95, s95, s89
    s_mov_b64 exec, 0xffff
    buffer_store_dwordx4 v[28:31], v1, s[36:39], s95 offen sc1
    buffer_store_dwordx4 v[28:31], v1, s[36:39], s95 offen offset:1024
    buffer_store_dwordx4 v[28:31], v1, s[36:39], s95 offen offset:2048 sc1
    s_mov_b64 exec, -1
    v_and_b32 v32, 0xf0, v1
    v_bfe_u32 v33, v0, 4, 1
    v_lshl_or_b32 v32, v33, 13, v32
    v_lshrrev_b32 v33, 5, v0
    v_lshl_or_b32 v32, v33, 17, v32
    s_lshl_b32 s74, s3, 7
    s_add_u32 s74, s74, s2
    s_lshl_b32 s74, s74, 8
    s_add_u32 s74, s74, 0x80000
    buffer_store_dwordx4 v[28:31], v32, s[36:39], s74 offen sc1
    s_add_u32 s95, s74, 0x40000
    buffer_store_dwordx4 v[28:31], v32, s[36:39], s95 offen sc1
    s_sub_u32 s74, s74, 0x28000
    s_mov_b32 exec_hi, 0
    buffer_store_dwordx4 v[28:31], v32, s[36:39], s74 offen sc1
    s_mov_b32 exec_hi, -1
    s_add_u32 s74, s73, 0x0
    buffer_load_dwordx4 v[132:135], v35, s[44:47], s74 offen nt
    s_add_u32 s74, s73, 0x2000
    buffer_load_dwordx4 v[140:143], v35, s[44:47], s74 offen nt
    s_add_u32 s74, s73, 0x20000
    buffer_load_dwordx4 v[148:151], v35, s[44:47], s74 offen nt
    s_add_u32 s74, s73, 0x22000
    buffer_load_dwordx4 v[156:159], v35, s[44:47], s74 offen nt
    s_add_u32 s74, s73, 0x80000
    buffer_load_dwordx4 v[164:167], v35, s[44:47], s74 offen nt
    s_add_u32 s74, s73, 0x82000
    buffer_load_dwordx4 v[172:175], v35, s[44:47], s74 offen nt
    s_add_u32 s74, s73, 0xa0000
    buffer_load_dwordx4 v[180:183], v35, s[44:47], s74 offen nt
    s_add_u32 s74, s73, 0xa2000
    buffer_load_dwordx4 v[188:191], v35, s[44:47], s74 offen nt
    s_add_u32 s74, s73, 0x8000
    buffer_load_dwordx4 v[196:199], v35, s[44:47], s74 offen nt
    s_add_u32 s74, s73, 0xa000
    buffer_load_dwordx4 v[204:207], v35, s[44:47], s74 offen nt
    s_add_u32 s74, s73, 0x28000
    buffer_load_dwordx4 v[212:215], v35, s[44:47], s74 offen nt
    s_add_u32 s74, s73, 0x2a000
    buffer_load_dwordx4 v[220:223], v35, s[44:47], s74 offen nt
    s_add_u32 s74, s73, 0x88000
    buffer_load_dwordx4 v[228:231], v35, s[44:47], s74 offen nt
    s_add_u32 s74, s73, 0x8a000
    buffer_load_dwordx4 v[236:239], v35, s[44:47], s74 offen nt
    s_add_u32 s74, s73, 0xa8000
    buffer_load_dwordx4 v[244:247], v35, s[44:47], s74 offen nt
    s_add_u32 s74, s73, 0xaa000
    buffer_load_dwordx4 v[252:255], v35, s[44:47], s74 offen nt
    s_add_u32 s74, s73, 0x10000
    buffer_load_dwordx4 v[128:131], v35, s[44:47], s74 offen nt
    s_add_u32 s74, s73, 0x12000
    buffer_load_dwordx4 v[136:139], v35, s[44:47], s74 offen nt
    s_add_u32 s74, s73, 0x30000
    buffer_load_dwordx4 v[144:147], v35, s[44:47], s74 offen nt
    s_add_u32 s74, s73, 0x32000
    buffer_load_dwordx4 v[152:155], v35, s[44:47], s74 offen nt
    s_add_u32 s74, s73, 0x90000
    buffer_load_dwordx4 v[160:163], v35, s[44:47], s74 offen nt
    s_add_u32 s74, s73, 0x92000
    buffer_load_dwordx4 v[168:171], v35, s[44:47], s74 offen nt
    s_add_u32 s74, s73, 0xb0000
    buffer_load_dwordx4 v[176:179], v35, s[44:47], s74 offen nt
    s_add_u32 s74, s73, 0xb2000
    buffer_load_dwordx4 v[184:187], v35, s[44:47], s74 offen nt
    s_add_u32 s74, s73, 0x18000
    buffer_load_dwordx4 v[192:195], v35, s[44:47], s74 offen nt
    s_add_u32 s74, s73, 0x1a000
    buffer_load_dwordx4 v[200:203], v35, s[44:47], s74 offen nt
    s_add_u32 s74, s73, 0x38000
    buffer_load_dwordx4 v[208:211], v35, s[44:47], s74 offen nt
    s_add_u32 s74, s73, 0x3a000
    buffer_load_dwordx4 v[216:219], v35, s[44:47], s74 offen nt
    s_add_u32 s74, s73, 0x98000
    buffer_load_dwordx4 v[224:227], v35, s[44:47], s74 offen nt
    s_add_u32 s74, s73, 0x9a000
    buffer_load_dwordx4 v[232:235], v35, s[44:47], s74 offen nt
    s_add_u32 s74, s73, 0xb8000
    buffer_load_dwordx4 v[240:243], v35, s[44:47], s74 offen nt
    s_add_u32 s74, s73, 0xba000
    buffer_load_dwordx4 v[248:251], v35, s[44:47], s74 offen nt
    buffer_load_dword v14, v6, s[64:67], 0 offen
    buffer_load_dword v114, v6, s[64:67], 0 offen offset:1024
    s_mov_b32 s28, s6
    s_mov_b32 s29, s7
    s_mov_b32 s30, 0x8000000
    s_mov_b32 s31, 0x00020000
    s_mov_b32 s32, s8
    s_mov_b32 s33, s9
    s_mov_b32 s34, 0x8000000
    s_mov_b32 s35, 0x00020000
    s_mov_b32 s40, s24
    s_mov_b32 s41, s25
    s_mov_b32 s42, 0x100
    s_mov_b32 s43, 0x00020000
    s_mov_b32 s48, s12
    s_mov_b32 s49, s13
    s_mov_b32 s50, 0x400000
    s_mov_b32 s51, 0x00020000
    s_mov_b32 s52, s16
    s_mov_b32 s53, s17
    s_mov_b32 s54, 0x1c0000
    s_mov_b32 s55, 0x00020000
    s_mov_b32 s56, s18
    s_mov_b32 s57, s19
    s_mov_b32 s58, 0x1c0000
    s_mov_b32 s59, 0x00020000
    s_mov_b32 s60, s20
    s_mov_b32 s61, s21
    s_mov_b32 s62, 0x1c0000
    s_mov_b32 s63, 0x00020000
    s_mov_b32 s68, s22
    s_mov_b32 s69, s23
    s_mov_b32 s70, 0x800
    s_mov_b32 s71, 0x00020000
    s_mov_b32 s76, 0x00ff00ff
    s_mov_b32 s77, 0x00ff00ff
    s_mov_b32 s78, 0x00010001
    s_mov_b32 s79, 0x00010001
    v_and_b32 v32, 3, v0
    v_lshlrev_b32 v32, 4, v32
    v_bfe_u32 v33, v0, 2, 2
    v_lshl_or_b32 v32, v33, 9, v32
    v_lshrrev_b32 v33, 4, v0
    v_lshl_or_b32 v32, v33, 6, v32
    v_and_b32 v33, 0x300, v1
    v_add_u32 v33, v33, v1
    s_lshr_b32 s73, s3, 1
    s_lshl_b32 s73, s73, 11
    s_and_b32 s74, s3, 1
    s_lshl_b32 s74, s74, 8
    s_add_u32 s73, s73, s74
    s_lshl_b32 s74, s2, 21
    s_add_u32 s73, s73, s74
    s_lshl_b32 s99, s3, 12
    s_add_u32 s99, s99, 20480
    s_add_u32 s74, s73, 0x1ff000
    s_add_u32 m0, s99, 0x0
    s_nop 0
    buffer_load_dwordx4 v32, s[28:31], s74 offen nt lds
    s_add_u32 m0, s99, 0x400
    s_nop 0
    buffer_load_dwordx4 v33, s[32:35], s74 offen nt lds
    s_add_u32 s74, s73, 0x41ff000
    s_add_u32 m0, s99, 0x800
    s_nop 0
    buffer_load_dwordx4 v32, s[28:31], s74 offen nt lds
    s_add_u32 m0, s99, 0xc00
    s_nop 0
    buffer_load_dwordx4 v33, s[32:35], s74 offen nt lds
    v_mov_b32 v3, 0x44444444
    v_mov_b32 v32, 0x11114444
    v_cndmask_b32 v3, v32, v3, s[76:77]
    v_and_b32 v32, 1, v0
    v_sub_u32 v32, 0, v32
    v_and_b32 v32, 0xaaaaaaaa, v32
    v_or_b32 v3, v3, v32
    v_and_b32 v5, 0x18, v2
    v_bfe_u32 v32, v0, 2, 1
    v_lshl_or_b32 v5, v32, 9, v5
    v_lshrrev_b32 v32, 4, v0
    v_lshl_or_b32 v5, v32, 7, v5
    v_lshlrev_b32 v4, 9, v0
    s_lshl_b32 s73, s3, 9
    v_add_u32 v7, s73, v2
    s_and_b32 s73, s2, 7
    s_lshl3_add_u32 s98, s3, s73
    s_mul_i32 s93, s98, 11264
    s_lshl_b32 s73, s3, 4
    s_bitcmp1_b32 s3, 0
    s_cselect_b32 s4, 0, -1
    s_cselect_b32 s5, -1, 0
    v_lshrrev_b32 v13, 4, v0
    v_lshlrev_b32 v13, 2, v13
    v_add_u32 v13, s73, v13
    v_and_b32 v12, 0x30, v1
    s_lshl_b32 s73, s3, 14
    s_add_u32 s73, s73, 65536
    v_add_u32 v11, s73, v1
    v_lshrrev_b32 v32, 2, v0
    v_lshlrev_b32 v8, 3, v32
    v_and_b32 v32, 1, v0
    v_lshl_or_b32 v8, v32, 8, v8
    v_bfe_u32 v32, v0, 1, 1
    v_lshl_or_b32 v8, v32, 7, v8
    v_and_b32 v32, 15, v0
    v_lshlrev_b32 v32, 2, v32
    v_lshrrev_b32 v33, 4, v0
    v_lshl_or_b32 v32, v33, 7, v32
    v_add_u32 v9, 8192, v32
    v_add_u32 v10, 9216, v32
    s_lshl_b32 s92, s3, 8
    s_add_u32 s92, s92, 15360
    v_mov_b32 v28, 1.0
    v_mov_b32 v29, 1.0
    s_mov_b64 vcc, 0
    v_mov_b64 v[96:97], 0
    v_mov_b64 v[100:101], 0
    v_mov_b64 v[104:105], 0
    v_mov_b64 v[108:109], 0
    v_mov_b64 v[80:81], 0
    v_mov_b64 v[84:85], 0
    v_mov_b64 v[88:89], 0
    v_mov_b64 v[92:93], 0
    v_and_b32 v25, 0x1f0, v1
    v_lshrrev_b32 v26, 5, v0
    v_lshl_or_b32 v25, v26, 3, v25
    v_mul_u32_u24 v24, 7936, v26
    v_add_u32 v24, v24, v2
    s_lshl_b32 s74, s3, 9
    v_add_u32 v25, s74, v25
    v_lshlrev_b32 v26, 2, v0
    s_mov_b32 s0, 0x05040100
    s_mov_b32 s1, 0x07060302
    v_and_b32 v32, 0xf0, v1
    v_lshl_or_b32 v35, v34, 10, v32
    s_lshl_b32 s98, s98, 17
    s_lshr_b32 s73, s2, 3
    s_lshl_b32 s73, s73, 8
    s_add_u32 s98, s98, s73
    s_waitcnt vmcnt(36)
    v_perm_b32 v40, v140, v132, s0
    v_perm_b32 v41, v140, v132, s1
    v_perm_b32 v42, v141, v133, s0
    v_perm_b32 v43, v141, v133, s1
    v_perm_b32 v44, v142, v134, s0
    v_perm_b32 v45, v142, v134, s1
    v_perm_b32 v46, v143, v135, s0
    v_perm_b32 v47, v143, v135, s1
    v_accvgpr_write_b32 a0, v40
    v_accvgpr_write_b32 a8, v41
    v_accvgpr_write_b32 a80, v42
    v_accvgpr_write_b32 a88, v43
    v_accvgpr_write_b32 a98, v44
    v_accvgpr_write_b32 a106, v45
    v_accvgpr_write_b32 a50, v46
    v_accvgpr_write_b32 a58, v47
    s_waitcnt vmcnt(34)
    v_perm_b32 v40, v156, v148, s0
    v_perm_b32 v41, v156, v148, s1
    v_perm_b32 v42, v157, v149, s0
    v_perm_b32 v43, v157, v149, s1
    v_perm_b32 v44, v158, v150, s0
    v_perm_b32 v45, v158, v150, s1
    v_perm_b32 v46, v159, v151, s0
    v_perm_b32 v47, v159, v151, s1
    v_accvgpr_write_b32 a1, v40
    v_accvgpr_write_b32 a9, v41
    v_accvgpr_write_b32 a81, v42
    v_accvgpr_write_b32 a89, v43
    v_accvgpr_write_b32 a99, v44
    v_accvgpr_write_b32 a107, v45
    v_accvgpr_write_b32 a51, v46
    v_accvgpr_write_b32 a59, v47
    s_waitcnt vmcnt(32)
    v_perm_b32 v40, v172, v164, s0
    v_perm_b32 v41, v172, v164, s1
    v_perm_b32 v42, v173, v165, s0
    v_perm_b32 v43, v173, v165, s1
    v_perm_b32 v44, v174, v166, s0
    v_perm_b32 v45, v174, v166, s1
    v_perm_b32 v46, v175, v167, s0
    v_perm_b32 v47, v175, v167, s1
    v_accvgpr_write_b32 a2, v40
    v_accvgpr_write_b32 a10, v41
    v_accvgpr_write_b32 a82, v42
    v_accvgpr_write_b32 a90, v43
    v_accvgpr_write_b32 a32, v44
    v_accvgpr_write_b32 a40, v45
    v_accvgpr_write_b32 a112, v46
    v_accvgpr_write_b32 a120, v47
    s_waitcnt vmcnt(30)
    v_perm_b32 v40, v188, v180, s0
    v_perm_b32 v41, v188, v180, s1
    v_perm_b32 v42, v189, v181, s0
    v_perm_b32 v43, v189, v181, s1
    v_perm_b32 v44, v190, v182, s0
    v_perm_b32 v45, v190, v182, s1
    v_perm_b32 v46, v191, v183, s0
    v_perm_b32 v47, v191, v183, s1
    v_accvgpr_write_b32 a3, v40
    v_accvgpr_write_b32 a11, v41
    v_accvgpr_write_b32 a83, v42
    v_accvgpr_write_b32 a91, v43
    v_accvgpr_write_b32 a33, v44
    v_accvgpr_write_b32 a41, v45
    v_accvgpr_write_b32 a113, v46
    v_accvgpr_write_b32 a121, v47
    s_waitcnt vmcnt(28)
    v_perm_b32 v40, v204, v196, s0
    v_perm_b32 v41, v204, v196, s1
    v_perm_b32 v42, v205, v197, s0
    v_perm_b32 v43, v205, v197, s1
    v_perm_b32 v44, v206, v198, s0
    v_perm_b32 v45, v206, v198, s1
    v_perm_b32 v46, v207, v199, s0
    v_perm_b32 v47, v207, v199, s1
    v_accvgpr_write_b32 a64, v40
    v_accvgpr_write_b32 a72, v41
    v_accvgpr_write_b32 a16, v42
    v_accvgpr_write_b32 a24, v43
    v_accvgpr_write_b32 a34, v44
    v_accvgpr_write_b32 a42, v45
    v_accvgpr_write_b32 a114, v46
    v_accvgpr_write_b32 a122, v47
    s_waitcnt vmcnt(26)
    v_perm_b32 v40, v220, v212, s0
    v_perm_b32 v41, v220, v212, s1
    v_perm_b32 v42, v221, v213, s0
    v_perm_b32 v43, v221, v213, s1
    v_perm_b32 v44, v222, v214, s0
    v_perm_b32 v45, v222, v214, s1
    v_perm_b32 v46, v223, v215, s0
    v_perm_b32 v47, v223, v215, s1
    v_accvgpr_write_b32 a65, v40
    v_accvgpr_write_b32 a73, v41
    v_accvgpr_write_b32 a17, v42
    v_accvgpr_write_b32 a25, v43
    v_accvgpr_write_b32 a35, v44
    v_accvgpr_write_b32 a43, v45
    v_accvgpr_write_b32 a115, v46
    v_accvgpr_write_b32 a123, v47
    s_waitcnt vmcnt(24)
    v_perm_b32 v40, v236, v228, s0
    v_perm_b32 v41, v236, v228, s1
    v_perm_b32 v42, v237, v229, s0
    v_perm_b32 v43, v237, v229, s1
    v_perm_b32 v44, v238, v230, s0
    v_perm_b32 v45, v238, v230, s1
    v_perm_b32 v46, v239, v231, s0
    v_perm_b32 v47, v239, v231, s1
    v_accvgpr_write_b32 a66, v40
    v_accvgpr_write_b32 a74, v41
    v_accvgpr_write_b32 a18, v42
    v_accvgpr_write_b32 a26, v43
    v_accvgpr_write_b32 a96, v44
    v_accvgpr_write_b32 a104, v45
    v_accvgpr_write_b32 a48, v46
    v_accvgpr_write_b32 a56, v47
    s_waitcnt vmcnt(22)
    v_perm_b32 v40, v252, v244, s0
    v_perm_b32 v41, v252, v244, s1
    v_perm_b32 v42, v253, v245, s0
    v_perm_b32 v43, v253, v245, s1
    v_perm_b32 v44, v254, v246, s0
    v_perm_b32 v45, v254, v246, s1
    v_perm_b32 v46, v255, v247, s0
    v_perm_b32 v47, v255, v247, s1
    v_accvgpr_write_b32 a67, v40
    v_accvgpr_write_b32 a75, v41
    v_accvgpr_write_b32 a19, v42
    v_accvgpr_write_b32 a27, v43
    v_accvgpr_write_b32 a97, v44
    v_accvgpr_write_b32 a105, v45
    v_accvgpr_write_b32 a49, v46
    v_accvgpr_write_b32 a57, v47
    s_waitcnt vmcnt(20)
    v_perm_b32 v40, v136, v128, s0
    v_perm_b32 v41, v136, v128, s1
    v_perm_b32 v42, v137, v129, s0
    v_perm_b32 v43, v137, v129, s1
    v_perm_b32 v44, v138, v130, s0
    v_perm_b32 v45, v138, v130, s1
    v_perm_b32 v46, v139, v131, s0
    v_perm_b32 v47, v139, v131, s1
    v_accvgpr_write_b32 a4, v40
    v_accvgpr_write_b32 a12, v41
    v_accvgpr_write_b32 a84, v42
    v_accvgpr_write_b32 a92, v43
    v_accvgpr_write_b32 a102, v44
    v_accvgpr_write_b32 a110, v45
    v_accvgpr_write_b32 a54, v46
    v_accvgpr_write_b32 a62, v47
    s_waitcnt vmcnt(18)
    v_perm_b32 v40, v152, v144, s0
    v_perm_b32 v41, v152, v144, s1
    v_perm_b32 v42, v153, v145, s0
    v_perm_b32 v43, v153, v145, s1
    v_perm_b32 v44, v154, v146, s0
    v_perm_b32 v45, v154, v146, s1
    v_perm_b32 v46, v155, v147, s0
    v_perm_b32 v47, v155, v147, s1
    v_accvgpr_write_b32 a5, v40
    v_accvgpr_write_b32 a13, v41
    v_accvgpr_write_b32 a85, v42
    v_accvgpr_write_b32 a93, v43
    v_accvgpr_write_b32 a103, v44
    v_accvgpr_write_b32 a111, v45
    v_accvgpr_write_b32 a55, v46
    v_accvgpr_write_b32 a63, v47
    s_waitcnt vmcnt(16)
    v_perm_b32 v40, v168, v160, s0
    v_perm_b32 v41, v168, v160, s1
    v_perm_b32 v42, v169, v161, s0
    v_perm_b32 v43, v169, v161, s1
    v_perm_b32 v44, v170, v162, s0
    v_perm_b32 v45, v170, v162, s1
    v_perm_b32 v46, v171, v163, s0
    v_perm_b32 v47, v171, v163, s1
    v_accvgpr_write_b32 a6, v40
    v_accvgpr_write_b32 a14, v41
    v_accvgpr_write_b32 a86, v42
    v_accvgpr_write_b32 a94, v43
    v_accvgpr_write_b32 a36, v44
    v_accvgpr_write_b32 a44, v45
    v_accvgpr_write_b32 a116, v46
    v_accvgpr_write_b32 a124, v47
    s_waitcnt vmcnt(14)
    v_perm_b32 v40, v184, v176, s0
    v_perm_b32 v41, v184, v176, s1
    v_perm_b32 v42, v185, v177, s0
    v_perm_b32 v43, v185, v177, s1
    v_perm_b32 v44, v186, v178, s0
    v_perm_b32 v45, v186, v178, s1
    v_perm_b32 v46, v187, v179, s0
    v_perm_b32 v47, v187, v179, s1
    v_accvgpr_write_b32 a7, v40
    v_accvgpr_write_b32 a15, v41
    v_accvgpr_write_b32 a87, v42
    v_accvgpr_write_b32 a95, v43
    v_accvgpr_write_b32 a37, v44
    v_accvgpr_write_b32 a45, v45
    v_accvgpr_write_b32 a117, v46
    v_accvgpr_write_b32 a125, v47
    s_waitcnt vmcnt(12)
    v_perm_b32 v40, v200, v192, s0
    v_perm_b32 v41, v200, v192, s1
    v_perm_b32 v42, v201, v193, s0
    v_perm_b32 v43, v201, v193, s1
    v_perm_b32 v44, v202, v194, s0
    v_perm_b32 v45, v202, v194, s1
    v_perm_b32 v46, v203, v195, s0
    v_perm_b32 v47, v203, v195, s1
    v_accvgpr_write_b32 a68, v40
    v_accvgpr_write_b32 a76, v41
    v_accvgpr_write_b32 a20, v42
    v_accvgpr_write_b32 a28, v43
    v_accvgpr_write_b32 a38, v44
    v_accvgpr_write_b32 a46, v45
    v_accvgpr_write_b32 a118, v46
    v_accvgpr_write_b32 a126, v47
    s_waitcnt vmcnt(10)
    v_perm_b32 v40, v216, v208, s0
    v_perm_b32 v41, v216, v208, s1
    v_perm_b32 v42, v217, v209, s0
    v_perm_b32 v43, v217, v209, s1
    v_perm_b32 v44, v218, v210, s0
    v_perm_b32 v45, v218, v210, s1
    v_perm_b32 v46, v219, v211, s0
    v_perm_b32 v47, v219, v211, s1
    v_accvgpr_write_b32 a69, v40
    v_accvgpr_write_b32 a77, v41
    v_accvgpr_write_b32 a21, v42
    v_accvgpr_write_b32 a29, v43
    v_accvgpr_write_b32 a39, v44
    v_accvgpr_write_b32 a47, v45
    v_accvgpr_write_b32 a119, v46
    v_accvgpr_write_b32 a127, v47
    s_add_u32 s74, s98, 0x0
    buffer_load_dwordx4 v[132:135], v35, s[48:51], s74 offen nt
    s_add_u32 s74, s98, 0x400
    buffer_load_dwordx4 v[140:143], v35, s[48:51], s74 offen nt
    s_add_u32 s74, s98, 0x4000
    buffer_load_dwordx4 v[148:151], v35, s[48:51], s74 offen nt
    s_add_u32 s74, s98, 0x4400
    buffer_load_dwordx4 v[156:159], v35, s[48:51], s74 offen nt
    s_add_u32 s74, s98, 0x10000
    buffer_load_dwordx4 v[164:167], v35, s[48:51], s74 offen nt
    s_add_u32 s74, s98, 0x10400
    buffer_load_dwordx4 v[172:175], v35, s[48:51], s74 offen nt
    s_add_u32 s74, s98, 0x14000
    buffer_load_dwordx4 v[180:183], v35, s[48:51], s74 offen nt
    s_add_u32 s74, s98, 0x14400
    buffer_load_dwordx4 v[188:191], v35, s[48:51], s74 offen nt
    s_waitcnt vmcnt(16)
    v_perm_b32 v40, v232, v224, s0
    v_perm_b32 v41, v232, v224, s1
    v_perm_b32 v42, v233, v225, s0
    v_perm_b32 v43, v233, v225, s1
    v_perm_b32 v44, v234, v226, s0
    v_perm_b32 v45, v234, v226, s1
    v_perm_b32 v46, v235, v227, s0
    v_perm_b32 v47, v235, v227, s1
    v_accvgpr_write_b32 a70, v40
    v_accvgpr_write_b32 a78, v41
    v_accvgpr_write_b32 a22, v42
    v_accvgpr_write_b32 a30, v43
    v_accvgpr_write_b32 a100, v44
    v_accvgpr_write_b32 a108, v45
    v_accvgpr_write_b32 a52, v46
    v_accvgpr_write_b32 a60, v47
    s_waitcnt vmcnt(14)
    v_perm_b32 v40, v248, v240, s0
    v_perm_b32 v41, v248, v240, s1
    v_perm_b32 v42, v249, v241, s0
    v_perm_b32 v43, v249, v241, s1
    v_perm_b32 v44, v250, v242, s0
    v_perm_b32 v45, v250, v242, s1
    v_perm_b32 v46, v251, v243, s0
    v_perm_b32 v47, v251, v243, s1
    v_accvgpr_write_b32 a71, v40
    v_accvgpr_write_b32 a79, v41
    v_accvgpr_write_b32 a23, v42
    v_accvgpr_write_b32 a31, v43
    v_accvgpr_write_b32 a101, v44
    v_accvgpr_write_b32 a109, v45
    v_accvgpr_write_b32 a53, v46
    v_accvgpr_write_b32 a61, v47
    s_waitcnt vmcnt(12)
    v_and_b32 v15, 0xffff0000, v14
    v_lshlrev_b32 v14, 16, v14
    v_and_b32 v115, 0xffff0000, v114
    v_lshlrev_b32 v114, 16, v114
    v_mul_u32_u24 v34, 3584, v34
    v_and_b32 v33, 0x70, v1
    v_add_u32 v34, v33, v34
    s_mul_i32 s97, s3, 458752
    s_lshl_b32 s74, s2, 7
    s_add_u32 s97, s97, s74
    s_cmp_ge_u32 s2, 28
    s_cselect_b32 s97, 0x40000000, s97
    s_mov_b32 s91, 0
    s_branch L_qstage
L_csq:
    v_mov_b32 v116, v98
    v_mov_b32 v117, v99
    v_mov_b64 v[96:97], 0
    v_mov_b64 v[100:101], 0
    v_mov_b64 v[104:105], 0
    v_mov_b64 v[108:109], 0
    v_mov_b64 v[80:81], 0
    v_mov_b64 v[84:85], 0
    v_mov_b64 v[88:89], 0
    v_mov_b64 v[92:93], 0
    v_mov_b32 v28, v14
    v_mov_b32 v29, v15
    s_mov_b64 vcc, 0
    s_getreg_b32 s101, hwreg(HW_REG_XCC_ID, 0, 4)
    s_or_b32 s73, s101, 0x80000000
    v_mov_b32 v127, s73
    s_and_b32 s73, s2, 7
    s_lshr_b32 s74, s2, 3
    s_lshl2_add_u32 s73, s73, s74
    s_lshl_b32 s73, s73, 2
    s_waitcnt vmcnt(8)
    s_add_u32 s74, s98, 0x1000
    buffer_load_dwordx4 v[196:199], v35, s[48:51], s74 offen nt
    s_add_u32 s74, s98, 0x1400
    buffer_load_dwordx4 v[204:207], v35, s[48:51], s74 offen nt
    s_add_u32 s74, s98, 0x5000
    buffer_load_dwordx4 v[212:215], v35, s[48:51], s74 offen nt
    s_add_u32 s74, s98, 0x5400
    buffer_load_dwordx4 v[220:223], v35, s[48:51], s74 offen nt
    s_add_u32 s74, s98, 0x11000
    buffer_load_dwordx4 v[228:231], v35, s[48:51], s74 offen nt
    s_add_u32 s74, s98, 0x11400
    buffer_load_dwordx4 v[236:239], v35, s[48:51], s74 offen nt
    s_add_u32 s74, s98, 0x15000
    buffer_load_dwordx4 v[244:247], v35, s[48:51], s74 offen nt
    s_add_u32 s74, s98, 0x15400
    buffer_load_dwordx4 v[252:255], v35, s[48:51], s74 offen nt
    s_mov_b32 s87, 0
    s_mov_b32 s91, 1
    s_lshl3_add_u32 s88, s87, s89
    s_barrier
    s_cmp_lg_u32 s3, 0
    s_cbranch_scc1 L_qstage
    s_mov_b64 exec, 1
    buffer_store_dword v127, off, s[40:43], s73 sc1
    s_mov_b64 exec, -1
    s_branch L_qstage
L_i1:
    v_mov_b64 v[96:97], 0
    v_mov_b64 v[100:101], 0
    v_mov_b64 v[104:105], 0
    v_mov_b64 v[108:109], 0
    v_mov_b64 v[80:81], 0
    v_mov_b64 v[84:85], 0
    v_mov_b64 v[88:89], 0
    v_mov_b64 v[92:93], 0
    v_mov_b32 v28, v114
    v_mov_b32 v29, v115
    s_mov_b64 vcc, 0
    s_waitcnt vmcnt(30)
    s_add_u32 s74, s98, 0x2000
    buffer_load_dwordx4 v[128:131], v35, s[48:51], s74 offen nt
    s_add_u32 s74, s98, 0x2400
    buffer_load_dwordx4 v[136:139], v35, s[48:51], s74 offen nt
    s_add_u32 s74, s98, 0x6000
    buffer_load_dwordx4 v[144:147], v35, s[48:51], s74 offen nt
    s_add_u32 s74, s98, 0x6400
    buffer_load_dwordx4 v[152:155], v35, s[48:51], s74 offen nt
    s_add_u32 s74, s98, 0x12000
    buffer_load_dwordx4 v[160:163], v35, s[48:51], s74 offen nt
    s_add_u32 s74, s98, 0x12400
    buffer_load_dwordx4 v[168:171], v35, s[48:51], s74 offen nt
    s_add_u32 s74, s98, 0x16000
    buffer_load_dwordx4 v[176:179], v35, s[48:51], s74 offen nt
    s_add_u32 s74, s98, 0x16400
    buffer_load_dwordx4 v[184:187], v35, s[48:51], s74 offen nt
    s_mov_b32 s87, 32
    s_add_u32 s92, s92, 1024
    s_mov_b32 s91, 2
    s_lshl3_add_u32 s88, s87, s89
    s_barrier
    s_branch L_qstage
L_i2:
    s_add_u32 s74, s98, 0x3000
    buffer_load_dwordx4 v[192:195], v35, s[48:51], s74 offen nt
    s_add_u32 s74, s98, 0x3400
    buffer_load_dwordx4 v[200:203], v35, s[48:51], s74 offen nt
    s_add_u32 s74, s98, 0x7000
    buffer_load_dwordx4 v[208:211], v35, s[48:51], s74 offen nt
    s_add_u32 s74, s98, 0x7400
    buffer_load_dwordx4 v[216:219], v35, s[48:51], s74 offen nt
    s_add_u32 s74, s98, 0x13000
    buffer_load_dwordx4 v[224:227], v35, s[48:51], s74 offen nt
    s_add_u32 s74, s98, 0x13400
    buffer_load_dwordx4 v[232:235], v35, s[48:51], s74 offen nt
    s_add_u32 s74, s98, 0x17000
    buffer_load_dwordx4 v[240:243], v35, s[48:51], s74 offen nt
    s_add_u32 s74, s98, 0x17400
    buffer_load_dwordx4 v[248:251], v35, s[48:51], s74 offen nt
    v_bfe_u32 v32, v0, 4, 1
    v_lshlrev_b32 v35, 14, v32
    v_lshrrev_b32 v32, 5, v0
    v_lshl_or_b32 v35, v32, 12, v35
    v_and_b32 v32, 0xf0, v1
    v_or_b32 v35, v35, v32
    s_lshl_b32 s73, s2, 16
    s_lshl_b32 s74, s3, 8
    s_add_u32 s73, s73, s74
    s_lshl_b32 s95, s3, 14
    s_add_u32 s74, s73, 0x0
    s_add_u32 m0, s95, 0x10000
    s_nop 0
    buffer_load_dwordx4 v35, s[60:63], s74 offen nt lds
    s_add_u32 s74, s73, 0x800
    s_add_u32 m0, s95, 0x10400
    s_nop 0
    buffer_load_dwordx4 v35, s[60:63], s74 offen nt lds
    s_add_u32 s74, s73, 0x8000
    s_add_u32 m0, s95, 0x10800
    s_nop 0
    buffer_load_dwordx4 v35, s[60:63], s74 offen nt lds
    s_add_u32 s74, s73, 0x8800
    s_add_u32 m0, s95, 0x10c00
    s_nop 0
    buffer_load_dwordx4 v35, s[60:63], s74 offen nt lds
    s_add_u32 s74, s73, 0x400
    s_add_u32 m0, s95, 0x11000
    s_nop 0
    buffer_load_dwordx4 v35, s[60:63], s74 offen nt lds
    s_add_u32 s74, s73, 0xc00
    s_add_u32 m0, s95, 0x11400
    s_nop 0
    buffer_load_dwordx4 v35, s[60:63], s74 offen nt lds
    s_add_u32 s74, s73, 0x8400
    s_add_u32 m0, s95, 0x11800
    s_nop 0
    buffer_load_dwordx4 v35, s[60:63], s74 offen nt lds
    s_add_u32 s74, s73, 0x8c00
    s_add_u32 m0, s95, 0x11c00
    s_nop 0
    buffer_load_dwordx4 v35, s[60:63], s74 offen nt lds
    s_add_u32 s74, s73, 0x2000
    s_add_u32 m0, s95, 0x12000
    s_nop 0
    buffer_load_dwordx4 v35, s[60:63], s74 offen nt lds
    s_add_u32 s74, s73, 0x2800
    s_add_u32 m0, s95, 0x12400
    s_nop 0
    buffer_load_dwordx4 v35, s[60:63], s74 offen nt lds
    s_add_u32 s74, s73, 0xa000
    s_add_u32 m0, s95, 0x12800
    s_nop 0
    buffer_load_dwordx4 v35, s[60:63], s74 offen nt lds
    s_add_u32 s74, s73, 0xa800
    s_add_u32 m0, s95, 0x12c00
    s_nop 0
    buffer_load_dwordx4 v35, s[60:63], s74 offen nt lds
    s_add_u32 s74, s73, 0x2400
    s_add_u32 m0, s95, 0x13000
    s_nop 0
    buffer_load_dwordx4 v35, s[60:63], s74 offen nt lds
    s_add_u32 s74, s73, 0x2c00
    s_add_u32 m0, s95, 0x13400
    s_nop 0
    buffer_load_dwordx4 v35, s[60:63], s74 offen nt lds
    s_add_u32 s74, s73, 0xa400
    s_add_u32 m0, s95, 0x13800
    s_nop 0
    buffer_load_dwordx4 v35, s[60:63], s74 offen nt lds
    s_add_u32 s74, s73, 0xac00
    s_add_u32 m0, s95, 0x13c00
    s_nop 0
    buffer_load_dwordx4 v35, s[60:63], s74 offen nt lds
    s_and_b32 s8, s2, 7
    s_lshl_b32 s8, s8, 4
    buffer_load_dwordx4 v[40:43], off, s[40:43], s8 sc1
    s_waitcnt vmcnt(47)
    v_perm_b32 v48, v140, v132, s0
    v_perm_b32 v49, v140, v132, s1
    v_perm_b32 v50, v141, v133, s0
    v_perm_b32 v51, v141, v133, s1
    v_perm_b32 v52, v142, v134, s0
    v_perm_b32 v53, v142, v134, s1
    v_perm_b32 v54, v143, v135, s0
    v_perm_b32 v55, v143, v135, s1
    v_accvgpr_write_b32 a128, v48
    v_accvgpr_write_b32 a136, v49
    v_accvgpr_write_b32 a208, v50
    v_accvgpr_write_b32 a216, v51
    v_accvgpr_write_b32 a226, v52
    v_accvgpr_write_b32 a234, v53
    v_accvgpr_write_b32 a178, v54
    v_accvgpr_write_b32 a186, v55
    s_not_b64 s[80:81], s[76:77]
    s_add_u32 s74, s97, 0x0
    s_mov_b64 exec, s[76:77]
    buffer_load_dwordx4 v[132:135], v34, s[52:55], s74 offen nt
    s_mov_b64 exec, s[80:81]
    buffer_load_dwordx4 v[132:135], v34, s[56:59], s74 offen nt
    s_add_u32 s74, s97, 0xe00
    s_mov_b64 exec, s[76:77]
    buffer_load_dwordx4 v[140:143], v34, s[52:55], s74 offen nt
    s_mov_b64 exec, s[80:81]
    buffer_load_dwordx4 v[140:143], v34, s[56:59], s74 offen nt
    s_mov_b64 exec, -1
    s_waitcnt vmcnt(49)
    v_perm_b32 v48, v156, v148, s0
    v_perm_b32 v49, v156, v148, s1
    v_perm_b32 v50, v157, v149, s0
    v_perm_b32 v51, v157, v149, s1
    v_perm_b32 v52, v158, v150, s0
    v_perm_b32 v53, v158, v150, s1
    v_perm_b32 v54, v159, v151, s0
    v_perm_b32 v55, v159, v151, s1
    v_accvgpr_write_b32 a129, v48
    v_accvgpr_write_b32 a137, v49
    v_accvgpr_write_b32 a209, v50
    v_accvgpr_write_b32 a217, v51
    v_accvgpr_write_b32 a227, v52
    v_accvgpr_write_b32 a235, v53
    v_accvgpr_write_b32 a179, v54
    v_accvgpr_write_b32 a187, v55
    s_not_b64 s[80:81], s[76:77]
    s_add_u32 s74, s97, 0xe000
    s_mov_b64 exec, s[76:77]
    buffer_load_dwordx4 v[148:151], v34, s[52:55], s74 offen nt
    s_mov_b64 exec, s[80:81]
    buffer_load_dwordx4 v[148:151], v34, s[56:59], s74 offen nt
    s_add_u32 s74, s97, 0xee00
    s_mov_b64 exec, s[76:77]
    buffer_load_dwordx4 v[156:159], v34, s[52:55], s74 offen nt
    s_mov_b64 exec, s[80:81]
    buffer_load_dwordx4 v[156:159], v34, s[56:59], s74 offen nt
    s_mov_b64 exec, -1
    s_waitcnt vmcnt(51)
    v_perm_b32 v48, v172, v164, s0
    v_perm_b32 v49, v172, v164, s1
    v_perm_b32 v50, v173, v165, s0
    v_perm_b32 v51, v173, v165, s1
    v_perm_b32 v52, v174, v166, s0
    v_perm_b32 v53, v174, v166, s1
    v_perm_b32 v54, v175, v167, s0
    v_perm_b32 v55, v175, v167, s1
    v_accvgpr_write_b32 a130, v48
    v_accvgpr_write_b32 a138, v49
    v_accvgpr_write_b32 a210, v50
    v_accvgpr_write_b32 a218, v51
    v_accvgpr_write_b32 a160, v52
    v_accvgpr_write_b32 a168, v53
    v_accvgpr_write_b32 a240, v54
    v_accvgpr_write_b32 a248, v55
    s_not_b64 s[80:81], s[76:77]
    s_add_u32 s74, s97, 0x38000
    s_mov_b64 exec, s[76:77]
    buffer_load_dwordx4 v[164:167], v34, s[52:55], s74 offen nt
    s_mov_b64 exec, s[80:81]
    buffer_load_dwordx4 v[164:167], v34, s[56:59], s74 offen nt
    s_add_u32 s74, s97, 0x38e00
    s_mov_b64 exec, s[76:77]
    buffer_load_dwordx4 v[172:175], v34, s[52:55], s74 offen nt
    s_mov_b64 exec, s[80:81]
    buffer_load_dwordx4 v[172:175], v34, s[56:59], s74 offen nt
    s_mov_b64 exec, -1
    s_waitcnt vmcnt(53)
    v_perm_b32 v48, v188, v180, s0
    v_perm_b32 v49, v188, v180, s1
    v_perm_b32 v50, v189, v181, s0
    v_perm_b32 v51, v189, v181, s1
    v_perm_b32 v52, v190, v182, s0
    v_perm_b32 v53, v190, v182, s1
    v_perm_b32 v54, v191, v183, s0
    v_perm_b32 v55, v191, v183, s1
    v_accvgpr_write_b32 a131, v48
    v_accvgpr_write_b32 a139, v49
    v_accvgpr_write_b32 a211, v50
    v_accvgpr_write_b32 a219, v51
    v_accvgpr_write_b32 a161, v52
    v_accvgpr_write_b32 a169, v53
    v_accvgpr_write_b32 a241, v54
    v_accvgpr_write_b32 a249, v55
    s_not_b64 s[80:81], s[76:77]
    s_add_u32 s74, s97, 0x46000
    s_mov_b64 exec, s[76:77]
    buffer_load_dwordx4 v[180:183], v34, s[52:55], s74 offen nt
    s_mov_b64 exec, s[80:81]
    buffer_load_dwordx4 v[180:183], v34, s[56:59], s74 offen nt
    s_add_u32 s74, s97, 0x46e00
    s_mov_b64 exec, s[76:77]
    buffer_load_dwordx4 v[188:191], v34, s[52:55], s74 offen nt
    s_mov_b64 exec, s[80:81]
    buffer_load_dwordx4 v[188:191], v34, s[56:59], s74 offen nt
    s_mov_b64 exec, -1
    s_waitcnt vmcnt(55)
    v_perm_b32 v48, v204, v196, s0
    v_perm_b32 v49, v204, v196, s1
    v_perm_b32 v50, v205, v197, s0
    v_perm_b32 v51, v205, v197, s1
    v_perm_b32 v52, v206, v198, s0
    v_perm_b32 v53, v206, v198, s1
    v_perm_b32 v54, v207, v199, s0
    v_perm_b32 v55, v207, v199, s1
    v_accvgpr_write_b32 a192, v48
    v_accvgpr_write_b32 a200, v49
    v_accvgpr_write_b32 a144, v50
    v_accvgpr_write_b32 a152, v51
    v_accvgpr_write_b32 a162, v52
    v_accvgpr_write_b32 a170, v53
    v_accvgpr_write_b32 a242, v54
    v_accvgpr_write_b32 a250, v55
    s_not_b64 s[80:81], s[76:77]
    s_add_u32 s74, s97, 0x3800
    s_mov_b64 exec, s[76:77]
    buffer_load_dwordx4 v[196:199], v34, s[52:55], s74 offen nt
    s_mov_b64 exec, s[80:81]
    buffer_load_dwordx4 v[196:199], v34, s[56:59], s74 offen nt
    s_add_u32 s74, s97, 0x4600
    s_mov_b64 exec, s[76:77]
    buffer_load_dwordx4 v[204:207], v34, s[52:55], s74 offen nt
    s_mov_b64 exec, s[80:81]
    buffer_load_dwordx4 v[204:207], v34, s[56:59], s74 offen nt
    s_mov_b64 exec, -1
    s_waitcnt vmcnt(57)
    v_perm_b32 v48, v220, v212, s0
    v_perm_b32 v49, v220, v212, s1
    v_perm_b32 v50, v221, v213, s0
    v_perm_b32 v51, v221, v213, s1
    v_perm_b32 v52, v222, v214, s0
    v_perm_b32 v53, v222, v214, s1
    v_perm_b32 v54, v223, v215, s0
    v_perm_b32 v55, v223, v215, s1
    v_accvgpr_write_b32 a193, v48
    v_accvgpr_write_b32 a201, v49
    v_accvgpr_write_b32 a145, v50
    v_accvgpr_write_b32 a153, v51
    v_accvgpr_write_b32 a163, v52
    v_accvgpr_write_b32 a171, v53
    v_accvgpr_write_b32 a243, v54
    v_accvgpr_write_b32 a251, v55
    s_not_b64 s[80:81], s[76:77]
    s_add_u32 s74, s97, 0x11800
    s_mov_b64 exec, s[76:77]
    buffer_load_dwordx4 v[212:215], v34, s[52:55], s74 offen nt
    s_mov_b64 exec, s[80:81]
    buffer_load_dwordx4 v[212:215], v34, s[56:59], s74 offen nt
    s_add_u32 s74, s97, 0x12600
    s_mov_b64 exec, s[76:77]
    buffer_load_dwordx4 v[220:223], v34, s[52:55], s74 offen nt
    s_mov_b64 exec, s[80:81]
    s_waitcnt vmcnt(59)
    buffer_load_dwordx4 v[220:223], v34, s[56:59], s74 offen nt
    s_mov_b64 exec, -1
    s_waitcnt vmcnt(59)
    v_perm_b32 v48, v236, v228, s0
    v_perm_b32 v49, v236, v228, s1
    v_perm_b32 v50, v237, v229, s0
    v_perm_b32 v51, v237, v229, s1
    v_perm_b32 v52, v238, v230, s0
    v_perm_b32 v53, v238, v230, s1
    v_perm_b32 v54, v239, v231, s0
    v_perm_b32 v55, v239, v231, s1
    v_accvgpr_write_b32 a194, v48
    v_accvgpr_write_b32 a202, v49
    v_accvgpr_write_b32 a146, v50
    v_accvgpr_write_b32 a154, v51
    v_accvgpr_write_b32 a224, v52
    v_accvgpr_write_b32 a232, v53
    v_accvgpr_write_b32 a176, v54
    v_accvgpr_write_b32 a184, v55
    s_not_b64 s[80:81], s[76:77]
    s_add_u32 s74, s97, 0x3b800
    s_mov_b64 exec, s[76:77]
    buffer_load_dwordx4 v[228:231], v34, s[52:55], s74 offen nt
    s_mov_b64 exec, s[80:81]
    s_waitcnt vmcnt(59)
    buffer_load_dwordx4 v[228:231], v34, s[56:59], s74 offen nt
    s_add_u32 s74, s97, 0x3c600
    s_mov_b64 exec, s[76:77]
    s_waitcnt vmcnt(59)
    buffer_load_dwordx4 v[236:239], v34, s[52:55], s74 offen nt
    s_mov_b64 exec, s[80:81]
    s_waitcnt vmcnt(59)
    buffer_load_dwordx4 v[236:239], v34, s[56:59], s74 offen nt
    s_mov_b64 exec, -1
    v_perm_b32 v48, v252, v244, s0
    v_perm_b32 v49, v252, v244, s1
    v_perm_b32 v50, v253, v245, s0
    v_perm_b32 v51, v253, v245, s1
    v_perm_b32 v52, v254, v246, s0
    v_perm_b32 v53, v254, v246, s1
    v_perm_b32 v54, v255, v247, s0
    v_perm_b32 v55, v255, v247, s1
    v_accvgpr_write_b32 a195, v48
    v_accvgpr_write_b32 a203, v49
    v_accvgpr_write_b32 a147, v50
    v_accvgpr_write_b32 a155, v51
    v_accvgpr_write_b32 a225, v52
    v_accvgpr_write_b32 a233, v53
    v_accvgpr_write_b32 a177, v54
    v_accvgpr_write_b32 a185, v55
    s_not_b64 s[80:81], s[76:77]
    s_add_u32 s74, s97, 0x49800
    s_mov_b64 exec, s[76:77]
    s_waitcnt vmcnt(59)
    buffer_load_dwordx4 v[244:247], v34, s[52:55], s74 offen nt
    s_mov_b64 exec, s[80:81]
    s_waitcnt vmcnt(59)
    buffer_load_dwordx4 v[244:247], v34, s[56:59], s74 offen nt
    s_add_u32 s74, s97, 0x4a600
    s_mov_b64 exec, s[76:77]
    s_waitcnt vmcnt(59)
    buffer_load_dwordx4 v[252:255], v34, s[52:55], s74 offen nt
    s_mov_b64 exec, s[80:81]
    s_waitcnt vmcnt(59)
    buffer_load_dwordx4 v[252:255], v34, s[56:59], s74 offen nt
    s_mov_b64 exec, -1
    v_perm_b32 v48, v136, v128, s0
    v_perm_b32 v49, v136, v128, s1
    v_perm_b32 v50, v137, v129, s0
    v_perm_b32 v51, v137, v129, s1
    v_perm_b32 v52, v138, v130, s0
    v_perm_b32 v53, v138, v130, s1
    v_perm_b32 v54, v139, v131, s0
    v_perm_b32 v55, v139, v131, s1
    v_accvgpr_write_b32 a132, v48
    v_accvgpr_write_b32 a140, v49
    v_accvgpr_write_b32 a212, v50
    v_accvgpr_write_b32 a220, v51
    v_accvgpr_write_b32 a230, v52
    v_accvgpr_write_b32 a238, v53
    v_accvgpr_write_b32 a182, v54
    v_accvgpr_write_b32 a190, v55
    s_not_b64 s[80:81], s[76:77]
    s_add_u32 s74, s97, 0x7000
    s_mov_b64 exec, s[76:77]
    s_waitcnt vmcnt(59)
    buffer_load_dwordx4 v[64:67], v34, s[52:55], s74 offen nt
    s_mov_b64 exec, s[80:81]
    s_waitcnt vmcnt(59)
    buffer_load_dwordx4 v[64:67], v34, s[56:59], s74 offen nt
    s_add_u32 s74, s97, 0x7e00
    s_mov_b64 exec, s[76:77]
    s_waitcnt vmcnt(59)
    buffer_load_dwordx4 v[68:71], v34, s[52:55], s74 offen nt
    s_mov_b64 exec, s[80:81]
    s_waitcnt vmcnt(59)
    buffer_load_dwordx4 v[68:71], v34, s[56:59], s74 offen nt
    s_mov_b64 exec, -1
    v_perm_b32 v48, v152, v144, s0
    v_perm_b32 v49, v152, v144, s1
    v_perm_b32 v50, v153, v145, s0
    v_perm_b32 v51, v153, v145, s1
    v_perm_b32 v52, v154, v146, s0
    v_perm_b32 v53, v154, v146, s1
    v_perm_b32 v54, v155, v147, s0
    v_perm_b32 v55, v155, v147, s1
    v_accvgpr_write_b32 a133, v48
    v_accvgpr_write_b32 a141, v49
    v_accvgpr_write_b32 a213, v50
    v_accvgpr_write_b32 a221, v51
    v_accvgpr_write_b32 a231, v52
    v_accvgpr_write_b32 a239, v53
    v_accvgpr_write_b32 a183, v54
    v_accvgpr_write_b32 a191, v55
    s_not_b64 s[80:81], s[76:77]
    s_add_u32 s74, s97, 0x15000
    s_mov_b64 exec, s[76:77]
    s_waitcnt vmcnt(59)
    buffer_load_dwordx4 v[72:75], v34, s[52:55], s74 offen nt
    s_mov_b64 exec, s[80:81]
    s_waitcnt vmcnt(59)
    buffer_load_dwordx4 v[72:75], v34, s[56:59], s74 offen nt
    s_add_u32 s74, s97, 0x15e00
    s_mov_b64 exec, s[76:77]
    s_waitcnt vmcnt(59)
    buffer_load_dwordx4 v[76:79], v34, s[52:55], s74 offen nt
    s_mov_b64 exec, s[80:81]
    s_waitcnt vmcnt(59)
    buffer_load_dwordx4 v[76:79], v34, s[56:59], s74 offen nt
    s_mov_b64 exec, -1
    v_perm_b32 v48, v168, v160, s0
    v_perm_b32 v49, v168, v160, s1
    v_perm_b32 v50, v169, v161, s0
    v_perm_b32 v51, v169, v161, s1
    v_perm_b32 v52, v170, v162, s0
    v_perm_b32 v53, v170, v162, s1
    v_perm_b32 v54, v171, v163, s0
    v_perm_b32 v55, v171, v163, s1
    v_accvgpr_write_b32 a134, v48
    v_accvgpr_write_b32 a142, v49
    v_accvgpr_write_b32 a214, v50
    v_accvgpr_write_b32 a222, v51
    v_accvgpr_write_b32 a164, v52
    v_accvgpr_write_b32 a172, v53
    v_accvgpr_write_b32 a244, v54
    v_accvgpr_write_b32 a252, v55
    s_not_b64 s[80:81], s[76:77]
    s_add_u32 s74, s97, 0x3f000
    s_mov_b64 exec, s[76:77]
    s_waitcnt vmcnt(59)
    buffer_load_dwordx4 v[80:83], v34, s[52:55], s74 offen nt
    s_mov_b64 exec, s[80:81]
    s_waitcnt vmcnt(59)
    buffer_load_dwordx4 v[80:83], v34, s[56:59], s74 offen nt
    s_add_u32 s74, s97, 0x3fe00
    s_mov_b64 exec, s[76:77]
    s_waitcnt vmcnt(59)
    buffer_load_dwordx4 v[84:87], v34, s[52:55], s74 offen nt
    s_mov_b64 exec, s[80:81]
    s_waitcnt vmcnt(59)
    buffer_load_dwordx4 v[84:87], v34, s[56:59], s74 offen nt
    s_mov_b64 exec, -1
    v_perm_b32 v48, v184, v176, s0
    v_perm_b32 v49, v184, v176, s1
    v_perm_b32 v50, v185, v177, s0
    v_perm_b32 v51, v185, v177, s1
    v_perm_b32 v52, v186, v178, s0
    v_perm_b32 v53, v186, v178, s1
    v_perm_b32 v54, v187, v179, s0
    v_perm_b32 v55, v187, v179, s1
    v_accvgpr_write_b32 a135, v48
    v_accvgpr_write_b32 a143, v49
    v_accvgpr_write_b32 a215, v50
    v_accvgpr_write_b32 a223, v51
    v_accvgpr_write_b32 a165, v52
    v_accvgpr_write_b32 a173, v53
    v_accvgpr_write_b32 a245, v54
    v_accvgpr_write_b32 a253, v55
    s_not_b64 s[80:81], s[76:77]
    s_add_u32 s74, s97, 0x4d000
    s_mov_b64 exec, s[76:77]
    s_waitcnt vmcnt(59)
    buffer_load_dwordx4 v[88:91], v34, s[52:55], s74 offen nt
    s_mov_b64 exec, s[80:81]
    s_waitcnt vmcnt(59)
    buffer_load_dwordx4 v[88:91], v34, s[56:59], s74 offen nt
    s_add_u32 s74, s97, 0x4de00
    s_mov_b64 exec, s[76:77]
    s_waitcnt vmcnt(59)
    buffer_load_dwordx4 v[92:95], v34, s[52:55], s74 offen nt
    s_mov_b64 exec, s[80:81]
    s_waitcnt vmcnt(59)
    buffer_load_dwordx4 v[92:95], v34, s[56:59], s74 offen nt
    s_mov_b64 exec, -1
    v_perm_b32 v48, v200, v192, s0
    v_perm_b32 v49, v200, v192, s1
    v_perm_b32 v50, v201, v193, s0
    v_perm_b32 v51, v201, v193, s1
    v_perm_b32 v52, v202, v194, s0
    v_perm_b32 v53, v202, v194, s1
    v_perm_b32 v54, v203, v195, s0
    v_perm_b32 v55, v203, v195, s1
    v_accvgpr_write_b32 a196, v48
    v_accvgpr_write_b32 a204, v49
    v_accvgpr_write_b32 a148, v50
    v_accvgpr_write_b32 a156, v51
    v_accvgpr_write_b32 a166, v52
    v_accvgpr_write_b32 a174, v53
    v_accvgpr_write_b32 a246, v54
    v_accvgpr_write_b32 a254, v55
    s_not_b64 s[80:81], s[76:77]
    s_add_u32 s74, s97, 0xa800
    s_mov_b64 exec, s[76:77]
    s_waitcnt vmcnt(59)
    buffer_load_dwordx4 v[96:99], v34, s[52:55], s74 offen nt
    s_mov_b64 exec, s[80:81]
    s_waitcnt vmcnt(59)
    buffer_load_dwordx4 v[96:99], v34, s[56:59], s74 offen nt
    s_add_u32 s74, s97, 0xb600
    s_mov_b64 exec, s[76:77]
    s_waitcnt vmcnt(59)
    buffer_load_dwordx4 v[100:103], v34, s[52:55], s74 offen nt
    s_mov_b64 exec, s[80:81]
    s_waitcnt vmcnt(59)
    buffer_load_dwordx4 v[100:103], v34, s[56:59], s74 offen nt
    s_mov_b64 exec, -1
    v_perm_b32 v48, v216, v208, s0
    v_perm_b32 v49, v216, v208, s1
    v_perm_b32 v50, v217, v209, s0
    v_perm_b32 v51, v217, v209, s1
    v_perm_b32 v52, v218, v210, s0
    v_perm_b32 v53, v218, v210, s1
    v_perm_b32 v54, v219, v211, s0
    v_perm_b32 v55, v219, v211, s1
    v_accvgpr_write_b32 a197, v48
    v_accvgpr_write_b32 a205, v49
    v_accvgpr_write_b32 a149, v50
    v_accvgpr_write_b32 a157, v51
    v_accvgpr_write_b32 a167, v52
    v_accvgpr_write_b32 a175, v53
    v_accvgpr_write_b32 a247, v54
    v_accvgpr_write_b32 a255, v55
    s_not_b64 s[80:81], s[76:77]
    s_add_u32 s74, s97, 0x18800
    s_mov_b64 exec, s[76:77]
    s_waitcnt vmcnt(59)
    buffer_load_dwordx4 v[104:107], v34, s[52:55], s74 offen nt
    s_mov_b64 exec, s[80:81]
    s_waitcnt vmcnt(59)
    buffer_load_dwordx4 v[104:107], v34, s[56:59], s74 offen nt
    s_add_u32 s74, s97, 0x19600
    s_mov_b64 exec, s[76:77]
    s_waitcnt vmcnt(59)
    buffer_load_dwordx4 v[108:111], v34, s[52:55], s74 offen nt
    s_mov_b64 exec, s[80:81]
    s_waitcnt vmcnt(59)
    buffer_load_dwordx4 v[108:111], v34, s[56:59], s74 offen nt
    s_mov_b64 exec, -1
    v_perm_b32 v48, v232, v224, s0
    v_perm_b32 v49, v232, v224, s1
    v_perm_b32 v50, v233, v225, s0
    v_perm_b32 v51, v233, v225, s1
    v_perm_b32 v52, v234, v226, s0
    v_perm_b32 v53, v234, v226, s1
    v_perm_b32 v54, v235, v227, s0
    v_perm_b32 v55, v235, v227, s1
    v_accvgpr_write_b32 a198, v48
    v_accvgpr_write_b32 a206, v49
    v_accvgpr_write_b32 a150, v50
    v_accvgpr_write_b32 a158, v51
    v_accvgpr_write_b32 a228, v52
    v_accvgpr_write_b32 a236, v53
    v_accvgpr_write_b32 a180, v54
    v_accvgpr_write_b32 a188, v55
    s_not_b64 s[80:81], s[76:77]
    s_add_u32 s74, s97, 0x42800
    s_mov_b64 exec, s[76:77]
    s_waitcnt vmcnt(59)
    buffer_load_dwordx4 v[120:123], v34, s[52:55], s74 offen nt
    s_mov_b64 exec, s[80:81]
    s_waitcnt vmcnt(59)
    buffer_load_dwordx4 v[120:123], v34, s[56:59], s74 offen nt
    s_add_u32 s74, s97, 0x43600
    s_mov_b64 exec, s[76:77]
    s_waitcnt vmcnt(59)
    buffer_load_dwordx4 v[124:127], v34, s[52:55], s74 offen nt
    s_mov_b64 exec, s[80:81]
    s_waitcnt vmcnt(59)
    buffer_load_dwordx4 v[124:127], v34, s[56:59], s74 offen nt
    s_mov_b64 exec, -1
    v_perm_b32 v48, v248, v240, s0
    v_perm_b32 v49, v248, v240, s1
    v_perm_b32 v50, v249, v241, s0
    v_perm_b32 v51, v249, v241, s1
    v_perm_b32 v52, v250, v242, s0
    v_perm_b32 v53, v250, v242, s1
    v_perm_b32 v54, v251, v243, s0
    v_perm_b32 v55, v251, v243, s1
    v_accvgpr_write_b32 a199, v48
    v_accvgpr_write_b32 a207, v49
    v_accvgpr_write_b32 a151, v50
    v_accvgpr_write_b32 a159, v51
    v_accvgpr_write_b32 a229, v52
    v_accvgpr_write_b32 a237, v53
    v_accvgpr_write_b32 a181, v54
    v_accvgpr_write_b32 a189, v55
    s_not_b64 s[80:81], s[76:77]
    s_add_u32 s74, s97, 0x50800
    s_mov_b64 exec, s[76:77]
    s_waitcnt vmcnt(59)
    buffer_load_dwordx4 v[16:19], v34, s[52:55], s74 offen nt
    s_mov_b64 exec, s[80:81]
    s_waitcnt vmcnt(59)
    buffer_load_dwordx4 v[16:19], v34, s[56:59], s74 offen nt
    s_add_u32 s74, s97, 0x51600
    s_mov_b64 exec, s[76:77]
    s_waitcnt vmcnt(59)
    buffer_load_dwordx4 v[20:23], v34, s[52:55], s74 offen nt
    s_mov_b64 exec, s[80:81]
    s_waitcnt vmcnt(59)
    buffer_load_dwordx4 v[20:23], v34, s[56:59], s74 offen nt
    s_mov_b64 exec, -1
    s_mov_b64 exec, 0
    s_cmp_eq_u32 s3, 1
    s_cbranch_scc1 L_ws1
    s_cmp_eq_u32 s3, 2
    s_cbranch_scc1 L_ws2
    s_cmp_eq_u32 s3, 3
    s_cbranch_scc1 L_ws3
    s_branch L_ws0
L_wr5:
    s_mov_b64 exec, -1
L_f4:
    v_min3_u32 v28, v40, v41, v42
    v_min_u32 v28, v28, v43
    v_cmp_eq_u32 vcc, 0, v28
    s_nop 4
    s_cbranch_vccz L_f4ok
    buffer_load_dwordx4 v[40:43], off, s[40:43], s8 sc1
    s_waitcnt vmcnt(0)
    s_sub_u32 s72, s72, 1
    s_cbranch_scc0 L_f4
    s_endpgm
L_f4ok:
    v_max3_u32 v29, v40, v41, v42
    v_max_u32 v29, v29, v43
    v_xor_b32 v28, v28, v29
    s_nop 0
    v_readfirstlane_b32 s8, v28
    s_sub_u32 s92, s92, 1024
    s_mov_b32 s87, 0
    s_mov_b32 s91, 4
    ds_read_b128 v[32:35], v11 offset:0
    ds_read_b128 v[36:39], v11 offset:2048
    ds_read_b128 v[40:43], v11 offset:4096
    ds_read_b128 v[44:47], v11 offset:6144
    ds_read_b128 v[48:51], v11 offset:8192
    ds_read_b128 v[52:55], v11 offset:10240
    ds_read_b128 v[56:59], v11 offset:12288
    ds_read_b128 v[60:63], v11 offset:14336
    s_waitcnt lgkmcnt(0)
    v_perm_b32 v28, v36, v32, s0
    v_perm_b32 v29, v44, v40, s0
    v_perm_b32 v30, v52, v48, s0
    v_perm_b32 v31, v60, v56, s0
    ds_write_b128 v11, v[28:31] offset:0
    s_nop 1
    v_perm_b32 v28, v36, v32, s1
    v_perm_b32 v29, v44, v40, s1
    v_perm_b32 v30, v52, v48, s1
    v_perm_b32 v31, v60, v56, s1
    ds_write_b128 v11, v[28:31] offset:2048
    s_nop 1
    v_perm_b32 v28, v37, v33, s0
    v_perm_b32 v29, v45, v41, s0
    v_perm_b32 v30, v53, v49, s0
    v_perm_b32 v31, v61, v57, s0
    ds_write_b128 v11, v[28:31] offset:4096
L_ws0:
    s_cbranch_execz L_ws4
    s_nop 0
    v_perm_b32 v28, v37, v33, s1
    v_perm_b32 v29, v45, v41, s1
    v_perm_b32 v30, v53, v49, s1
    v_perm_b32 v31, v61, v57, s1
    ds_write_b128 v11, v[28:31] offset:6144
    s_nop 1
    v_perm_b32 v28, v38, v34, s0
    v_perm_b32 v29, v46, v42, s0
    v_perm_b32 v30, v54, v50, s0
    v_perm_b32 v31, v62, v58, s0
    ds_write_b128 v11, v[28:31] offset:8192
    s_nop 1
    v_perm_b32 v28, v38, v34, s1
    v_perm_b32 v29, v46, v42, s1
    v_perm_b32 v30, v54, v50, s1
    v_perm_b32 v31, v62, v58, s1
    ds_write_b128 v11, v[28:31] offset:10240
    s_nop 1
    v_perm_b32 v28, v39, v35, s0
    v_perm_b32 v29, v47, v43, s0
    v_perm_b32 v30, v55, v51, s0
    v_perm_b32 v31, v63, v59, s0
    ds_write_b128 v11, v[28:31] offset:12288
    s_nop 1
    v_perm_b32 v28, v39, v35, s1
    v_perm_b32 v29, v47, v43, s1
    v_perm_b32 v30, v55, v51, s1
    v_perm_b32 v31, v63, v59, s1
    ds_write_b128 v11, v[28:31] offset:14336
    s_nop 1
    ds_read_b128 v[32:35], v11 offset:1024
    ds_read_b128 v[36:39], v11 offset:3072
    ds_read_b128 v[40:43], v11 offset:5120
    ds_read_b128 v[44:47], v11 offset:7168
    ds_read_b128 v[48:51], v11 offset:9216
    ds_read_b128 v[52:55], v11 offset:11264
    ds_read_b128 v[56:59], v11 offset:13312
    s_waitcnt lgkmcnt(14)
    ds_read_b128 v[60:63], v11 offset:15360
    s_waitcnt lgkmcnt(0)
    v_perm_b32 v28, v36, v32, s0
    v_perm_b32 v29, v44, v40, s0
    v_perm_b32 v30, v52, v48, s0
    v_perm_b32 v31, v60, v56, s0
    ds_write_b128 v11, v[28:31] offset:1024
    s_nop 1
    v_perm_b32 v28, v36, v32, s1
    v_perm_b32 v29, v44, v40, s1
    v_perm_b32 v30, v52, v48, s1
    v_perm_b32 v31, v60, v56, s1
    ds_write_b128 v11, v[28:31] offset:3072
    s_nop 1
    v_perm_b32 v28, v37, v33, s0
    v_perm_b32 v29, v45, v41, s0
    v_perm_b32 v30, v53, v49, s0
    v_perm_b32 v31, v61, v57, s0
    ds_write_b128 v11, v[28:31] offset:5120
    s_nop 1
    v_perm_b32 v28, v37, v33, s1
    v_perm_b32 v29, v45, v41, s1
    v_perm_b32 v30, v53, v49, s1
    v_perm_b32 v31, v61, v57, s1
    ds_write_b128 v11, v[28:31] offset:7168
    s_nop 1
    v_perm_b32 v28, v38, v34, s0
    v_perm_b32 v29, v46, v42, s0
    v_perm_b32 v30, v54, v50, s0
    v_perm_b32 v31, v62, v58, s0
    ds_write_b128 v11, v[28:31] offset:9216
    s_nop 1
    v_perm_b32 v28, v38, v34, s1
    v_perm_b32 v29, v46, v42, s1
    v_perm_b32 v30, v54, v50, s1
    v_perm_b32 v31, v62, v58, s1
    ds_write_b128 v11, v[28:31] offset:11264
    s_nop 1
    v_perm_b32 v28, v39, v35, s0
    v_perm_b32 v29, v47, v43, s0
    v_perm_b32 v30, v55, v51, s0
    v_perm_b32 v31, v63, v59, s0
    ds_write_b128 v11, v[28:31] offset:13312
    s_nop 1
    v_perm_b32 v28, v39, v35, s1
    v_perm_b32 v29, v47, v43, s1
    v_perm_b32 v30, v55, v51, s1
    v_perm_b32 v31, v63, v59, s1
    ds_write_b128 v11, v[28:31] offset:15360
    s_nop 1
    s_waitcnt lgkmcnt(0)
    v_perm_b32 v128, v140, v132, s0
    v_perm_b32 v136, v140, v132, s1
    v_perm_b32 v208, v141, v133, s0
    v_perm_b32 v216, v141, v133, s1
    v_perm_b32 v226, v142, v134, s0
    v_perm_b32 v234, v142, v134, s1
    v_perm_b32 v178, v143, v135, s0
    v_perm_b32 v186, v143, v135, s1
    s_waitcnt vmcnt(56)
    v_perm_b32 v129, v156, v148, s0
    v_perm_b32 v137, v156, v148, s1
    v_perm_b32 v209, v157, v149, s0
    v_perm_b32 v217, v157, v149, s1
    v_perm_b32 v227, v158, v150, s0
    v_perm_b32 v235, v158, v150, s1
    v_perm_b32 v179, v159, v151, s0
    v_perm_b32 v187, v159, v151, s1
    s_waitcnt vmcnt(52)
    v_perm_b32 v130, v172, v164, s0
    v_perm_b32 v138, v172, v164, s1
    v_perm_b32 v210, v173, v165, s0
    v_perm_b32 v218, v173, v165, s1
    v_perm_b32 v160, v174, v166, s0
    v_perm_b32 v168, v174, v166, s1
    v_perm_b32 v240, v175, v167, s0
    v_perm_b32 v248, v175, v167, s1
    s_waitcnt vmcnt(48)
    v_perm_b32 v131, v188, v180, s0
    v_perm_b32 v139, v188, v180, s1
    v_perm_b32 v211, v189, v181, s0
    v_perm_b32 v219, v189, v181, s1
    v_perm_b32 v161, v190, v182, s0
    v_perm_b32 v169, v190, v182, s1
    v_perm_b32 v241, v191, v183, s0
    v_perm_b32 v249, v191, v183, s1
    s_waitcnt vmcnt(44)
    v_perm_b32 v192, v204, v196, s0
    v_perm_b32 v200, v204, v196, s1
    v_perm_b32 v144, v205, v197, s0
    v_perm_b32 v152, v205, v197, s1
    v_perm_b32 v162, v206, v198, s0
    v_perm_b32 v170, v206, v198, s1
    v_perm_b32 v242, v207, v199, s0
    v_perm_b32 v250, v207, v199, s1
    s_waitcnt vmcnt(40)
    v_perm_b32 v193, v220, v212, s0
    v_perm_b32 v201, v220, v212, s1
    v_perm_b32 v145, v221, v213, s0
    v_perm_b32 v153, v221, v213, s1
    v_perm_b32 v163, v222, v214, s0
    v_perm_b32 v171, v222, v214, s1
    v_perm_b32 v243, v223, v215, s0
    v_perm_b32 v251, v223, v215, s1
    s_waitcnt vmcnt(36)
    v_perm_b32 v194, v236, v228, s0
    v_perm_b32 v202, v236, v228, s1
    v_perm_b32 v146, v237, v229, s0
    v_perm_b32 v154, v237, v229, s1
    v_perm_b32 v224, v238, v230, s0
    v_perm_b32 v232, v238, v230, s1
    v_perm_b32 v176, v239, v231, s0
    v_perm_b32 v184, v239, v231, s1
L_ws1:
    s_cbranch_execz L_ws5
    s_waitcnt vmcnt(32)
    v_perm_b32 v195, v252, v244, s0
    v_perm_b32 v203, v252, v244, s1
    v_perm_b32 v147, v253, v245, s0
    v_perm_b32 v155, v253, v245, s1
    v_perm_b32 v225, v254, v246, s0
    v_perm_b32 v233, v254, v246, s1
    v_perm_b32 v177, v255, v247, s0
    v_perm_b32 v185, v255, v247, s1
    s_nop 1
    s_branch L_own
L_i4:
    v_perm_b32 v132, v68, v64, s0
    v_perm_b32 v140, v68, v64, s1
    v_perm_b32 v212, v69, v65, s0
    v_perm_b32 v220, v69, v65, s1
    v_perm_b32 v230, v70, v66, s0
    v_perm_b32 v238, v70, v66, s1
    v_perm_b32 v182, v71, v67, s0
    v_perm_b32 v190, v71, v67, s1
    v_perm_b32 v133, v76, v72, s0
    v_perm_b32 v141, v76, v72, s1
    v_perm_b32 v213, v77, v73, s0
    v_perm_b32 v221, v77, v73, s1
    v_perm_b32 v231, v78, v74, s0
    v_perm_b32 v239, v78, v74, s1
    v_perm_b32 v183, v79, v75, s0
    v_perm_b32 v191, v79, v75, s1
    v_perm_b32 v134, v84, v80, s0
    v_perm_b32 v142, v84, v80, s1
    v_perm_b32 v214, v85, v81, s0
    v_perm_b32 v222, v85, v81, s1
    v_perm_b32 v164, v86, v82, s0
    v_perm_b32 v172, v86, v82, s1
    v_perm_b32 v244, v87, v83, s0
    v_perm_b32 v252, v87, v83, s1
    v_perm_b32 v135, v92, v88, s0
    v_perm_b32 v143, v92, v88, s1
    v_perm_b32 v215, v93, v89, s0
    v_perm_b32 v223, v93, v89, s1
    v_perm_b32 v165, v94, v90, s0
    v_perm_b32 v173, v94, v90, s1
    v_perm_b32 v245, v95, v91, s0
    v_perm_b32 v253, v95, v91, s1
    v_perm_b32 v196, v100, v96, s0
    v_perm_b32 v204, v100, v96, s1
    v_perm_b32 v148, v101, v97, s0
    v_perm_b32 v156, v101, v97, s1
    v_perm_b32 v166, v102, v98, s0
    v_perm_b32 v174, v102, v98, s1
    v_perm_b32 v246, v103, v99, s0
    v_perm_b32 v254, v103, v99, s1
    v_perm_b32 v197, v108, v104, s0
    v_perm_b32 v205, v108, v104, s1
    v_perm_b32 v149, v109, v105, s0
    v_perm_b32 v157, v109, v105, s1
    v_perm_b32 v167, v110, v106, s0
    v_perm_b32 v175, v110, v106, s1
    v_perm_b32 v247, v111, v107, s0
    v_perm_b32 v255, v111, v107, s1
    v_perm_b32 v198, v124, v120, s0
    v_perm_b32 v206, v124, v120, s1
    v_perm_b32 v150, v125, v121, s0
    v_perm_b32 v158, v125, v121, s1
    v_perm_b32 v228, v126, v122, s0
    v_perm_b32 v236, v126, v122, s1
    v_perm_b32 v180, v127, v123, s0
    v_perm_b32 v188, v127, v123, s1
    v_perm_b32 v199, v20, v16, s0
    v_perm_b32 v207, v20, v16, s1
    v_perm_b32 v151, v21, v17, s0
    v_perm_b32 v159, v21, v17, s1
    v_perm_b32 v229, v22, v18, s0
    v_perm_b32 v237, v22, v18, s1
    v_perm_b32 v181, v23, v19, s0
    v_perm_b32 v189, v23, v19, s1
    v_mov_b32 v28, 1.0
    v_mov_b32 v29, 1.0
    s_mov_b64 vcc, 0
    v_mov_b64 v[96:97], 0
    v_mov_b64 v[100:101], 0
    v_mov_b64 v[104:105], 0
    v_mov_b64 v[108:109], 0
    v_mov_b64 v[80:81], 0
    v_mov_b64 v[84:85], 0
    v_mov_b64 v[88:89], 0
    v_mov_b64 v[92:93], 0
    s_nop 1
    s_branch L_fgemv
L_csf:
    v_mov_b32 v118, v98
    v_mov_b32 v119, v99
    v_mov_b32 v112, v14
    v_mov_b32 v113, v15
    s_mov_b32 s80, 0x0f0f0f0f
    s_mov_b32 s81, 0x0f0f0f0f
    v_cndmask_b32 v14, 0, -1, s[80:81]
    v_cndmask_b32 v15, -1, 0, s[80:81]
    v_lshlrev_b32 v28, 2, v0
    s_lshr_b32 s27, s101, 2
    s_cmp_lt_u32 s2, 28
    s_cbranch_scc1 L_flags
    s_lshl2_add_u32 s95, s2, s3
    s_lshl_b32 s73, s95, 8
    s_add_u32 s73, s73, 0xf9000
    s_mov_b32 s1, 0
    s_mov_b32 exec_hi, 0
    s_waitcnt vmcnt(0)
    s_movk_i32 s96, 1000
    s_add_u32 s97, s73, 0x0
    buffer_store_dword v28, v28, s[36:39], s97 offen sc1
L_rc0:
    s_getreg_b32 s74, hwreg(HW_REG_IB_STS, 0, 4)
    s_sub_u32 s1, s1, 1
    s_sub_u32 s96, s96, 1
    s_cselect_b32 s74, 0, s74
    s_cmp_lg_u32 s74, 0
    s_cbranch_scc1 L_rc0
    s_movk_i32 s96, 1000
    s_add_u32 s97, s73, 0x2000
    buffer_store_dword v28, v28, s[36:39], s97 offen sc1
L_rc1:
L_ws2:
    s_cbranch_execz L_ws6
    s_getreg_b32 s74, hwreg(HW_REG_IB_STS, 0, 4)
    s_add_u32 s1, s1, 1
    s_sub_u32 s96, s96, 1
    s_cselect_b32 s74, 0, s74
    s_cmp_lg_u32 s74, 0
    s_cbranch_scc1 L_rc1
    s_movk_i32 s96, 1000
    s_add_u32 s97, s73, 0x3000
    buffer_store_dword v28, v28, s[36:39], s97 offen sc1
L_rc2:
    s_getreg_b32 s74, hwreg(HW_REG_IB_STS, 0, 4)
    s_add_u32 s1, s1, 1
    s_sub_u32 s96, s96, 1
    s_cselect_b32 s74, 0, s74
    s_cmp_lg_u32 s74, 0
    s_cbranch_scc1 L_rc2
    s_movk_i32 s96, 1000
    s_add_u32 s97, s73, 0x1000
    buffer_store_dword v28, v28, s[36:39], s97 offen sc1
L_rc3:
    s_getreg_b32 s74, hwreg(HW_REG_IB_STS, 0, 4)
    s_sub_u32 s1, s1, 1
    s_sub_u32 s96, s96, 1
    s_cselect_b32 s74, 0, s74
    s_cmp_lg_u32 s74, 0
    s_cbranch_scc1 L_rc3
    s_lshr_b32 s1, s1, 31
    s_xor_b32 s1, s1, s27
    s_add_u32 s1, s1, 1
    v_mov_b32 v29, s1
    s_lshl_b32 s95, s95, 2
    s_sub_u32 s95, s95, 320
    s_mov_b64 exec, 1
    buffer_store_dword v29, off, s[40:43], s95 sc1
    s_mov_b64 exec, -1
    s_waitcnt vmcnt(0)
L_flags:
    buffer_load_dword v29, v28, s[40:43], 0 offen sc1
    s_waitcnt vmcnt(0)
    v_cmp_eq_u32 vcc, 0, v29
    s_nop 0
    s_cmp_eq_u32 vcc_lo, 0
    s_nop 2
    s_cbranch_scc1 L_flagsok
    s_sleep 4
    s_sub_u32 s72, s72, 1
    s_cbranch_scc0 L_flags
    s_endpgm
L_flagsok:
    v_cmp_eq_u32 vcc, 2, v29
    s_nop 0
    s_bcnt1_i32_b32 s73, vcc_hi
    v_cmp_eq_u32 vcc, 1, v29
    s_nop 0
    s_bcnt1_i32_b32 s74, vcc_hi
    s_cmp_gt_u32 s73, s74
    s_cselect_b32 s1, 1, 0
    s_xor_b32 s1, s1, s27
    s_and_b32 s1, s1, 1
    s_lshl_b32 s101, s1, 13
    s_mov_b32 s86, 0
    s_mov_b32 s100, 0
    s_mov_b32 s91, 5
L_loop:
    s_and_b32 s73, s86, 1
    s_lshl_b32 s73, s73, 1
    s_lshr_b32 s74, s86, 1
    s_or_b32 s73, s73, s74
    s_lshl_b32 s7, s74, 8
    s_lshl_b32 s87, s73, 5
    s_add_u32 s96, s87, s93
    s_bitcmp1_b32 s86, 0
    s_cselect_b32 s95, 4096, 0
    s_add_u32 s95, s95, 3072
    s_add_u32 s95, s95, s7
    s_add_u32 s95, s95, s93
    s_lshl_b32 s90, s73, 15
    s_add_u32 s90, s90, 0x58000
    s_and_b32 s74, s3, 2
    s_lshl4_add_u32 s74, s74, s2
    s_lshl_b32 s74, s74, 8
    s_add_u32 s88, s90, s74
    s_lshl_b32 s74, s3, 11
    s_add_u32 s90, s90, s74
    s_add_u32 s90, s90, s101
    s_lshl2_add_u32 s94, s73, s3
    s_lshl_b32 s94, s94, 15
    s_add_u32 s94, s94, s101
    s_add_u32 s94, s94, 0x80000
    v_mov_b64 v[96:97], 0
    v_mov_b64 v[100:101], 0
    v_mov_b64 v[104:105], 0
    v_mov_b64 v[108:109], 0
    v_mov_b64 v[64:65], 0
    v_mov_b64 v[68:69], 0
    v_mov_b64 v[72:73], 0
    v_mov_b64 v[76:77], 0
    v_mov_b64 v[56:57], 0
    v_mov_b64 v[58:59], 0
    v_mov_b64 v[60:61], 0
    v_mov_b64 v[62:63], 0
    v_and_b32 v36, 16, v1
    s_mov_b32 s73, 0xffff
    v_lshlrev_b32 v36, v36, s73
    v_and_b32 v37, 0x300, v1
    v_add_u32 v37, v37, v1
    s_mov_b32 s80, 0xcccccccc
    s_mov_b32 s81, 0xcccccccc
    buffer_load_dwordx4 v[48:51], v37, s[36:39], s95 offen offset:0 sc1
    buffer_load_dwordx4 v[52:55], v37, s[36:39], s95 offen offset:2048 sc1
L_stats:
    buffer_load_dwordx2 v[32:33], v5, s[36:39], s96 offen sc1
    s_waitcnt vmcnt(0)
    v_max_u32 v28, v32, v33
    v_cmp_eq_u32 vcc, -1, v28
    s_nop 4
    s_cbranch_vccz L_statsok
    s_sleep 2
    s_sub_u32 s72, s72, 1
    s_cbranch_scc0 L_stats
    s_endpgm
L_statsok:
    s_bitcmp1_b32 s86, 0
    s_cbranch_scc1 L_noprobe
    s_mov_b64 exec, 0x7f
L_probe:
    buffer_load_dword v48, v4, s[36:39], s95 offen sc1
    s_waitcnt vmcnt(0)
    v_cmp_ne_u32 vcc, -1, v48
    s_nop 4
    s_cbranch_vccnz L_probeok
    s_sleep 2
    s_sub_u32 s72, s72, 1
    s_cbranch_scc0 L_probe
    s_endpgm
L_probeok:
    s_mov_b64 exec, -1
    s_cmp_lg_u32 s86, 0
    s_cbranch_scc1 L_ntp
    v_lshlrev_b32 v48, 3, v1
    s_mov_b32 exec_lo, 0xff00ffff
    s_mov_b32 exec_hi, 0x00ffffff
    buffer_load_dword v48, v48, s[36:39], s93 offen sc1
    s_mov_b64 exec, -1
L_ntp:
L_noprobe:
    buffer_load_dwordx4 v[48:51], v37, s[36:39], s95 offen offset:0 sc1
    buffer_load_dwordx4 v[52:55], v37, s[36:39], s95 offen offset:2048 sc1
    v_mov_b32 v40, v32
    s_nop 1
    v_max_f32_dpp v40, v40, v40 quad_perm:[1,0,3,2] row_mask:0xf bank_mask:0xf
    s_nop 1
    v_max_f32_dpp v40, v40, v40 quad_perm:[2,3,0,1] row_mask:0xf bank_mask:0xf
    v_mov_b32 v28, v40
    s_nop 1
    v_max_f32_dpp v28, v28, v28 row_ror:4 row_mask:0xf bank_mask:0xf
    v_mov_b32 v30, v28
    s_nop 1
    v_permlane16_swap_b32 v28, v30
    v_max_f32 v28, v28, v30
    v_mov_b32 v30, v28
    s_nop 1
    v_permlane32_swap_b32 v28, v30
    v_max_f32 v28, v28, v30
    v_sub_f32 v29, v32, v28
    v_sub_f32 v40, v40, v28
    v_exp_f32 v29, v29
    v_exp_f32 v40, v40
    v_mul_f32 v29, v29, v33
    s_nop 1
    v_add_f32_dpp v29, v29, v29 quad_perm:[1,0,3,2] row_mask:0xf bank_mask:0xf
    s_nop 1
    v_add_f32_dpp v29, v29, v29 quad_perm:[2,3,0,1] row_mask:0xf bank_mask:0xf
    s_nop 1
    v_add_f32_dpp v29, v29, v29 row_ror:4 row_mask:0xf bank_mask:0xf
    v_mov_b32 v30, v29
    s_nop 1
    v_permlane16_swap_b32 v29, v30
    v_add_f32 v29, v29, v30
    v_mov_b32 v30, v29
    s_nop 1
    v_permlane32_swap_b32 v29, v30
    v_add_f32 v29, v29, v30
    v_rcp_f32 v29, v29
    s_nop 0
    v_mul_f32 v40, v40, v29
    v_cvt_pk_bf16_f32 v28, 0, v40
    v_sub_f32 v28, v40, v28
    v_cndmask_b32 v40, v40, v28, s[80:81]
    v_cvt_pk_bf16_f32 v40, v40, v40
    v_and_b32 v40, v40, v36
    buffer_load_dwordx4 v[80:83], v37, s[36:39], s95 offen offset:0 sc1
    buffer_load_dwordx4 v[84:87], v37, s[36:39], s95 offen offset:2048 sc1
    v_mov_b32_dpp v56, v40 quad_perm:[0,1,2,3] row_mask:0xf bank_mask:0x1
    v_mov_b32_dpp v57, v40 row_ror:4 row_mask:0xf bank_mask:0x2
    v_mov_b32_dpp v58, v40 quad_perm:[0,1,2,3] row_mask:0xf bank_mask:0x4
    v_mov_b32_dpp v59, v40 row_ror:4 row_mask:0xf bank_mask:0x8
    v_mov_b32_dpp v60, v40 row_ror:4 row_mask:0xf bank_mask:0x1
    v_mov_b32_dpp v61, v40 quad_perm:[0,1,2,3] row_mask:0xf bank_mask:0x2
    v_mov_b32_dpp v62, v40 row_ror:4 row_mask:0xf bank_mask:0x4
    v_mov_b32_dpp v63, v40 quad_perm:[0,1,2,3] row_mask:0xf bank_mask:0x8
    s_nop 1
L_ogather:
    s_waitcnt vmcnt(3)
    v_mfma_f32_16x16x32_bf16 v[44:47], v[56:59], v[48:51], 0
    s_waitcnt vmcnt(2)
    v_mfma_f32_16x16x32_bf16 v[44:47], v[60:63], v[52:55], v[44:47]
    v_max3_u32 v29, v48, v49, v50
    v_max3_u32 v29, v29, v51, v52
    v_max3_u32 v29, v29, v53, v54
    v_max_u32 v29, v29, v55
    v_cmp_eq_u32 vcc, -1, v29
    s_nop 2
    v_pk_add_f32 v[44:45], v[44:45], v[46:47]
    v_cvt_pk_bf16_f32 v16, v44, v45
    s_nop 1
    v_mov_b32_dpp v17, v16 row_ror:12 row_mask:0xf bank_mask:0xf
    s_cbranch_vccnz L_oagain
L_ook:
    v_mov_b32_dpp v18, v16 row_ror:14 row_mask:0xf bank_mask:0xf
    v_mov_b32_dpp v19, v16 row_ror:10 row_mask:0xf bank_mask:0xf
    v_mov_b32_dpp v20, v16 row_ror:8 row_mask:0xf bank_mask:0xf
    v_mov_b32_dpp v21, v16 row_ror:4 row_mask:0xf bank_mask:0xf
    v_smfmac_f32_16x16x64_bf16 v[96:99], v[16:19], a[128:135], v3
    v_mov_b32_dpp v22, v16 row_ror:6 row_mask:0xf bank_mask:0xf
    v_smfmac_f32_16x16x64_bf16 v[100:103], v[16:19], a[136:143], v3
    v_mov_b32_dpp v23, v16 row_ror:2 row_mask:0xf bank_mask:0xf
    v_smfmac_f32_16x16x64_bf16 v[104:107], v[16:19], a[144:151], v3
    v_smfmac_f32_16x16x64_bf16 v[108:111], v[16:19], a[152:159], v3
    v_smfmac_f32_16x16x64_bf16 v[96:99], v[20:23], a[192:199], v3
L_ws3:
    s_cbranch_execz L_wr5
    s_nop 0
    v_smfmac_f32_16x16x64_bf16 v[100:103], v[20:23], a[200:207], v3
    s_nop 1
    v_smfmac_f32_16x16x64_bf16 v[104:107], v[20:23], a[208:215], v3
    s_nop 1
    v_add_f32_dpp v28, v96, v97 quad_perm:[0,1,2,3] row_mask:0x1 bank_mask:0xf
    v_smfmac_f32_16x16x64_bf16 v[108:111], v[20:23], a[216:223], v3
    s_nop 1
    v_add_f32_dpp v29, v100, v101 quad_perm:[0,1,2,3] row_mask:0x1 bank_mask:0xf
    v_smfmac_f32_16x16x64_bf16 v[64:67], v[16:19], a[160:167], v3
    s_nop 1
    v_add_f32_dpp v28, v104, v105 quad_perm:[0,1,2,3] row_mask:0x4 bank_mask:0xf
    v_smfmac_f32_16x16x64_bf16 v[68:71], v[16:19], a[168:175], v3
    s_nop 1
    v_add_f32_dpp v29, v108, v109 quad_perm:[0,1,2,3] row_mask:0x4 bank_mask:0xf
    v_smfmac_f32_16x16x64_bf16 v[64:67], v[20:23], a[224:231], v3
    s_nop 1
    v_smfmac_f32_16x16x64_bf16 v[68:71], v[20:23], a[232:239], v3
    s_nop 1
    v_smfmac_f32_16x16x64_bf16 v[72:75], v[16:19], a[176:183], v3
    s_nop 1
    v_add_f32_dpp v28, v64, v65 quad_perm:[0,1,2,3] row_mask:0x2 bank_mask:0xf
    v_smfmac_f32_16x16x64_bf16 v[76:79], v[16:19], a[184:191], v3
    s_nop 1
    v_add_f32_dpp v29, v68, v69 quad_perm:[0,1,2,3] row_mask:0x2 bank_mask:0xf
    v_smfmac_f32_16x16x64_bf16 v[72:75], v[20:23], a[240:247], v3
    s_nop 1
    v_smfmac_f32_16x16x64_bf16 v[76:79], v[20:23], a[248:255], v3
    s_nop 1
    s_nop 2
    v_add_f32_dpp v28, v72, v73 quad_perm:[0,1,2,3] row_mask:0x8 bank_mask:0xf
    s_nop 1
    v_add_f32_dpp v29, v76, v77 quad_perm:[0,1,2,3] row_mask:0x8 bank_mask:0xf
    ds_write_b64 v25, v[28:29] offset:0
    s_waitcnt lgkmcnt(0)
    s_barrier
    ds_read_b64 v[98:99], v2 offset:0
    ds_read_b64 v[102:103], v2 offset:512
    ds_read_b64 v[106:107], v2 offset:1024
    ds_read_b64 v[110:111], v2 offset:1536
    s_waitcnt lgkmcnt(2)
    v_pk_add_f32 v[98:99], v[98:99], v[102:103]
    s_waitcnt lgkmcnt(0)
    v_pk_add_f32 v[106:107], v[106:107], v[110:111]
    v_pk_add_f32 v[98:99], v[98:99], v[106:107]
    s_mov_b64 exec, s[4:5]
    v_cvt_pk_bf16_f32 v98, v98, v99
    v_min_u32 v98, -2, v98
    buffer_store_dword v98, v26, s[36:39], s88 offen sc1
    s_mov_b64 exec, -1
    s_waitcnt vmcnt(1)
    s_cmp_lg_u32 s86, 0
    s_cbranch_scc1 L_nty
    v_lshlrev_b32 v27, 3, v1
    s_mov_b32 exec_lo, 0xff00ffff
    s_mov_b32 exec_hi, 0x00ffffff
    buffer_load_dword v27, v27, s[36:39], s93 offen sc1
    s_mov_b64 exec, -1
L_nty:
    ds_read_b128 v[32:35], v11 offset:0
    ds_read_b128 v[36:39], v11 offset:1024
    ds_read_b128 v[40:43], v11 offset:2048
    ds_read_b128 v[44:47], v11 offset:3072
    ds_read_b128 v[48:51], v11 offset:4096
    ds_read_b128 v[52:55], v11 offset:5120
    ds_read_b128 v[56:59], v11 offset:6144
    ds_read_b128 v[60:63], v11 offset:7168
    ds_read_b128 v[64:67], v11 offset:8192
    ds_read_b128 v[68:71], v11 offset:9216
    ds_read_b128 v[72:75], v11 offset:10240
    ds_read_b128 v[76:79], v11 offset:11264
    v_mov_b64 v[96:97], 0
    v_mov_b64 v[100:101], 0
    v_mov_b64 v[104:105], 0
    v_mov_b64 v[108:109], 0
    v_mov_b64 v[80:81], 0
    v_mov_b64 v[84:85], 0
    v_mov_b64 v[88:89], 0
    v_mov_b64 v[92:93], 0
    s_lshl_b32 s88, s2, 8
    s_add_u32 s88, s88, s94
    s_andn2_b32 s95, s88, 8192
    v_and_b32 v28, 16, v1
    s_movk_i32 s73, 0x3f80
    v_lshlrev_b32 v28, v28, s73
    s_mov_b32 s80, 0x00030003
    s_mov_b32 s81, 0x00030003
    v_cndmask_b32 v120, 0, v28, s[80:81]
    s_mov_b32 s80, 0x00300030
    s_mov_b32 s81, 0x00300030
    v_cndmask_b32 v121, 0, v28, s[80:81]
    s_mov_b32 s80, 0x03000300
    s_mov_b32 s81, 0x03000300
    v_cndmask_b32 v122, 0, v28, s[80:81]
    s_mov_b32 s80, 0x30003000
    s_mov_b32 s81, 0x30003000
    v_cndmask_b32 v123, 0, v28, s[80:81]
    s_waitcnt vmcnt(0)
    s_nop 0
L_y_ld:
    buffer_load_dwordx4 v[124:127], v1, s[36:39], s90 offen offset:0 sc1
    buffer_load_dwordx4 v[20:23], v1, s[36:39], s90 offen offset:1024 sc1
    s_waitcnt vmcnt(1)
    v_mfma_f32_16x16x32_bf16 v[28:31], v[120:123], v[124:127], 0
    s_waitcnt vmcnt(0)
    v_mfma_f32_16x16x32_bf16 v[28:31], v[120:123], v[20:23], v[28:31]
    s_nop 7
    v_cmp_u_f32 vcc, v28, v29
    v_cvt_pk_bf16_f32 v28, 0, v28
    v_cvt_pk_bf16_f32 v29, 0, v29
    v_pk_add_f32 v[28:29], v[112:113], v[28:29]
L_fgemv:
    v_cvt_pk_bf16_f32 v16, v28, v29
    v_readfirstlane_b32 s74, v28
    s_cbranch_vccnz L_y_bad
L_y_ok:
    v_mov_b32_dpp v17, v16 row_ror:12 row_mask:0xf bank_mask:0xf
    v_mov_b32_dpp v18, v16 row_ror:14 row_mask:0xf bank_mask:0xf
    v_mov_b32_dpp v19, v16 row_ror:10 row_mask:0xf bank_mask:0xf
    v_cvt_pk_bf16_f32 v112, 0, v28
    v_cvt_pk_bf16_f32 v113, 0, v29
    v_smfmac_f32_16x16x64_bf16 v[96:99], v[16:19], v[128:135], v3
    v_subrev_f32 v122, s74, v112
    v_subrev_f32 v123, s74, v113
    v_smfmac_f32_16x16x64_bf16 v[100:103], v[16:19], v[136:143], v3
    v_mul_f32 v121, v122, v122
    v_add_f32 v120, v122, v123
    v_smfmac_f32_16x16x64_bf16 v[104:107], v[16:19], v[144:151], v3
    v_fmac_f32 v121, v123, v123
    v_mov_b32_dpp v20, v16 row_ror:8 row_mask:0xf bank_mask:0xf
    v_smfmac_f32_16x16x64_bf16 v[108:111], v[16:19], v[152:159], v3
    v_permlane32_swap_b32 v120, v121
    v_add_f32 v120, v120, v121
    v_smfmac_f32_16x16x64_bf16 v[80:83], v[16:19], v[160:167], v3
    v_mov_b32_dpp v21, v16 row_ror:4 row_mask:0xf bank_mask:0xf
    v_add_f32_dpp v120, v120, v120 quad_perm:[1,0,3,2] row_mask:0xf bank_mask:0xf
    v_smfmac_f32_16x16x64_bf16 v[84:87], v[16:19], v[168:175], v3
    v_mov_b32_dpp v22, v16 row_ror:6 row_mask:0xf bank_mask:0xf
    v_add_f32_dpp v120, v120, v120 quad_perm:[2,3,0,1] row_mask:0xf bank_mask:0xf
    v_smfmac_f32_16x16x64_bf16 v[88:91], v[16:19], v[176:183], v3
    v_mov_b32_dpp v23, v16 row_ror:2 row_mask:0xf bank_mask:0xf
    v_add_f32_dpp v120, v120, v120 row_ror:4 row_mask:0xf bank_mask:0xf
    s_nop 0
    v_smfmac_f32_16x16x64_bf16 v[96:99], v[20:23], v[192:199], v3
    v_add_f32_dpp v120, v120, v120 row_ror:8 row_mask:0xf bank_mask:0xf
    v_smfmac_f32_16x16x64_bf16 v[100:103], v[20:23], v[200:207], v3
    s_nop 0
    v_add_f32_dpp v120, v120, v120 row_bcast:15 row_mask:0xa bank_mask:0xf
    v_writelane_b32 v120, s74, 0
    s_mov_b64 exec, s[78:79]
    ds_write_b32 v13, v120 offset:10240
    s_mov_b64 exec, -1
    v_smfmac_f32_16x16x64_bf16 v[104:107], v[20:23], v[208:215], v3
    s_nop 1
    v_add_f32_dpp v28, v96, v97 quad_perm:[0,1,2,3] row_mask:0x1 bank_mask:0xf
    v_smfmac_f32_16x16x64_bf16 v[108:111], v[20:23], v[216:223], v3
    s_nop 1
    v_add_f32_dpp v29, v100, v101 quad_perm:[0,1,2,3] row_mask:0x1 bank_mask:0xf
    v_smfmac_f32_16x16x64_bf16 v[92:95], v[16:19], v[184:191], v3
    s_nop 1
    v_add_f32_dpp v28, v104, v105 quad_perm:[0,1,2,3] row_mask:0x4 bank_mask:0xf
    v_smfmac_f32_16x16x64_bf16 v[80:83], v[20:23], v[224:231], v3
    s_waitcnt lgkmcnt(0)
    s_barrier
    ds_read_b128 v[124:127], v12 offset:10240
    v_add_f32_dpp v29, v108, v109 quad_perm:[0,1,2,3] row_mask:0x4 bank_mask:0xf
    v_smfmac_f32_16x16x64_bf16 v[84:87], v[20:23], v[232:239], v3
L_ws4:
    s_cbranch_execz L_wr5
    s_nop 0
    v_smfmac_f32_16x16x64_bf16 v[88:91], v[20:23], v[240:247], v3
    s_nop 1
    v_add_f32_dpp v28, v80, v81 quad_perm:[0,1,2,3] row_mask:0x2 bank_mask:0xf
    v_smfmac_f32_16x16x64_bf16 v[92:95], v[20:23], v[248:255], v3
    s_nop 1
    v_add_f32_dpp v29, v84, v85 quad_perm:[0,1,2,3] row_mask:0x2 bank_mask:0xf
    s_waitcnt lgkmcnt(0)
    v_add_f32_dpp v28, v88, v89 quad_perm:[0,1,2,3] row_mask:0x8 bank_mask:0xf
    v_mul_f32 v125, 0x3c000000, v125
    v_mul_f32 v127, 0x3c000000, v127
    v_add_f32 v124, v124, v125
    v_add_f32_dpp v29, v92, v93 quad_perm:[0,1,2,3] row_mask:0x8 bank_mask:0xf
    ds_write_b64 v7, v[28:29] offset:8192
    v_fma_f32 v127, -v125, v125, v127
    v_add_f32_dpp v126, v124, v124 quad_perm:[1,0,3,2] row_mask:0xf bank_mask:0xf
    v_mov_b32 v30, 0xc0135761
    s_nop 0
    v_add_f32_dpp v126, v126, v126 quad_perm:[2,3,0,1] row_mask:0xf bank_mask:0xf
    v_mul_f32 v126, 0.25, v126
    v_sub_f32 v125, v124, v126
    v_fmac_f32 v127, v125, v125
    v_cvt_pk_bf16_f32 v126, 0, v126
    v_mul_f32 v120, v126, v118
    v_add_f32_dpp v127, v127, v127 quad_perm:[1,0,3,2] row_mask:0xf bank_mask:0xf
    v_mul_f32 v121, v126, v119
    s_nop 0
    v_add_f32_dpp v127, v127, v127 quad_perm:[2,3,0,1] row_mask:0xf bank_mask:0xf
    v_mul_f32 v127, 0.25, v127
    s_waitcnt lgkmcnt(0)
    s_barrier
    ds_read2_b32 v[98:99], v9 offset0:0 offset1:16
    ds_read2_b32 v[102:103], v9 offset0:128 offset1:144
    ds_read2_b32 v[106:107], v10 offset0:0 offset1:16
    ds_read2_b32 v[110:111], v10 offset0:128 offset1:144
    ds_read_b128 v[80:83], v11 offset:12288
    ds_read_b128 v[84:87], v11 offset:13312
    ds_read_b128 v[88:91], v11 offset:14336
    ds_read_b128 v[92:95], v11 offset:15360
    s_cmp_eq_u32 s91, 4
    v_max_f32 v127, 0, v127
    v_cvt_pk_bf16_f32 v127, 0, v127
    v_add_f32 v127, 0x3727c5ac, v127
    v_cvt_pk_bf16_f32 v127, 0, v127
    v_sqrt_f32 v127, v127
    s_nop 0
    v_cvt_pk_bf16_f32 v127, 0, v127
    v_rcp_f32 v122, v127
    s_nop 0
    v_mul_f32 v120, -v120, v122
    v_mul_f32 v121, -v121, v122
    s_waitcnt lgkmcnt(6)
    v_pk_add_f32 v[98:99], v[98:99], v[102:103]
    s_waitcnt lgkmcnt(4)
    v_pk_add_f32 v[106:107], v[106:107], v[110:111]
    v_pk_add_f32 v[98:99], v[98:99], v[106:107]
    s_cbranch_scc1 L_csf
    v_pk_fma_f32 v[98:99], v[98:99], v[122:123], v[120:121] op_sel_hi:[1,0,1]
    v_cvt_pk_bf16_f32 v98, 0, v98
    v_mul_f32 v31, v98, v98
    v_fmac_f32 v30, 0xbdd2d3e8, v31
    v_mul_f32 v31, v30, v98
    v_exp_f32 v31, v31
    v_cvt_pk_bf16_f32 v99, 0, v99
    v_add_f32 v31, 1.0, v31
    v_rcp_f32 v31, v31
    v_mov_b64 v[96:97], 0
    v_mul_f32 v31, v31, v98
    v_cvt_pk_bf16_f32 v31, 0, v31
    v_mul_f32 v31, v31, v99
    s_bitcmp1_b32 s86, 0
    v_mov_b64 v[100:101], 0
    v_mov_b32_dpp v30, v31 row_ror:8 row_mask:0xf bank_mask:0xf
    v_cvt_pk_bf16_f32 v31, v31, v30
    v_mov_b64 v[104:105], 0
    v_mov_b64 v[108:109], 0
    v_and_b32 v16, v31, v14
    v_and_b32_dpp v17, v31, v14 row_ror:14 row_mask:0xf bank_mask:0xf
    v_and_b32_dpp v18, v31, v14 row_ror:12 row_mask:0xf bank_mask:0xf
    v_and_b32_dpp v19, v31, v14 row_ror:10 row_mask:0xf bank_mask:0xf
    v_and_b32_dpp v20, v31, v15 row_ror:4 row_mask:0xf bank_mask:0xf
    v_and_b32_dpp v21, v31, v15 row_ror:2 row_mask:0xf bank_mask:0xf
    s_waitcnt lgkmcnt(0)
    v_smfmac_f32_16x16x64_bf16 v[96:99], v[16:19], v[32:39], v3 abid:1
    v_and_b32 v22, v31, v15
    v_smfmac_f32_16x16x64_bf16 v[100:103], v[16:19], v[40:47], v3 abid:1
    v_and_b32_dpp v23, v31, v15 row_ror:14 row_mask:0xf bank_mask:0xf
    v_smfmac_f32_16x16x64_bf16 v[104:107], v[16:19], v[48:55], v3 abid:1
    s_nop 0
    v_smfmac_f32_16x16x64_bf16 v[96:99], v[20:23], v[64:71], v3 abid:1
    s_nop 1
    v_smfmac_f32_16x16x64_bf16 v[100:103], v[20:23], v[72:79], v3 abid:1
    s_nop 1
    v_smfmac_f32_16x16x64_bf16 v[108:111], v[16:19], v[56:63], v3 abid:1
    s_nop 1
    v_add_f32 v96, v96, v97
    v_smfmac_f32_16x16x64_bf16 v[104:107], v[20:23], v[80:87], v3 abid:1
    s_nop 1
    v_add_f32 v100, v100, v101
    v_smfmac_f32_16x16x64_bf16 v[108:111], v[20:23], v[88:95], v3 abid:1
    s_nop 1
    v_cvt_pk_bf16_f32 v98, v96, v100
    v_min_u32 v98, -2, v98
    v_add_f32 v104, v104, v105
    s_nop 2
    v_add_f32 v108, v108, v109
    v_cvt_pk_bf16_f32 v99, v104, v108
    v_min_u32 v99, -2, v99
    buffer_store_dwordx2 v[98:99], v24, s[36:39], s95 offen sc1
    s_nop 0
    s_cbranch_scc1 L_out
    v_and_b32 v28, 16, v1
    s_movk_i32 s73, 0x3f80
    v_lshlrev_b32 v28, v28, s73
    s_mov_b32 s80, 0x00030003
    s_mov_b32 s81, 0x00030003
    v_cndmask_b32 v64, 0, v28, s[80:81]
    s_mov_b32 s80, 0x00300030
    s_mov_b32 s81, 0x00300030
    v_cndmask_b32 v65, 0, v28, s[80:81]
    s_mov_b32 s80, 0x03000300
    s_mov_b32 s81, 0x03000300
    v_cndmask_b32 v66, 0, v28, s[80:81]
    s_mov_b32 s80, 0x30003000
    s_mov_b32 s81, 0x30003000
    v_cndmask_b32 v67, 0, v28, s[80:81]
    s_add_u32 s95, s94, 4096
    v_mov_b64 v[96:97], 0
    v_mov_b64 v[100:101], 0
    v_mov_b64 v[104:105], 0
    v_mov_b64 v[108:109], 0
    v_mov_b64 v[80:81], 0
    v_mov_b64 v[84:85], 0
    v_mov_b64 v[88:89], 0
    v_mov_b64 v[92:93], 0
    s_add_u32 s87, s87, 64
    s_lshl3_add_u32 s88, s87, s89
    s_cmp_lg_u32 s86, 0
    s_cbranch_scc1 L_ntz
    v_lshlrev_b32 v72, 3, v1
    s_mov_b32 exec_lo, 0xff00ffff
    s_mov_b32 exec_hi, 0x00ffffff
    buffer_load_dword v72, v72, s[36:39], s93 offen sc1
    s_mov_b64 exec, -1
L_ntz:
    s_waitcnt vmcnt(0)
L_z_ld:
    buffer_load_dwordx4 v[32:35], v1, s[36:39], s94 offen offset:0 sc1
    buffer_load_dwordx4 v[36:39], v1, s[36:39], s94 offen offset:1024 sc1
    buffer_load_dwordx4 v[40:43], v1, s[36:39], s94 offen offset:2048 sc1
    buffer_load_dwordx4 v[44:47], v1, s[36:39], s94 offen offset:3072 sc1
    buffer_load_dwordx4 v[48:51], v1, s[36:39], s95 offen offset:0 sc1
    buffer_load_dwordx4 v[52:55], v1, s[36:39], s95 offen offset:1024 sc1
    buffer_load_dwordx4 v[56:59], v1, s[36:39], s95 offen offset:2048 sc1
    s_waitcnt vmcnt(6)
    v_mfma_f32_16x16x32_bf16 v[28:31], v[64:67], v[32:35], 0
    s_waitcnt vmcnt(5)
    v_mfma_f32_16x16x32_bf16 v[28:31], v[64:67], v[36:39], v[28:31]
    s_waitcnt vmcnt(4)
    v_mfma_f32_16x16x32_bf16 v[28:31], v[64:67], v[40:43], v[28:31]
    s_waitcnt vmcnt(3)
    v_mfma_f32_16x16x32_bf16 v[28:31], v[64:67], v[44:47], v[28:31]
    s_waitcnt vmcnt(2)
    v_mfma_f32_16x16x32_bf16 v[28:31], v[64:67], v[48:51], v[28:31]
    s_waitcnt vmcnt(1)
    v_mfma_f32_16x16x32_bf16 v[28:31], v[64:67], v[52:55], v[28:31]
    s_waitcnt vmcnt(0)
    v_mfma_f32_16x16x32_bf16 v[28:31], v[64:67], v[56:59], v[28:31]
    s_nop 7
    v_cmp_u_f32 vcc, v28, v29
    v_cvt_pk_bf16_f32 v28, 0, v28
    v_cvt_pk_bf16_f32 v29, 0, v29
    v_pk_add_f32 v[28:29], v[112:113], v[28:29]
L_qstage:
    v_cvt_pk_bf16_f32 v16, v28, v29
    v_readfirstlane_b32 s74, v28
    s_cbranch_vccnz L_z_bad
L_z_ok:
    v_mov_b32_dpp v17, v16 row_ror:12 row_mask:0xf bank_mask:0xf
    v_mov_b32_dpp v18, v16 row_ror:14 row_mask:0xf bank_mask:0xf
    v_mov_b32_dpp v19, v16 row_ror:10 row_mask:0xf bank_mask:0xf
    v_cvt_pk_bf16_f32 v112, 0, v28
    v_cvt_pk_bf16_f32 v113, 0, v29
    v_smfmac_f32_16x16x64_bf16 v[96:99], v[16:19], a[0:7], v3
    v_subrev_f32 v122, s74, v112
    v_subrev_f32 v123, s74, v113
    v_smfmac_f32_16x16x64_bf16 v[100:103], v[16:19], a[8:15], v3
    v_mul_f32 v121, v122, v122
    v_add_f32 v120, v122, v123
    v_smfmac_f32_16x16x64_bf16 v[104:107], v[16:19], a[16:23], v3
    v_fmac_f32 v121, v123, v123
    v_mov_b32_dpp v20, v16 row_ror:8 row_mask:0xf bank_mask:0xf
    v_smfmac_f32_16x16x64_bf16 v[108:111], v[16:19], a[24:31], v3
    v_permlane32_swap_b32 v120, v121
    v_add_f32 v120, v120, v121
    v_smfmac_f32_16x16x64_bf16 v[80:83], v[16:19], a[32:39], v3
    v_mov_b32_dpp v21, v16 row_ror:4 row_mask:0xf bank_mask:0xf
    v_add_f32_dpp v120, v120, v120 quad_perm:[1,0,3,2] row_mask:0xf bank_mask:0xf
    v_smfmac_f32_16x16x64_bf16 v[84:87], v[16:19], a[40:47], v3
    v_mov_b32_dpp v22, v16 row_ror:6 row_mask:0xf bank_mask:0xf
    v_add_f32_dpp v120, v120, v120 quad_perm:[2,3,0,1] row_mask:0xf bank_mask:0xf
    v_smfmac_f32_16x16x64_bf16 v[88:91], v[16:19], a[48:55], v3
    v_mov_b32_dpp v23, v16 row_ror:2 row_mask:0xf bank_mask:0xf
    v_add_f32_dpp v120, v120, v120 row_ror:4 row_mask:0xf bank_mask:0xf
    s_nop 0
    v_smfmac_f32_16x16x64_bf16 v[96:99], v[20:23], a[64:71], v3
    v_add_f32_dpp v120, v120, v120 row_ror:8 row_mask:0xf bank_mask:0xf
    v_smfmac_f32_16x16x64_bf16 v[100:103], v[20:23], a[72:79], v3
    s_nop 0
    v_add_f32_dpp v120, v120, v120 row_bcast:15 row_mask:0xa bank_mask:0xf
    v_writelane_b32 v120, s74, 0
    s_mov_b64 exec, s[78:79]
    ds_write_b32 v13, v120 offset:14336
    s_mov_b64 exec, -1
    v_smfmac_f32_16x16x64_bf16 v[104:107], v[20:23], a[80:87], v3
    s_nop 1
    v_add_f32_dpp v28, v96, v97 quad_perm:[0,1,2,3] row_mask:0x1 bank_mask:0xf
    v_smfmac_f32_16x16x64_bf16 v[108:111], v[20:23], a[88:95], v3
    s_nop 1
    v_add_f32_dpp v29, v100, v101 quad_perm:[0,1,2,3] row_mask:0x1 bank_mask:0xf
    v_smfmac_f32_16x16x64_bf16 v[92:95], v[16:19], a[56:63], v3
    s_nop 1
    v_add_f32_dpp v28, v104, v105 quad_perm:[0,1,2,3] row_mask:0x4 bank_mask:0xf
    v_smfmac_f32_16x16x64_bf16 v[80:83], v[20:23], a[96:103], v3
    s_waitcnt lgkmcnt(0)
    s_barrier
    ds_read_b128 v[124:127], v12 offset:14336
    v_add_f32_dpp v29, v108, v109 quad_perm:[0,1,2,3] row_mask:0x4 bank_mask:0xf
    v_smfmac_f32_16x16x64_bf16 v[84:87], v[20:23], a[104:111], v3
    s_nop 1
    v_smfmac_f32_16x16x64_bf16 v[88:91], v[20:23], a[112:119], v3
    s_nop 1
    v_add_f32_dpp v28, v80, v81 quad_perm:[0,1,2,3] row_mask:0x2 bank_mask:0xf
    v_smfmac_f32_16x16x64_bf16 v[92:95], v[20:23], a[120:127], v3
    s_nop 1
    v_add_f32_dpp v29, v84, v85 quad_perm:[0,1,2,3] row_mask:0x2 bank_mask:0xf
    s_waitcnt lgkmcnt(0)
    v_add_f32_dpp v28, v88, v89 quad_perm:[0,1,2,3] row_mask:0x8 bank_mask:0xf
    v_mul_f32 v125, 0x3c000000, v125
    v_mul_f32 v127, 0x3c000000, v127
    v_add_f32 v124, v124, v125
    v_add_f32_dpp v29, v92, v93 quad_perm:[0,1,2,3] row_mask:0x8 bank_mask:0xf
    ds_write_b64 v7, v[28:29] offset:12288
    v_fma_f32 v127, -v125, v125, v127
    v_add_f32_dpp v126, v124, v124 quad_perm:[1,0,3,2] row_mask:0xf bank_mask:0xf
    s_nop 1
    v_add_f32_dpp v126, v126, v126 quad_perm:[2,3,0,1] row_mask:0xf bank_mask:0xf
    v_mul_f32 v126, 0.25, v126
    v_sub_f32 v125, v124, v126
    v_fmac_f32 v127, v125, v125
    v_cvt_pk_bf16_f32 v126, 0, v126
    v_mul_f32 v120, v126, v116
    v_add_f32_dpp v127, v127, v127 quad_perm:[1,0,3,2] row_mask:0xf bank_mask:0xf
    v_mul_f32 v121, v126, v117
    s_nop 0
    v_add_f32_dpp v127, v127, v127 quad_perm:[2,3,0,1] row_mask:0xf bank_mask:0xf
    v_mul_f32 v127, 0.25, v127
    v_max_f32 v127, 0, v127
    s_waitcnt lgkmcnt(0)
    s_barrier
    ds_read_b64 v[98:99], v8 offset:12288
    ds_read_b64 v[102:103], v8 offset:12800
    ds_read_b64 v[106:107], v8 offset:13312
    ds_read_b64 v[110:111], v8 offset:13824
    s_cmp_eq_u32 s91, 0
    v_cvt_pk_bf16_f32 v127, 0, v127
    v_add_f32 v127, 0x3727c5ac, v127
    v_cvt_pk_bf16_f32 v127, 0, v127
    v_sqrt_f32 v127, v127
    s_nop 0
    v_cvt_pk_bf16_f32 v127, 0, v127
    v_rcp_f32 v122, v127
    s_nop 0
    v_mul_f32 v120, -v120, v122
    v_mul_f32 v121, -v121, v122
    s_waitcnt lgkmcnt(2)
    v_pk_add_f32 v[98:99], v[98:99], v[102:103]
    s_waitcnt lgkmcnt(0)
    v_pk_add_f32 v[106:107], v[106:107], v[110:111]
    v_pk_add_f32 v[98:99], v[98:99], v[106:107]
    s_cbranch_scc1 L_csq
    v_pk_fma_f32 v[98:99], v[98:99], v[122:123], v[120:121] op_sel_hi:[1,0,1]
    s_cmp_lg_u32 s3, 0
    v_cvt_pk_bf16_f32 v28, v98, v99
    v_min_u32 v28, -2, v28
    s_cbranch_scc1 L_qn
    buffer_store_dword v28, v26, s[36:39], s88 offen offset:1024
    buffer_store_dword v28, v26, s[36:39], s88 offen offset:2048 sc1
L_qn:
    v_add_u32 v29, s92, v26
    ds_write_b32 v29, v28
    s_waitcnt lgkmcnt(0)
    s_cmp_eq_u32 s91, 1
    s_cbranch_scc1 L_i1
    s_cmp_eq_u32 s91, 2
    s_cbranch_scc1 L_i2
L_own:
    v_and_b32 v30, 3, v0
    v_lshlrev_b32 v30, 4, v30
    v_lshrrev_b32 v31, 4, v0
    v_lshl_or_b32 v30, v31, 6, v30
    v_add_u32 v30, s92, v30
    v_add_u32 v31, s99, v1
    ds_read_b128 v[32:35], v30
    ds_read_b128 v[40:43], v31
    ds_read_b128 v[44:47], v31 offset:1024
    v_mov_b32 v28, 0x3e0293ee
    s_mov_b32 s80, 0x11111111
    s_mov_b32 s81, 0x11111111
    v_cndmask_b32 v48, 0, v28, s[80:81]
L_ws5:
    s_cbranch_execz L_wr5
    v_mov_b32 v28, 0xffff
    v_mov_b32 v29, 0xffff0000
    s_mov_b32 s80, 0x00010001
    s_mov_b32 s81, 0x00010001
    v_cndmask_b32 v52, 0, v28, s[80:81]
    s_mov_b32 s80, 0x00020002
    s_mov_b32 s81, 0x00020002
    v_cndmask_b32 v52, v52, v29, s[80:81]
    s_mov_b32 s80, 0x00040004
    s_mov_b32 s81, 0x00040004
    v_cndmask_b32 v53, 0, v28, s[80:81]
    s_mov_b32 s80, 0x00080008
    s_mov_b32 s81, 0x00080008
    v_cndmask_b32 v53, v53, v29, s[80:81]
    s_mov_b32 s80, 0x00100010
    s_mov_b32 s81, 0x00100010
    v_cndmask_b32 v54, 0, v28, s[80:81]
    s_mov_b32 s80, 0x00200020
    s_mov_b32 s81, 0x00200020
    v_cndmask_b32 v54, v54, v29, s[80:81]
    s_mov_b32 s80, 0x00400040
    s_mov_b32 s81, 0x00400040
    v_cndmask_b32 v55, 0, v28, s[80:81]
    s_mov_b32 s80, 0x00800080
    s_mov_b32 s81, 0x00800080
    v_cndmask_b32 v55, v55, v29, s[80:81]
    s_waitcnt lgkmcnt(0)
    s_mov_b32 s80, 0x000f000f
    s_mov_b32 s81, 0x000f000f
    v_cndmask_b32 v36, 0, v32, s[80:81]
    v_cndmask_b32 v37, 0, v33, s[80:81]
    v_cndmask_b32 v38, 0, v34, s[80:81]
    v_cndmask_b32 v39, 0, v35, s[80:81]
    s_nop 1
    v_mfma_f32_16x16x32_bf16 v[60:63], v[40:43], v[36:39], 0
    s_nop 7
    v_mul_f32_dpp v49, v60, v48 quad_perm:[0,0,0,0] row_mask:0xf bank_mask:0xf
    s_nop 1
    v_fmac_f32_dpp v49, v61, v48 quad_perm:[1,1,1,1] row_mask:0xf bank_mask:0xf
    s_nop 1
    v_fmac_f32_dpp v49, v62, v48 quad_perm:[2,2,2,2] row_mask:0xf bank_mask:0xf
    s_nop 1
    v_fmac_f32_dpp v49, v63, v48 quad_perm:[3,3,3,3] row_mask:0xf bank_mask:0xf
    s_lshl3_add_u32 s73, s3, s87
    s_add_u32 s73, s73, s89
    s_lshl_b32 s74, s3, 4
    v_mov_b32 v28, 0xff800000
    v_cndmask_b32 v49, v28, v49, s[78:79]
    v_mov_b32 v50, v49
    s_nop 1
    v_max_f32_dpp v50, v50, v50 quad_perm:[1,0,3,2] row_mask:0xf bank_mask:0xf
    s_nop 1
    v_max_f32_dpp v50, v50, v50 quad_perm:[2,3,0,1] row_mask:0xf bank_mask:0xf
    s_nop 1
    v_max_f32_dpp v50, v50, v50 row_ror:4 row_mask:0xf bank_mask:0xf
    s_nop 1
    v_max_f32_dpp v50, v50, v50 row_ror:8 row_mask:0xf bank_mask:0xf
    v_mov_b32 v28, v50
    s_nop 1
    v_permlane16_swap_b32 v50, v28
    v_max_f32 v50, v50, v28
    v_mov_b32 v28, v50
    s_nop 1
    v_permlane32_swap_b32 v50, v28
    v_max_f32 v50, v50, v28
    v_sub_f32 v49, v49, v50
    v_exp_f32 v49, v49
    s_nop 0
    v_cvt_pk_bf16_f32 v49, 0, v49
    v_mov_b32 v51, v49
    s_nop 1
    v_add_f32_dpp v51, v51, v51 quad_perm:[1,0,3,2] row_mask:0xf bank_mask:0xf
    s_nop 1
    v_add_f32_dpp v51, v51, v51 quad_perm:[2,3,0,1] row_mask:0xf bank_mask:0xf
    s_nop 1
    v_add_f32_dpp v51, v51, v51 row_ror:4 row_mask:0xf bank_mask:0xf
    s_nop 1
    v_add_f32_dpp v51, v51, v51 row_ror:8 row_mask:0xf bank_mask:0xf
    v_mov_b32 v28, v51
    s_nop 1
    v_permlane16_swap_b32 v51, v28
    v_add_f32 v51, v51, v28
    v_mov_b32 v28, v51
    s_nop 1
    v_permlane32_swap_b32 v51, v28
    v_add_f32 v51, v51, v28
    v_min_u32 v50, -2, v50
    v_min_u32 v51, -2, v51
    v_mov_b32 v28, s74
    s_mov_b64 exec, 1
    ds_write_b32 v28, v50 offset:4096
    s_mov_b64 exec, -1
    v_lshrrev_b32 v28, 16, v49
    v_or_b32 v28, v28, v49
    s_nop 1
    v_and_b32_dpp v56, v28, v52 row_newbcast:0 row_mask:0xf bank_mask:0xf
    v_and_b32_dpp v57, v28, v53 row_newbcast:0 row_mask:0xf bank_mask:0xf
    v_and_b32_dpp v58, v28, v54 row_newbcast:0 row_mask:0xf bank_mask:0xf
    v_and_b32_dpp v59, v28, v55 row_newbcast:0 row_mask:0xf bank_mask:0xf
    s_nop 1
    v_mfma_f32_16x16x32_bf16 v[60:63], v[56:59], v[44:47], 0
    v_and_b32 v48, 0x30, v1
    s_waitcnt lgkmcnt(0)
    s_barrier
    ds_read_b32 v48, v48 offset:4096
    s_bitcmp1_b32 s87, 5
    s_cselect_b32 s6, 256, 0
    s_bitcmp1_b32 s87, 6
    s_cselect_b32 s74, 4096, 0
    s_add_u32 s74, s74, 6656
    s_add_u32 s74, s74, s6
    s_add_u32 s74, s74, s89
    v_permlane32_swap_b32 v60, v62
    v_permlane32_swap_b32 v61, v63
    s_waitcnt lgkmcnt(0)
    v_max_f32_dpp v48, v48, v48 quad_perm:[1,0,3,2] row_mask:0xf bank_mask:0xf
    s_nop 1
    v_max_f32_dpp v48, v48, v48 quad_perm:[2,3,0,1] row_mask:0xf bank_mask:0xf
    v_sub_f32 v48, v50, v48
    v_exp_f32 v48, v48
    s_nop 0
    v_mul_f32 v60, v60, v48
    v_mul_f32 v61, v61, v48
    s_cmp_lg_u32 s3, 0
    ds_write_b64 v7, v[60:61] offset:2048
    v_lshrrev_b32 v32, 8, v2
    v_and_b32 v33, 0xf8, v2
    v_lshl_or_b32 v38, v32, 2, v33
    s_waitcnt lgkmcnt(0)
    s_barrier
    s_cbranch_scc1 L_ownn
    ds_read_b64 v[32:33], v2 offset:2560
    ds_read_b64 v[34:35], v2 offset:3072
    ds_read_b64 v[36:37], v2 offset:3584
    s_waitcnt lgkmcnt(2)
    v_pk_add_f32 v[60:61], v[60:61], v[32:33]
    s_waitcnt lgkmcnt(0)
    v_pk_add_f32 v[34:35], v[34:35], v[36:37]
    v_pk_add_f32 v[60:61], v[60:61], v[34:35]
    v_cvt_pk_bf16_f32 v60, v60, v61
    v_min_u32 v60, -2, v60
    s_cmp_eq_u32 s8, 0
    s_cbranch_scc0 L_st_own
    buffer_store_dword v60, v38, s[36:39], s74 offen
L_str_own:
L_ownn:
    s_waitcnt vmcnt(0)
    s_mov_b64 exec, 1
    s_cmp_eq_u32 s8, 0
    s_cbranch_scc0 L_st_owns
    buffer_store_dwordx2 v[50:51], off, s[36:39], s73 offset:896
L_str_owns:
    s_mov_b64 exec, -1
    s_cmp_eq_u32 s91, 4
    s_cbranch_scc1 L_i4
    s_add_u32 s86, s86, 1
    s_branch L_loop
L_out:
    s_lshr_b32 s73, s2, 1
    s_sub_u32 s73, s73, 0
    s_cmp_eq_u32 s73, s3
    s_cbranch_scc0 L_outn
    v_and_b32 v28, 16, v1
    s_movk_i32 s73, 0x3f80
    v_lshlrev_b32 v28, v28, s73
    s_mov_b32 s80, 0x00030003
    s_mov_b32 s81, 0x00030003
    v_cndmask_b32 v48, 0, v28, s[80:81]
    s_mov_b32 s80, 0x00300030
    s_mov_b32 s81, 0x00300030
    v_cndmask_b32 v49, 0, v28, s[80:81]
    s_mov_b32 s80, 0x03000300
    s_mov_b32 s81, 0x03000300
    v_cndmask_b32 v50, 0, v28, s[80:81]
    s_mov_b32 s80, 0x30003000
    s_mov_b32 s81, 0x30003000
    v_cndmask_b32 v51, 0, v28, s[80:81]
    v_and_b32 v52, 0x380, v1
    v_add_u32 v52, v52, v1
    v_mov_b64 v[44:45], 0
    v_mov_b64 v[46:47], 0
    s_and_b32 s74, s2, 1
    s_lshl_b32 s73, s74, 7
    s_add_u32 s73, s73, s94
    s_lshl_b32 s74, s74, 3
    s_lshl_b64 s[80:81], s[76:77], s74
    s_add_u32 s74, s73, 4096
L_ws6:
    s_cbranch_execz L_wr5
    s_waitcnt vmcnt(0)
L_o_ld:
    buffer_load_dwordx4 v[32:35], v52, s[36:39], s73 offen offset:0 sc1
    buffer_load_dwordx4 v[36:39], v52, s[36:39], s73 offen offset:2048 sc1
    buffer_load_dwordx4 v[40:43], v52, s[36:39], s74 offen offset:0 sc1
    s_mov_b32 exec_hi, 0
    buffer_load_dwordx4 v[44:47], v52, s[36:39], s74 offen offset:2048 sc1
    s_mov_b32 exec_hi, -1
    s_waitcnt vmcnt(3)
    v_mfma_f32_16x16x32_bf16 v[28:31], v[48:51], v[32:35], 0
    s_waitcnt vmcnt(2)
    v_mfma_f32_16x16x32_bf16 v[28:31], v[48:51], v[36:39], v[28:31]
    s_waitcnt vmcnt(1)
    v_mfma_f32_16x16x32_bf16 v[28:31], v[48:51], v[40:43], v[28:31]
    s_waitcnt vmcnt(0)
    v_mfma_f32_16x16x32_bf16 v[28:31], v[48:51], v[44:47], v[28:31]
    s_nop 7
    v_add_f32_dpp v28, v28, v28 row_ror:8 row_mask:0xf bank_mask:0xf
    v_add_f32_dpp v29, v29, v29 row_ror:8 row_mask:0xf bank_mask:0xf
    v_cmp_u_f32 vcc, v28, v29
    v_cvt_pk_bf16_f32 v28, 0, v28
    v_cvt_pk_bf16_f32 v29, 0, v29
    v_add_f32 v28, v112, v28
    v_add_f32 v29, v113, v29
    v_cvt_pk_bf16_f32 v28, v28, v29
    s_cbranch_vccnz L_o_bad
L_o_ok:
    s_mov_b64 exec, s[80:81]
    buffer_store_dword v28, v6, s[68:71], s100 offen sc1
    s_mov_b64 exec, -1
L_outn:
    s_cmp_eq_u32 s86, 3
    s_cbranch_scc0 L_next
    s_endpgm
L_next:
    v_lshlrev_b32 v28, 2, v0
    buffer_load_dword v29, v28, s[40:43], 0 offen sc1
    s_waitcnt vmcnt(0)
    v_cmp_eq_u32 vcc, 2, v29
    s_nop 0
    s_bcnt1_i32_b32 s73, vcc_hi
    v_cmp_eq_u32 vcc, 1, v29
    s_nop 0
    s_bcnt1_i32_b32 s74, vcc_hi
    s_cmp_gt_u32 s73, s74
    s_cselect_b32 s1, 1, 0
    s_xor_b32 s1, s1, s27
    s_and_b32 s1, s1, 1
    s_lshl_b32 s101, s1, 13
    v_mov_b32 v112, v114
    v_mov_b32 v113, v115
    s_add_u32 s99, s99, 2048
    s_mov_b32 s100, 1024
    s_add_u32 s92, s92, 1024
    s_mov_b32 s87, 32
    s_branch L_own
L_st_fill0:
    buffer_store_dwordx2 v[34:35], v5, s[36:39], s73 offen sc1
    s_branch L_str_fill0
L_st_s0:
    buffer_store_dwordx2 v[26:27], off, s[36:39], s91 sc1
    s_branch L_str_s0
L_st_fill1:
    buffer_store_dwordx2 v[52:53], v5, s[36:39], s73 offen sc1
    s_branch L_str_fill1
L_st_s1:
    buffer_store_dwordx2 v[26:27], off, s[36:39], s91 sc1
    s_branch L_str_s1
L_oagain:
    s_nop 1
    buffer_load_dwordx4 v[48:51], v37, s[36:39], s95 offen offset:0 sc1
    buffer_load_dwordx4 v[52:55], v37, s[36:39], s95 offen offset:2048 sc1
    s_waitcnt vmcnt(3)
    v_mfma_f32_16x16x32_bf16 v[44:47], v[56:59], v[80:83], 0
    s_waitcnt vmcnt(2)
    v_mfma_f32_16x16x32_bf16 v[44:47], v[60:63], v[84:87], v[44:47]
    v_max3_u32 v29, v80, v81, v82
    v_max3_u32 v29, v29, v83, v84
    v_max3_u32 v29, v29, v85, v86
    v_max_u32 v29, v29, v87
    v_cmp_eq_u32 vcc, -1, v29
    s_nop 2
    v_pk_add_f32 v[44:45], v[44:45], v[46:47]
    v_cvt_pk_bf16_f32 v16, v44, v45
    s_nop 1
    v_mov_b32_dpp v17, v16 row_ror:12 row_mask:0xf bank_mask:0xf
    s_cbranch_vccz L_ook
    buffer_load_dwordx4 v[80:83], v37, s[36:39], s95 offen offset:0 sc1
    buffer_load_dwordx4 v[84:87], v37, s[36:39], s95 offen offset:2048 sc1
    s_sub_u32 s72, s72, 1
    s_cbranch_scc0 L_ogather
    s_endpgm
L_y_bad:
    s_nop 1
    v_max3_u32 v31, v124, v125, v126
    v_max3_u32 v31, v31, v127, v20
    v_max3_u32 v31, v31, v21, v22
    v_max_u32 v31, v31, v23
    v_cmp_eq_u32 vcc, -1, v31
    s_nop 4
    s_cbranch_vccz L_y_ok
    s_sub_u32 s72, s72, 1
    s_cbranch_scc0 L_y_ld
    s_endpgm
L_z_bad:
    s_nop 1
    v_max3_u32 v30, v32, v33, v34
    v_max3_u32 v30, v30, v35, v36
    v_max3_u32 v30, v30, v37, v38
    v_max3_u32 v30, v30, v39, v40
    v_max3_u32 v30, v30, v41, v42
    v_max3_u32 v30, v30, v43, v44
    v_max3_u32 v30, v30, v45, v46
    v_max3_u32 v30, v30, v47, v48
    v_max3_u32 v30, v30, v49, v50
    v_max3_u32 v30, v30, v51, v52
    v_max3_u32 v30, v30, v53, v54
    v_max3_u32 v30, v30, v55, v56
    v_max3_u32 v30, v30, v57, v58
    v_max_u32 v30, v30, v59
    v_cmp_eq_u32 vcc, -1, v30
    s_nop 4
    s_cbranch_vccz L_z_ok
    s_sub_u32 s72, s72, 1
    s_cbranch_scc0 L_z_ld
    s_endpgm
L_st_owns:
    buffer_store_dwordx2 v[50:51], off, s[36:39], s73 offset:896 sc1
    s_branch L_str_owns
L_o_bad:
    s_nop 1
    v_max3_u32 v30, v32, v33, v34
    v_max3_u32 v30, v30, v35, v36
    v_max3_u32 v30, v30, v37, v38
    v_max3_u32 v30, v30, v39, v40
    v_max3_u32 v30, v30, v41, v42
    v_max3_u32 v30, v30, v43, v44
    v_max3_u32 v30, v30, v45, v46
    v_max_u32 v30, v30, v47
    v_cmp_eq_u32 vcc, -1, v30
    s_nop 4
    s_cbranch_vccz L_o_ok
    s_sub_u32 s72, s72, 1
    s_cbranch_scc0 L_o_ld
    s_endpgm
L_st_o0:
    buffer_store_dword v12, v34, s[36:39], s90 offen sc1
    s_branch L_str_o0
L_st_sp:
    buffer_store_dwordx2 v[26:27], off, s[36:39], s91 sc1
    s_branch L_str_sp
L_st_op:
    buffer_store_dword v104, v34, s[36:39], s90 offen sc1
    s_branch L_str_op
L_st_o1:
    buffer_store_dword v12, v34, s[36:39], s90 offen sc1
    s_branch L_str_o1
L_st_own:
    buffer_store_dword v60, v38, s[36:39], s74 offen sc1
    s_branch L_str_own
s_endpgm
.section .rodata,"a"
.p2align 6
.amdhsa_kernel interleave_layers__mha_block_cached__glu_gated_geglu__decode_kernel
  .amdhsa_next_free_vgpr 512
  .amdhsa_next_free_sgpr 102
  .amdhsa_accum_offset 256
  .amdhsa_group_segment_fixed_size 0
  .amdhsa_kernarg_size 96
  .amdhsa_user_sgpr_count 2
  .amdhsa_user_sgpr_kernarg_segment_ptr 1
  .amdhsa_system_sgpr_workgroup_id_x 1
.end_amdhsa_kernel
```
